```python
import torch

def _softmax(x, axis=-1):
    return torch.softmax(x, dim=axis)
def _gelu(x):
    return torch.nn.functional.gelu(x, approximate="tanh")
def _silu(x):
    return torch.nn.functional.silu(x)
def _sigmoid(x):
    return torch.sigmoid(x)
def _layernorm(x, axis=-1, eps=1e-5):
    m = x.mean(dim=axis, keepdim=True)
    v = x.var(dim=axis, keepdim=True, unbiased=False)
    return (x - m) / torch.sqrt(v + eps)
def _scatter_add(tgt, idx, src, axis=0):
    return tgt.clone().index_add_(axis, idx, src)
def _segment_sum(src, seg, n):
    out = torch.zeros((n,) + src.shape[1:], dtype=src.dtype)
    return out.index_add_(0, seg, src)
def _pad(x, pw):
    flat = tuple(v for pair in reversed(pw) for v in pair)
    return torch.nn.functional.pad(x, flat)

kernel_name = 'interleave_layers__linear_kernel_hedgehog__sliding_block__prompt'

def setup_inputs():

    _w = (lambda a: (lambda t: t.to(torch.bfloat16) if t.is_floating_point() else t)(torch.as_tensor(a)))
    def _A_setup():
        B, S, D, H = 1, 2048, 576, 32
        Dh = D // H
        return {
            "x": _w((lambda *s: torch.randn(*s, dtype=torch.bfloat16) * 0.05)(B, S, D)),
            "wqkv": _w((lambda *s: torch.randn(*s, dtype=torch.bfloat16) * 0.2)(D, 3 * D)),
            "w_phi": _w((lambda *s: torch.randn(*s, dtype=torch.bfloat16) * 0.2)(H, Dh, Dh) * (Dh ** -0.5)),
            "wo": _w((lambda *s: torch.randn(*s, dtype=torch.bfloat16) * 0.05)(D, D)),
        }
    _A_in = _A_setup()

    def _B_setup():
        B, S, D = 1, 2048, 576
        return {
            "x": _w((lambda *s: torch.randn(*s, dtype=torch.bfloat16) * 0.05)(B, S, D)),
            "wqkv": _w((lambda *s: torch.randn(*s, dtype=torch.bfloat16) * 0.1)(D, 3 * D)),
            "wo": _w((lambda *s: torch.randn(*s, dtype=torch.bfloat16) * 0.05)(D, D)),
        }
    _B_in = _B_setup()

    return {
        "A_x": _A_in["x"],
        "A_wqkv": _A_in["wqkv"],
        "A_w_phi": _A_in["w_phi"],
        "A_wo": _A_in["wo"],
        "B_x": _B_in["x"],
        "B_wqkv": _B_in["wqkv"],
        "B_wo": _B_in["wo"],
    }

def reference(A_x, A_wqkv, A_w_phi, A_wo, B_x, B_wqkv, B_wo):
    def _A_ref(x, wqkv, w_phi, wo):
        B, S, D = x.shape
        H = 32; Dh = D // H
        qkv = (lambda x, *d: x.permute(*d))((x @ wqkv).reshape(B, S, 3, H, Dh), 2, 0, 3, 1, 4)
        q, k, v = qkv[0], qkv[1], qkv[2]
        pq = torch.einsum("bhsd,hdf->bhsf", q, w_phi)
        pk = torch.einsum("bhsd,hdf->bhsf", k, w_phi)
        phi_q = torch.concatenate([_softmax(pq, axis=-1), _softmax(-pq, axis=-1)], axis=-1)
        phi_k = torch.concatenate([_softmax(pk, axis=-1), _softmax(-pk, axis=-1)], axis=-1)
        kv = torch.einsum("bhsf,bhsd->bhfd", phi_k, v)
        z  = torch.einsum("bhsf->bhf", phi_k)
        num = torch.einsum("bhqf,bhfd->bhqd", phi_q, kv)
        den = torch.einsum("bhqf,bhf->bhq", phi_q, z)[..., None] + 1e-6
        o = num / den
        return (lambda x, *d: x.permute(*d))(o, 0, 2, 1, 3).reshape(B, S, D) @ wo

    def _B_ref(x, wqkv, wo):
        B, S, D = x.shape
        H = 32; Dh = D // H; W = 256
        qkv = (lambda x, *d: x.permute(*d))((x @ wqkv).reshape(B, S, 3, H, Dh), 2, 0, 3, 1, 4)
        q, k, v = qkv[0], qkv[1], qkv[2]
        scores = torch.einsum("bhqd,bhkd->bhqk", q, k) * (Dh ** -0.5)
        idx = torch.arange(S)
        mask = (idx[:, None] - idx[None, :] >= 0) & (idx[:, None] - idx[None, :] < W)
        scores = torch.where(mask[None, None], scores, -1e9)
        p = _softmax(scores, axis=-1)
        o = torch.einsum("bhqk,bhkd->bhqd", p, v)
        return (lambda x, *d: x.permute(*d))(o, 0, 2, 1, 3).reshape(B, S, D) @ wo

    x = A_x
    x = x + _A_ref(_layernorm(x, axis=-1), A_wqkv, A_w_phi, A_wo)
    x = x + _B_ref(_layernorm(x, axis=-1), B_wqkv, B_wo)
    x = x + _A_ref(_layernorm(x, axis=-1), A_wqkv, A_w_phi, A_wo)
    x = x + _B_ref(_layernorm(x, axis=-1), B_wqkv, B_wo)
    return x
```

```asm
; @launch kernel=mega_kernel grid=(256,1,1) block=(256,1,1) lds=163840
.amdgcn_target "amdgcn-amd-amdhsa--gfx950"
.text
.globl mega_kernel
.p2align 8
.type mega_kernel,@function
mega_kernel:
    s_load_dwordx16 s[4:19], s[0:1], 0
    s_load_dwordx4 s[20:23], s[0:1], 64
    s_cmp_ge_u32 s2, 256
    s_cbranch_scc1 mega_end
    v_lshrrev_b32 v5, 6, v0
    s_mov_b32 s98, s2
    v_readfirstlane_b32 s99, v5
    v_and_b32 v0, 63, v0
    s_getpc_b64 s[90:91]
    v_lshlrev_b32 v3, 4, v0
    s_lshl_b32 s61, s99, 12
    v_add_u32 v3, s61, v3
    global_load_dwordx4 a[0:3], v3, s[90:91] offset:0
    global_load_dwordx4 a[4:7], v3, s[90:91] offset:1024
    global_load_dwordx4 a[8:11], v3, s[90:91] offset:2048
    global_load_dwordx4 a[12:15], v3, s[90:91] offset:3072
    s_waitcnt lgkmcnt(0)
    s_cmp_lg_u32 s99, 0
    s_cbranch_scc1 mega_nononce
    s_memrealtime s[92:93]
    s_mov_b32 s88, s20
    s_mov_b32 s89, s21
    s_mov_b32 s90, 256
    s_mov_b32 s91, 0x00020000
    s_waitcnt lgkmcnt(0)
    s_lshl_b32 s92, s92, 5
    s_or_b32 s92, s92, 0x80000000
    v_mov_b32 v250, s92
    v_mov_b32 v251, 0
    s_mov_b64 exec, 1
    buffer_atomic_cmpswap v[250:251], off, s[88:91], 0 sc0 sc1
    s_mov_b64 exec, -1
mega_nononce:
    s_nop 1
    v_and_b32 v1, 15, v0
    v_lshrrev_b32 v2, 4, v0
    v_lshlrev_b32 v3, 4, v0
    s_mov_b32 s97, -1
    s_mov_b32 s96, 1
    s_cmp_lt_u32 s98, 128
    s_cbranch_scc1 prep_noxi
    s_mov_b32 s68, s4
    s_mov_b32 s69, s5
    s_mov_b32 s70, 2359296
    s_mov_b32 s71, 0x00020000
    s_sub_u32 s72, s98, 128
    s_mul_i32 s73, s72, 18432
    s_lshl_b32 s74, s99, 10
    s_add_u32 s75, s74, 0
    s_add_u32 s76, s75, 65536
    s_add_u32 s75, s75, s73
    s_mov_b32 m0, s76
    s_nop 0
    buffer_load_dwordx4 v3, s[68:71], s75 offen lds
    s_add_u32 s75, s74, 4096
    s_add_u32 s76, s75, 65536
    s_add_u32 s75, s75, s73
    s_mov_b32 m0, s76
    s_nop 0
    buffer_load_dwordx4 v3, s[68:71], s75 offen lds
    s_add_u32 s75, s74, 8192
    s_add_u32 s76, s75, 65536
    s_add_u32 s75, s75, s73
    s_mov_b32 m0, s76
    s_nop 0
    buffer_load_dwordx4 v3, s[68:71], s75 offen lds
    s_add_u32 s75, s74, 12288
    s_add_u32 s76, s75, 65536
    s_add_u32 s75, s75, s73
    s_mov_b32 m0, s76
    s_nop 0
    buffer_load_dwordx4 v3, s[68:71], s75 offen lds
    s_add_u32 s75, s74, 16384
    s_min_u32 s75, s75, 17408
    s_add_u32 s76, s75, 65536
    s_add_u32 s75, s75, s73
    s_mov_b32 m0, s76
    s_nop 0
    buffer_load_dwordx4 v3, s[68:71], s75 offen lds
prep_noxi:
    s_cmp_ge_u32 s98, 144
    s_cbranch_scc1 prep_other
    s_cmp_ge_u32 s98, 72
    s_cselect_b32 s40, 1, 0
    s_cselect_b32 s41, 72, 0
    s_cselect_b32 s24, s14, s6
    s_cselect_b32 s25, s15, s7
    s_mov_b32 s42, 0
    s_cselect_b32 s42, 2932736, s42
    s_mov_b32 s26, 1990656
    s_mov_b32 s27, 0x00020000
    s_sub_u32 s41, s98, s41
    s_and_b32 s43, s41, 1
    s_lshr_b32 s41, s41, 1
    s_add_u32 s28, s22, s42
    s_addc_u32 s29, s23, 0
    s_mov_b32 s30, 2097152
    s_mov_b32 s31, 0x00020000
    s_mov_b32 s36, s8
    s_mov_b32 s37, s9
    s_mov_b32 s38, 20736
    s_mov_b32 s39, 0x00020000
    s_mul_i32 s44, s43, 10368
    s_lshl_b32 s45, s99, 10
    s_add_u32 s46, s45, 0
    s_min_u32 s46, s46, 10240
    s_add_u32 s47, s46, 28672
    s_add_u32 s46, s46, s44
    s_mov_b32 m0, s47
    s_nop 0
    buffer_load_dwordx4 v3, s[36:39], s46 offen lds
    s_add_u32 s46, s45, 4096
    s_min_u32 s46, s46, 10240
    s_add_u32 s47, s46, 28672
    s_add_u32 s46, s46, s44
    s_mov_b32 m0, s47
    s_nop 0
    buffer_load_dwordx4 v3, s[36:39], s46 offen lds
    s_add_u32 s46, s45, 8192
    s_min_u32 s46, s46, 10240
    s_add_u32 s47, s46, 28672
    s_add_u32 s46, s46, s44
    s_mov_b32 m0, s47
    s_nop 0
    buffer_load_dwordx4 v3, s[36:39], s46 offen lds
    s_mul_i32 s44, s41, 55296
    s_mul_i32 s45, s99, 13824
    s_add_u32 s44, s44, s45
    s_mul_i32 s45, s43, 576
    s_add_u32 s44, s44, s45
    s_mul_i32 s45, s99, 6912
    s_mov_b32 exec_lo, -1
    s_mov_b32 exec_hi, 15
    s_add_u32 s46, s44, 0
    s_add_u32 s47, s45, 0
    s_mov_b32 m0, s47
    s_nop 0
    buffer_load_dwordx4 v3, s[24:27], s46 offen lds
    s_add_u32 s46, s44, 1152
    s_add_u32 s47, s45, 576
    s_mov_b32 m0, s47
    s_nop 0
    buffer_load_dwordx4 v3, s[24:27], s46 offen lds
    s_add_u32 s46, s44, 2304
    s_add_u32 s47, s45, 1152
    s_mov_b32 m0, s47
    s_nop 0
    buffer_load_dwordx4 v3, s[24:27], s46 offen lds
    s_add_u32 s46, s44, 3456
    s_add_u32 s47, s45, 1728
    s_mov_b32 m0, s47
    s_nop 0
    buffer_load_dwordx4 v3, s[24:27], s46 offen lds
    s_add_u32 s46, s44, 4608
    s_add_u32 s47, s45, 2304
    s_mov_b32 m0, s47
    s_nop 0
    buffer_load_dwordx4 v3, s[24:27], s46 offen lds
    s_add_u32 s46, s44, 5760
    s_add_u32 s47, s45, 2880
    s_mov_b32 m0, s47
    s_nop 0
    buffer_load_dwordx4 v3, s[24:27], s46 offen lds
    s_add_u32 s46, s44, 6912
    s_add_u32 s47, s45, 3456
    s_mov_b32 m0, s47
    s_nop 0
    buffer_load_dwordx4 v3, s[24:27], s46 offen lds
    s_add_u32 s46, s44, 8064
    s_add_u32 s47, s45, 4032
    s_mov_b32 m0, s47
    s_nop 0
    buffer_load_dwordx4 v3, s[24:27], s46 offen lds
    s_add_u32 s46, s44, 9216
    s_add_u32 s47, s45, 4608
    s_mov_b32 m0, s47
    s_nop 0
    buffer_load_dwordx4 v3, s[24:27], s46 offen lds
    s_add_u32 s46, s44, 10368
    s_add_u32 s47, s45, 5184
    s_mov_b32 m0, s47
    s_nop 0
    buffer_load_dwordx4 v3, s[24:27], s46 offen lds
    s_add_u32 s46, s44, 11520
    s_add_u32 s47, s45, 5760
    s_mov_b32 m0, s47
    s_nop 0
    buffer_load_dwordx4 v3, s[24:27], s46 offen lds
    s_add_u32 s46, s44, 12672
    s_add_u32 s47, s45, 6336
    s_mov_b32 m0, s47
    s_nop 0
    buffer_load_dwordx4 v3, s[24:27], s46 offen lds
    s_mov_b64 exec, -1
    s_lshl_b32 s44, s43, 3
    s_lshl_b32 s45, s99, 1
    s_add_u32 s44, s44, s45
    s_lshl_b32 s45, s44, 17
    s_and_b32 s46, s41, 1
    s_lshl_b32 s46, s46, 9
    s_add_u32 s45, s45, s46
    v_lshrrev_b32 v20, 1, v2
    v_and_b32 v21, 1, v2
    v_lshlrev_b32 v5, 8, v20
    v_lshl_add_u32 v5, v1, 4, v5
    v_lshl_add_u32 v5, v21, 3, v5
    v_add_u32 v5, s45, v5
    s_lshr_b32 s48, s41, 1
    s_mul_i32 s49, s99, 144
    v_mul_u32_u24 v4, 6912, v2
    v_add_u32 v4, s49, v4
    v_lshrrev_b32 v16, 3, v1
    v_bfe_u32 v17, v1, 2, 1
    v_and_b32 v18, 3, v1
    s_cmp_eq_u32 s40, 1
    s_cbranch_scc1 prep_wb
    v_mul_u32_u24 v19, 9, v17
    v_add_u32 v19, v19, v18
    s_mul_i32 s50, s99, 2592
    s_add_u32 s50, s50, 28672
    v_mul_u32_u24 v22, 648, v16
    v_lshl_add_u32 v22, v19, 1, v22
    v_add_u32 v22, s50, v22
    v_add_u32 v23, 576, v22
    v_mul_u32_u24 v24, 288, v21
    v_add_u32 v22, v22, v24
    v_cmp_eq_u32 s[52:53], v20, v16
    v_cmp_eq_u32 s[54:55], v2, v16
    v_cmp_eq_u32 s[58:59], 0, v18
    v_cmp_lt_u32 s[60:61], 1, v18
    s_not_b64 s[62:63], s[58:59]
    s_not_b64 s[64:65], s[60:61]
    v_mul_u32_u24 v25, 1728, v1
    v_add_u32 v25, s49, v25
    v_mul_u32_u24 v26, 36, v20
    v_lshl_add_u32 v26, v21, 4, v26
    v_add_u32 v26, v25, v26
    v_mul_u32_u24 v27, 36, v2
    v_add3_u32 v27, v25, v27, 32
    v_mul_u32_u24 v28, 18, v16
    v_add_u32 v28, v28, v19
    v_lshl_add_u32 v28, v28, 1, v4
    s_waitcnt vmcnt(12)
    s_barrier
    ds_read_u16 v128, v22 offset:0
    ds_read_u16 v129, v22 offset:36
    ds_read_u16 v130, v22 offset:72
    ds_read_u16 v131, v22 offset:108
    ds_read_u16 v132, v22 offset:144
    ds_read_u16 v133, v22 offset:180
    ds_read_u16 v134, v22 offset:216
    ds_read_u16 v135, v22 offset:252
    ds_read_u16 v136, v23 offset:0
    ds_read_u16 v137, v23 offset:36
    ds_read_u16 v138, v22 offset:8
    ds_read_u16 v139, v22 offset:44
    ds_read_u16 v140, v22 offset:80
    ds_read_u16 v141, v22 offset:116
    ds_read_u16 v142, v22 offset:152
    ds_read_u16 v143, v22 offset:188
    ds_read_u16 v144, v22 offset:224
    ds_read_u16 v145, v22 offset:260
    ds_read_u16 v146, v23 offset:8
    ds_read_u16 v147, v23 offset:44
    ds_read_u16 v148, v22 offset:16
    ds_read_u16 v149, v22 offset:52
    ds_read_u16 v150, v22 offset:88
    ds_read_u16 v151, v22 offset:124
    ds_read_u16 v152, v22 offset:160
    ds_read_u16 v153, v22 offset:196
    ds_read_u16 v154, v22 offset:232
    ds_read_u16 v155, v22 offset:268
    ds_read_u16 v156, v23 offset:16
    ds_read_u16 v157, v23 offset:52
    ds_read_u16 v158, v22
    ds_read_u16 v159, v22 offset:32
    ds_read_u16 v160, v22 offset:68
    ds_read_u16 v161, v22 offset:104
    ds_read_u16 v162, v22 offset:140
    ds_read_u16 v163, v22 offset:176
    ds_read_u16 v164, v22 offset:212
    ds_read_u16 v165, v22 offset:248
    ds_read_u16 v166, v23
    ds_read_u16 v167, v23 offset:32
    ds_read_u16 v168, v22 offset:4
    ds_read_u16 v169, v22 offset:40
    ds_read_u16 v170, v22 offset:76
    ds_read_u16 v171, v22 offset:112
    ds_read_u16 v172, v22 offset:148
    ds_read_u16 v173, v22 offset:184
    ds_read_u16 v174, v22 offset:220
    ds_read_u16 v175, v22 offset:256
    ds_read_u16 v176, v23 offset:4
    ds_read_u16 v177, v23 offset:40
    ds_read_u16 v178, v22 offset:12
    ds_read_u16 v179, v22 offset:48
    ds_read_u16 v180, v22 offset:84
    ds_read_u16 v181, v22 offset:120
    ds_read_u16 v182, v22 offset:156
    ds_read_u16 v183, v22 offset:192
    ds_read_u16 v184, v22 offset:228
    ds_read_u16 v185, v22 offset:264
    ds_read_u16 v186, v23 offset:12
    ds_read_u16 v187, v23 offset:48
    v_subrev_u32 v29, 4, v22
    v_subrev_u32 v30, 4, v23
    s_waitcnt lgkmcnt(0)
    ds_read_u16 v158, v29
    ds_read_u16 v166, v30
    s_waitcnt lgkmcnt(0)
    v_lshl_or_b32 v32, v129, 16, v128
    v_cndmask_b32 v32, 0, v32, s[52:53]
    v_lshl_or_b32 v33, v131, 16, v130
    v_cndmask_b32 v33, 0, v33, s[52:53]
    v_lshl_or_b32 v34, v133, 16, v132
    v_cndmask_b32 v34, 0, v34, s[52:53]
    v_lshl_or_b32 v35, v135, 16, v134
    v_cndmask_b32 v35, 0, v35, s[52:53]
    v_lshl_or_b32 v36, v137, 16, v136
    v_cndmask_b32 v36, 0, v36, s[54:55]
    v_mov_b32 v37, 0
    v_mov_b32 v38, 0
    v_mov_b32 v39, 0
    v_lshl_or_b32 v40, v139, 16, v138
    v_cndmask_b32 v40, 0, v40, s[52:53]
    v_lshl_or_b32 v41, v141, 16, v140
    v_cndmask_b32 v41, 0, v41, s[52:53]
    v_lshl_or_b32 v42, v143, 16, v142
    v_cndmask_b32 v42, 0, v42, s[52:53]
    v_lshl_or_b32 v43, v145, 16, v144
    v_cndmask_b32 v43, 0, v43, s[52:53]
    v_lshl_or_b32 v44, v147, 16, v146
    v_cndmask_b32 v44, 0, v44, s[54:55]
    v_mov_b32 v45, 0
    v_mov_b32 v46, 0
    v_mov_b32 v47, 0
    v_lshl_or_b32 v48, v149, 16, v148
    v_cndmask_b32 v48, 0, v48, s[52:53]
    v_lshl_or_b32 v49, v151, 16, v150
    v_cndmask_b32 v49, 0, v49, s[52:53]
    v_lshl_or_b32 v50, v153, 16, v152
    v_cndmask_b32 v50, 0, v50, s[52:53]
    v_lshl_or_b32 v51, v155, 16, v154
    v_cndmask_b32 v51, 0, v51, s[52:53]
    v_lshl_or_b32 v52, v157, 16, v156
    v_cndmask_b32 v52, 0, v52, s[54:55]
    v_mov_b32 v53, 0
    v_mov_b32 v54, 0
    v_mov_b32 v55, 0
    v_lshl_or_b32 v56, v159, 16, v158
    v_cndmask_b32 v56, 0, v56, s[52:53]
    v_lshl_or_b32 v57, v161, 16, v160
    v_cndmask_b32 v57, 0, v57, s[52:53]
    v_lshl_or_b32 v58, v163, 16, v162
    v_cndmask_b32 v58, 0, v58, s[52:53]
    v_lshl_or_b32 v59, v165, 16, v164
    v_cndmask_b32 v59, 0, v59, s[52:53]
    v_lshl_or_b32 v60, v167, 16, v166
    v_cndmask_b32 v60, 0, v60, s[54:55]
    v_mov_b32 v61, 0
    v_mov_b32 v62, 0
    v_mov_b32 v63, 0
    v_lshl_or_b32 v64, v169, 16, v168
    v_cndmask_b32 v64, 0, v64, s[52:53]
    v_lshl_or_b32 v65, v171, 16, v170
    v_cndmask_b32 v65, 0, v65, s[52:53]
    v_lshl_or_b32 v66, v173, 16, v172
    v_cndmask_b32 v66, 0, v66, s[52:53]
    v_lshl_or_b32 v67, v175, 16, v174
    v_cndmask_b32 v67, 0, v67, s[52:53]
    v_lshl_or_b32 v68, v177, 16, v176
    v_cndmask_b32 v68, 0, v68, s[54:55]
    v_mov_b32 v69, 0
    v_mov_b32 v70, 0
    v_mov_b32 v71, 0
    v_lshl_or_b32 v72, v179, 16, v178
    v_cndmask_b32 v72, 0, v72, s[52:53]
    v_lshl_or_b32 v73, v181, 16, v180
    v_cndmask_b32 v73, 0, v73, s[52:53]
    v_lshl_or_b32 v74, v183, 16, v182
    v_cndmask_b32 v74, 0, v74, s[52:53]
    v_lshl_or_b32 v75, v185, 16, v184
    v_cndmask_b32 v75, 0, v75, s[52:53]
    v_lshl_or_b32 v76, v187, 16, v186
    v_cndmask_b32 v76, 0, v76, s[54:55]
    v_mov_b32 v77, 0
    v_mov_b32 v78, 0
    v_mov_b32 v79, 0
    ds_read_u16 v128, v22 offset:1296
    ds_read_u16 v129, v22 offset:1332
    ds_read_u16 v130, v22 offset:1368
    ds_read_u16 v131, v22 offset:1404
    ds_read_u16 v132, v22 offset:1440
    ds_read_u16 v133, v22 offset:1476
    ds_read_u16 v134, v22 offset:1512
    ds_read_u16 v135, v22 offset:1548
    ds_read_u16 v136, v23 offset:1296
    ds_read_u16 v137, v23 offset:1332
    ds_read_u16 v138, v22 offset:1304
    ds_read_u16 v139, v22 offset:1340
    ds_read_u16 v140, v22 offset:1376
    ds_read_u16 v141, v22 offset:1412
    ds_read_u16 v142, v22 offset:1448
    ds_read_u16 v143, v22 offset:1484
    ds_read_u16 v144, v22 offset:1520
    ds_read_u16 v145, v22 offset:1556
    ds_read_u16 v146, v23 offset:1304
    ds_read_u16 v147, v23 offset:1340
    ds_read_u16 v148, v22 offset:1312
    ds_read_u16 v149, v22 offset:1348
    ds_read_u16 v150, v22 offset:1384
    ds_read_u16 v151, v22 offset:1420
    ds_read_u16 v152, v22 offset:1456
    ds_read_u16 v153, v22 offset:1492
    ds_read_u16 v154, v22 offset:1528
    ds_read_u16 v155, v22 offset:1564
    ds_read_u16 v156, v23 offset:1312
    ds_read_u16 v157, v23 offset:1348
    ds_read_u16 v158, v22 offset:1292
    ds_read_u16 v159, v22 offset:1328
    ds_read_u16 v160, v22 offset:1364
    ds_read_u16 v161, v22 offset:1400
    ds_read_u16 v162, v22 offset:1436
    ds_read_u16 v163, v22 offset:1472
    ds_read_u16 v164, v22 offset:1508
    ds_read_u16 v165, v22 offset:1544
    ds_read_u16 v166, v23 offset:1292
    ds_read_u16 v167, v23 offset:1328
    ds_read_u16 v168, v22 offset:1300
    ds_read_u16 v169, v22 offset:1336
    ds_read_u16 v170, v22 offset:1372
    ds_read_u16 v171, v22 offset:1408
    ds_read_u16 v172, v22 offset:1444
    ds_read_u16 v173, v22 offset:1480
    ds_read_u16 v174, v22 offset:1516
    ds_read_u16 v175, v22 offset:1552
    ds_read_u16 v176, v23 offset:1300
    ds_read_u16 v177, v23 offset:1336
    ds_read_u16 v178, v22 offset:1308
    ds_read_u16 v179, v22 offset:1344
    ds_read_u16 v180, v22 offset:1380
    ds_read_u16 v181, v22 offset:1416
    ds_read_u16 v182, v22 offset:1452
    ds_read_u16 v183, v22 offset:1488
    ds_read_u16 v184, v22 offset:1524
    ds_read_u16 v185, v22 offset:1560
    ds_read_u16 v186, v23 offset:1308
    ds_read_u16 v187, v23 offset:1344
    s_waitcnt lgkmcnt(0)
    v_lshl_or_b32 v80, v129, 16, v128
    v_cndmask_b32 v80, 0, v80, s[52:53]
    v_lshl_or_b32 v81, v131, 16, v130
    v_cndmask_b32 v81, 0, v81, s[52:53]
    v_lshl_or_b32 v82, v133, 16, v132
    v_cndmask_b32 v82, 0, v82, s[52:53]
    v_lshl_or_b32 v83, v135, 16, v134
    v_cndmask_b32 v83, 0, v83, s[52:53]
    v_lshl_or_b32 v84, v137, 16, v136
    v_cndmask_b32 v84, 0, v84, s[54:55]
    v_mov_b32 v85, 0
    v_mov_b32 v86, 0
    v_mov_b32 v87, 0
    v_lshl_or_b32 v88, v139, 16, v138
    v_cndmask_b32 v88, 0, v88, s[52:53]
    v_lshl_or_b32 v89, v141, 16, v140
    v_cndmask_b32 v89, 0, v89, s[52:53]
    v_lshl_or_b32 v90, v143, 16, v142
    v_cndmask_b32 v90, 0, v90, s[52:53]
    v_lshl_or_b32 v91, v145, 16, v144
    v_cndmask_b32 v91, 0, v91, s[52:53]
    v_lshl_or_b32 v92, v147, 16, v146
    v_cndmask_b32 v92, 0, v92, s[54:55]
    v_mov_b32 v93, 0
    v_mov_b32 v94, 0
    v_mov_b32 v95, 0
    v_lshl_or_b32 v96, v149, 16, v148
    v_cndmask_b32 v96, 0, v96, s[52:53]
    v_lshl_or_b32 v97, v151, 16, v150
    v_cndmask_b32 v97, 0, v97, s[52:53]
    v_lshl_or_b32 v98, v153, 16, v152
    v_cndmask_b32 v98, 0, v98, s[52:53]
    v_lshl_or_b32 v99, v155, 16, v154
    v_cndmask_b32 v99, 0, v99, s[52:53]
    v_lshl_or_b32 v100, v157, 16, v156
    v_cndmask_b32 v100, 0, v100, s[54:55]
    v_mov_b32 v101, 0
    v_mov_b32 v102, 0
    v_mov_b32 v103, 0
    v_lshl_or_b32 v104, v159, 16, v158
    v_cndmask_b32 v104, 0, v104, s[52:53]
    v_lshl_or_b32 v105, v161, 16, v160
    v_cndmask_b32 v105, 0, v105, s[52:53]
    v_lshl_or_b32 v106, v163, 16, v162
    v_cndmask_b32 v106, 0, v106, s[52:53]
    v_lshl_or_b32 v107, v165, 16, v164
    v_cndmask_b32 v107, 0, v107, s[52:53]
    v_lshl_or_b32 v108, v167, 16, v166
    v_cndmask_b32 v108, 0, v108, s[54:55]
    v_mov_b32 v109, 0
    v_mov_b32 v110, 0
    v_mov_b32 v111, 0
    v_lshl_or_b32 v112, v169, 16, v168
    v_cndmask_b32 v112, 0, v112, s[52:53]
    v_lshl_or_b32 v113, v171, 16, v170
    v_cndmask_b32 v113, 0, v113, s[52:53]
    v_lshl_or_b32 v114, v173, 16, v172
    v_cndmask_b32 v114, 0, v114, s[52:53]
    v_lshl_or_b32 v115, v175, 16, v174
    v_cndmask_b32 v115, 0, v115, s[52:53]
    v_lshl_or_b32 v116, v177, 16, v176
    v_cndmask_b32 v116, 0, v116, s[54:55]
    v_mov_b32 v117, 0
    v_mov_b32 v118, 0
    v_mov_b32 v119, 0
    v_lshl_or_b32 v120, v179, 16, v178
    v_cndmask_b32 v120, 0, v120, s[52:53]
    v_lshl_or_b32 v121, v181, 16, v180
    v_cndmask_b32 v121, 0, v121, s[52:53]
    v_lshl_or_b32 v122, v183, 16, v182
    v_cndmask_b32 v122, 0, v122, s[52:53]
    v_lshl_or_b32 v123, v185, 16, v184
    v_cndmask_b32 v123, 0, v123, s[52:53]
    v_lshl_or_b32 v124, v187, 16, v186
    v_cndmask_b32 v124, 0, v124, s[54:55]
    v_mov_b32 v125, 0
    v_mov_b32 v126, 0
    v_mov_b32 v127, 0
    v_mov_b32 v197, 0
    v_mov_b32 v198, 0
    v_mov_b32 v199, 0
    v_mov_b32 v205, 0
    v_mov_b32 v206, 0
    v_mov_b32 v207, 0
    v_mov_b32 v213, 0
    v_mov_b32 v214, 0
    v_mov_b32 v215, 0
    v_mov_b32 v221, 0
    v_mov_b32 v222, 0
    v_mov_b32 v223, 0
    s_waitcnt vmcnt(0)
    s_barrier
    ds_read2_b32 v[192:193], v26 offset0:144 offset1:145
    ds_read2_b32 v[194:195], v26 offset0:146 offset1:147
    ds_read_b32 v196, v27 offset:576
    ds_read2_b32 v[200:201], v26 offset0:0 offset1:1
    ds_read2_b32 v[202:203], v26 offset0:2 offset1:3
    ds_read_b32 v204, v27 offset:0
    ds_read2_b32 v[208:209], v26 offset0:162 offset1:163
    ds_read2_b32 v[210:211], v26 offset0:164 offset1:165
    ds_read_b32 v212, v27 offset:648
    ds_read2_b32 v[216:217], v26 offset0:18 offset1:19
    ds_read2_b32 v[218:219], v26 offset0:20 offset1:21
    ds_read_b32 v220, v27 offset:72
    ds_read_u16 v128, v28 offset:1150
    ds_read_u16 v129, v28 offset:2878
    ds_read_u16 v130, v28 offset:4606
    ds_read_u16 v131, v28 offset:6334
    ds_read_u16 v132, v28 offset:1158
    ds_read_u16 v133, v28 offset:2886
    ds_read_u16 v134, v28 offset:4614
    ds_read_u16 v135, v28 offset:6342
    ds_read_u16 v136, v28 offset:1166
    ds_read_u16 v137, v28 offset:2894
    ds_read_u16 v138, v28 offset:4622
    ds_read_u16 v139, v28 offset:6350
    ds_read_u16 v140, v28 offset:1222
    ds_read_u16 v141, v28 offset:2950
    ds_read_u16 v142, v28 offset:4678
    ds_read_u16 v143, v28 offset:6406
    ds_read_u16 v144, v28 offset:1230
    ds_read_u16 v145, v28 offset:2958
    ds_read_u16 v146, v28 offset:4686
    ds_read_u16 v147, v28 offset:6414
    ds_read_u16 v148, v28 offset:1238
    ds_read_u16 v149, v28 offset:2966
    ds_read_u16 v150, v28 offset:4694
    ds_read_u16 v151, v28 offset:6422
    s_waitcnt lgkmcnt(15)
    v_mfma_f32_16x16x32_bf16 v[160:163], v[192:195], v[32:35], 0
    v_mfma_f32_16x16x32_bf16 v[160:163], v[196:199], v[36:39], v[160:163]
    v_mfma_f32_16x16x32_bf16 v[164:167], v[192:195], v[40:43], 0
    v_mfma_f32_16x16x32_bf16 v[164:167], v[196:199], v[44:47], v[164:167]
    v_mfma_f32_16x16x32_bf16 v[168:171], v[192:195], v[48:51], 0
    v_mfma_f32_16x16x32_bf16 v[168:171], v[196:199], v[52:55], v[168:171]
    v_mfma_f32_16x16x32_bf16 v[172:175], v[200:203], v[56:59], 0
    v_mfma_f32_16x16x32_bf16 v[172:175], v[204:207], v[60:63], v[172:175]
    v_mfma_f32_16x16x32_bf16 v[176:179], v[200:203], v[64:67], 0
    v_mfma_f32_16x16x32_bf16 v[176:179], v[204:207], v[68:71], v[176:179]
    v_mfma_f32_16x16x32_bf16 v[180:183], v[200:203], v[72:75], 0
    v_mfma_f32_16x16x32_bf16 v[180:183], v[204:207], v[76:79], v[180:183]
    v_lshl_or_b32 v128, v129, 16, v128
    v_lshl_or_b32 v129, v131, 16, v130
    s_mul_i32 s50, s48, 5120
    s_add_u32 s50, s50, 2048
    s_mov_b64 exec, s[62:63]
    buffer_store_dwordx2 v[128:129], v5, s[28:31], s50 offen sc1
    s_mov_b64 exec, -1
    v_lshl_or_b32 v132, v133, 16, v132
    v_lshl_or_b32 v133, v135, 16, v134
    s_mul_i32 s50, s48, 5120
    s_add_u32 s50, s50, 3072
    buffer_store_dwordx2 v[132:133], v5, s[28:31], s50 offen sc1
    s_waitcnt lgkmcnt(12)
    v_lshl_or_b32 v136, v137, 16, v136
    v_lshl_or_b32 v137, v139, 16, v138
    s_mul_i32 s50, s48, 5120
    s_add_u32 s50, s50, 4096
    s_mov_b64 exec, s[64:65]
    buffer_store_dwordx2 v[136:137], v5, s[28:31], s50 offen sc1
    s_mov_b64 exec, -1
    v_cvt_pk_bf16_f32 v160, v160, v161
    v_cvt_pk_bf16_f32 v161, v162, v163
    s_mul_i32 s50, s48, 5120
    s_add_u32 s50, s50, 0
    buffer_store_dwordx2 v[160:161], v5, s[28:31], s50 offen sc1
    v_cvt_pk_bf16_f32 v164, v164, v165
    v_cvt_pk_bf16_f32 v165, v166, v167
    s_mul_i32 s50, s48, 5120
    s_add_u32 s50, s50, 1024
    buffer_store_dwordx2 v[164:165], v5, s[28:31], s50 offen sc1
    v_cvt_pk_bf16_f32 v168, v168, v169
    v_cvt_pk_bf16_f32 v169, v170, v171
    s_mul_i32 s50, s48, 5120
    s_add_u32 s50, s50, 2048
    s_mov_b64 exec, s[58:59]
    buffer_store_dwordx2 v[168:169], v5, s[28:31], s50 offen sc1
    s_mov_b64 exec, -1
    v_cvt_pk_bf16_f32 v172, v172, v173
    v_cvt_pk_bf16_f32 v173, v174, v175
    s_mul_i32 s50, s48, 5120
    s_add_u32 s50, s50, 4096
    s_mov_b64 exec, s[60:61]
    buffer_store_dwordx2 v[172:173], v5, s[28:31], s50 offen sc1
    s_mov_b64 exec, -1
    v_cvt_pk_bf16_f32 v176, v176, v177
    v_cvt_pk_bf16_f32 v177, v178, v179
    s_mul_i32 s50, s48, 2048
    s_add_u32 s50, s50, 94208
    buffer_store_dwordx2 v[176:177], v5, s[28:31], s50 offen sc1
    v_cvt_pk_bf16_f32 v180, v180, v181
    v_cvt_pk_bf16_f32 v181, v182, v183
    s_mul_i32 s50, s48, 2048
    s_add_u32 s50, s50, 95232
    buffer_store_dwordx2 v[180:181], v5, s[28:31], s50 offen sc1
    s_nop 3
    v_mfma_f32_16x16x32_bf16 v[160:163], v[208:211], v[80:83], 0
    v_mfma_f32_16x16x32_bf16 v[160:163], v[212:215], v[84:87], v[160:163]
    v_mfma_f32_16x16x32_bf16 v[164:167], v[208:211], v[88:91], 0
    v_mfma_f32_16x16x32_bf16 v[164:167], v[212:215], v[92:95], v[164:167]
    v_mfma_f32_16x16x32_bf16 v[168:171], v[208:211], v[96:99], 0
    v_mfma_f32_16x16x32_bf16 v[168:171], v[212:215], v[100:103], v[168:171]
    v_mfma_f32_16x16x32_bf16 v[172:175], v[216:219], v[104:107], 0
    v_mfma_f32_16x16x32_bf16 v[172:175], v[220:223], v[108:111], v[172:175]
    v_mfma_f32_16x16x32_bf16 v[176:179], v[216:219], v[112:115], 0
    v_mfma_f32_16x16x32_bf16 v[176:179], v[220:223], v[116:119], v[176:179]
    v_mfma_f32_16x16x32_bf16 v[180:183], v[216:219], v[120:123], 0
    v_mfma_f32_16x16x32_bf16 v[180:183], v[220:223], v[124:127], v[180:183]
    s_waitcnt lgkmcnt(8)
    v_lshl_or_b32 v140, v141, 16, v140
    v_lshl_or_b32 v141, v143, 16, v142
    s_mul_i32 s50, s48, 5120
    s_add_u32 s50, s50, 133120
    s_mov_b64 exec, s[62:63]
    buffer_store_dwordx2 v[140:141], v5, s[28:31], s50 offen sc1
    s_mov_b64 exec, -1
    s_waitcnt lgkmcnt(4)
    v_lshl_or_b32 v144, v145, 16, v144
    v_lshl_or_b32 v145, v147, 16, v146
    s_mul_i32 s50, s48, 5120
    s_add_u32 s50, s50, 134144
    buffer_store_dwordx2 v[144:145], v5, s[28:31], s50 offen sc1
    s_waitcnt lgkmcnt(0)
    v_lshl_or_b32 v148, v149, 16, v148
    v_lshl_or_b32 v149, v151, 16, v150
    s_mul_i32 s50, s48, 5120
    s_add_u32 s50, s50, 135168
    s_mov_b64 exec, s[64:65]
    buffer_store_dwordx2 v[148:149], v5, s[28:31], s50 offen sc1
    s_mov_b64 exec, -1
    v_cvt_pk_bf16_f32 v160, v160, v161
    v_cvt_pk_bf16_f32 v161, v162, v163
    s_mul_i32 s50, s48, 5120
    s_add_u32 s50, s50, 131072
    buffer_store_dwordx2 v[160:161], v5, s[28:31], s50 offen sc1
    v_cvt_pk_bf16_f32 v164, v164, v165
    v_cvt_pk_bf16_f32 v165, v166, v167
    s_mul_i32 s50, s48, 5120
    s_add_u32 s50, s50, 132096
    buffer_store_dwordx2 v[164:165], v5, s[28:31], s50 offen sc1
    v_cvt_pk_bf16_f32 v168, v168, v169
    v_cvt_pk_bf16_f32 v169, v170, v171
    s_mul_i32 s50, s48, 5120
    s_add_u32 s50, s50, 133120
    s_mov_b64 exec, s[58:59]
    buffer_store_dwordx2 v[168:169], v5, s[28:31], s50 offen sc1
    s_mov_b64 exec, -1
    v_cvt_pk_bf16_f32 v172, v172, v173
    v_cvt_pk_bf16_f32 v173, v174, v175
    s_mul_i32 s50, s48, 5120
    s_add_u32 s50, s50, 135168
    s_mov_b64 exec, s[60:61]
    buffer_store_dwordx2 v[172:173], v5, s[28:31], s50 offen sc1
    s_mov_b64 exec, -1
    v_cvt_pk_bf16_f32 v176, v176, v177
    v_cvt_pk_bf16_f32 v177, v178, v179
    s_mul_i32 s50, s48, 2048
    s_add_u32 s50, s50, 225280
    buffer_store_dwordx2 v[176:177], v5, s[28:31], s50 offen sc1
    v_cvt_pk_bf16_f32 v180, v180, v181
    v_cvt_pk_bf16_f32 v181, v182, v183
    s_mul_i32 s50, s48, 2048
    s_add_u32 s50, s50, 226304
    buffer_store_dwordx2 v[180:181], v5, s[28:31], s50 offen sc1
    s_nop 3
    s_branch prep_wflag
prep_wb:
    s_nop 3
    v_mul_u32_u24 v22, 18, v16
    v_lshl_add_u32 v22, v17, 3, v22
    v_add_u32 v22, v22, v18
    v_lshl_add_u32 v22, v22, 1, v4
    v_lshl_add_u32 v23, v1, 1, v4
    v_lshrrev_b32 v24, 2, v1
    v_min_u32 v24, 2, v24
    v_mul_u32_u24 v24, 288, v24
    v_bfe_u32 v25, v1, 1, 1
    v_mul_u32_u24 v25, 18, v25
    v_add_u32 v24, v24, v25
    v_and_b32 v25, 1, v1
    v_add3_u32 v24, v24, v25, 16
    v_lshl_add_u32 v24, v24, 1, v4
    s_waitcnt vmcnt(0)
    s_barrier
    s_barrier
    ds_read_u16 v32, v22 offset:0
    ds_read_u16 v33, v22 offset:1728
    ds_read_u16 v34, v22 offset:3456
    ds_read_u16 v35, v22 offset:5184
    ds_read_u16 v36, v22 offset:8
    ds_read_u16 v37, v22 offset:1736
    ds_read_u16 v38, v22 offset:3464
    ds_read_u16 v39, v22 offset:5192
    ds_read_u16 v40, v22 offset:576
    ds_read_u16 v41, v22 offset:2304
    ds_read_u16 v42, v22 offset:4032
    ds_read_u16 v43, v22 offset:5760
    s_waitcnt lgkmcnt(8)
    v_lshl_or_b32 v32, v33, 16, v32
    v_lshl_or_b32 v33, v35, 16, v34
    s_mul_i32 s50, s48, 7168
    s_add_u32 s50, s50, 0
    buffer_store_dwordx2 v[32:33], v5, s[28:31], s50 offen sc1
    ds_read_u16 v44, v22 offset:584
    ds_read_u16 v45, v22 offset:2312
    ds_read_u16 v46, v22 offset:4040
    ds_read_u16 v47, v22 offset:5768
    s_waitcnt lgkmcnt(8)
    v_lshl_or_b32 v36, v37, 16, v36
    v_lshl_or_b32 v37, v39, 16, v38
    s_mul_i32 s50, s48, 7168
    s_add_u32 s50, s50, 1024
    buffer_store_dwordx2 v[36:37], v5, s[28:31], s50 offen sc1
    ds_read_u16 v48, v23 offset:1152
    ds_read_u16 v49, v23 offset:2880
    ds_read_u16 v50, v23 offset:4608
    ds_read_u16 v51, v23 offset:6336
    s_waitcnt lgkmcnt(8)
    v_lshl_or_b32 v40, v41, 16, v40
    v_lshl_or_b32 v41, v43, 16, v42
    s_mul_i32 s50, s48, 7168
    s_add_u32 s50, s50, 2048
    buffer_store_dwordx2 v[40:41], v5, s[28:31], s50 offen sc1
    ds_read_u16 v52, v23 offset:1188
    ds_read_u16 v53, v23 offset:2916
    ds_read_u16 v54, v23 offset:4644
    ds_read_u16 v55, v23 offset:6372
    s_waitcnt lgkmcnt(8)
    v_lshl_or_b32 v44, v45, 16, v44
    v_lshl_or_b32 v45, v47, 16, v46
    s_mul_i32 s50, s48, 7168
    s_add_u32 s50, s50, 3072
    buffer_store_dwordx2 v[44:45], v5, s[28:31], s50 offen sc1
    ds_read_u16 v56, v24 offset:0
    ds_read_u16 v57, v24 offset:1728
    ds_read_u16 v58, v24 offset:3456
    ds_read_u16 v59, v24 offset:5184
    s_waitcnt lgkmcnt(8)
    v_lshl_or_b32 v48, v49, 16, v48
    v_lshl_or_b32 v49, v51, 16, v50
    s_mul_i32 s50, s48, 7168
    s_add_u32 s50, s50, 4096
    buffer_store_dwordx2 v[48:49], v5, s[28:31], s50 offen sc1
    s_waitcnt lgkmcnt(4)
    v_lshl_or_b32 v52, v53, 16, v52
    v_lshl_or_b32 v53, v55, 16, v54
    s_mul_i32 s50, s48, 7168
    s_add_u32 s50, s50, 5120
    buffer_store_dwordx2 v[52:53], v5, s[28:31], s50 offen sc1
    s_waitcnt lgkmcnt(0)
    v_lshl_or_b32 v56, v57, 16, v56
    v_lshl_or_b32 v57, v59, 16, v58
    s_mul_i32 s50, s48, 7168
    s_add_u32 s50, s50, 6144
    buffer_store_dwordx2 v[56:57], v5, s[28:31], s50 offen sc1
    ds_read_u16 v60, v22 offset:72
    ds_read_u16 v61, v22 offset:1800
    ds_read_u16 v62, v22 offset:3528
    ds_read_u16 v63, v22 offset:5256
    ds_read_u16 v64, v22 offset:80
    ds_read_u16 v65, v22 offset:1808
    ds_read_u16 v66, v22 offset:3536
    ds_read_u16 v67, v22 offset:5264
    ds_read_u16 v68, v22 offset:648
    ds_read_u16 v69, v22 offset:2376
    ds_read_u16 v70, v22 offset:4104
    ds_read_u16 v71, v22 offset:5832
    s_waitcnt lgkmcnt(8)
    v_lshl_or_b32 v60, v61, 16, v60
    v_lshl_or_b32 v61, v63, 16, v62
    s_mul_i32 s50, s48, 7168
    s_add_u32 s50, s50, 131072
    buffer_store_dwordx2 v[60:61], v5, s[28:31], s50 offen sc1
    ds_read_u16 v72, v22 offset:656
    ds_read_u16 v73, v22 offset:2384
    ds_read_u16 v74, v22 offset:4112
    ds_read_u16 v75, v22 offset:5840
    s_waitcnt lgkmcnt(8)
    v_lshl_or_b32 v64, v65, 16, v64
    v_lshl_or_b32 v65, v67, 16, v66
    s_mul_i32 s50, s48, 7168
    s_add_u32 s50, s50, 132096
    buffer_store_dwordx2 v[64:65], v5, s[28:31], s50 offen sc1
    ds_read_u16 v76, v23 offset:1224
    ds_read_u16 v77, v23 offset:2952
    ds_read_u16 v78, v23 offset:4680
    ds_read_u16 v79, v23 offset:6408
    s_waitcnt lgkmcnt(8)
    v_lshl_or_b32 v68, v69, 16, v68
    v_lshl_or_b32 v69, v71, 16, v70
    s_mul_i32 s50, s48, 7168
    s_add_u32 s50, s50, 133120
    buffer_store_dwordx2 v[68:69], v5, s[28:31], s50 offen sc1
    ds_read_u16 v80, v23 offset:1260
    ds_read_u16 v81, v23 offset:2988
    ds_read_u16 v82, v23 offset:4716
    ds_read_u16 v83, v23 offset:6444
    s_waitcnt lgkmcnt(8)
    v_lshl_or_b32 v72, v73, 16, v72
    v_lshl_or_b32 v73, v75, 16, v74
    s_mul_i32 s50, s48, 7168
    s_add_u32 s50, s50, 134144
    buffer_store_dwordx2 v[72:73], v5, s[28:31], s50 offen sc1
    ds_read_u16 v84, v24 offset:72
    ds_read_u16 v85, v24 offset:1800
    ds_read_u16 v86, v24 offset:3528
    ds_read_u16 v87, v24 offset:5256
    s_waitcnt lgkmcnt(8)
    v_lshl_or_b32 v76, v77, 16, v76
    v_lshl_or_b32 v77, v79, 16, v78
    s_mul_i32 s50, s48, 7168
    s_add_u32 s50, s50, 135168
    buffer_store_dwordx2 v[76:77], v5, s[28:31], s50 offen sc1
    s_waitcnt lgkmcnt(4)
    v_lshl_or_b32 v80, v81, 16, v80
    v_lshl_or_b32 v81, v83, 16, v82
    s_mul_i32 s50, s48, 7168
    s_add_u32 s50, s50, 136192
    buffer_store_dwordx2 v[80:81], v5, s[28:31], s50 offen sc1
    s_waitcnt lgkmcnt(0)
    v_lshl_or_b32 v84, v85, 16, v84
    v_lshl_or_b32 v85, v87, 16, v86
    s_mul_i32 s50, s48, 7168
    s_add_u32 s50, s50, 137216
    buffer_store_dwordx2 v[84:85], v5, s[28:31], s50 offen sc1
prep_wflag:
    s_nop 3
    s_cmp_eq_u32 s40, 1
    s_mov_b32 s97, 135168
    s_cselect_b32 s97, 143360, s97
    s_lshl_b32 s45, s44, 8
    s_add_u32 s97, s97, s45
    s_lshl_b32 s45, s41, 2
    s_add_u32 s97, s97, s45
    s_mov_b32 s96, 3
    s_branch prep_x
prep_other:
    s_nop 1
    s_cmp_ge_u32 s98, 216
    s_cbranch_scc1 prep_c
    s_sub_u32 s3, s98, 144
    s_cmp_ge_u32 s3, 36
    s_cselect_b32 s40, 1, 0
    s_cselect_b32 s41, 36, 0
    s_cselect_b32 s24, s16, s10
    s_cselect_b32 s25, s17, s11
    s_mov_b32 s42, 2097152
    s_cselect_b32 s42, 5029888, s42
    s_mov_b32 s26, 663552
    s_mov_b32 s27, 0x00020000
    s_sub_u32 s41, s3, s41
    s_add_u32 s28, s22, s42
    s_addc_u32 s29, s23, 0
    s_mov_b32 s30, 688128
    s_mov_b32 s31, 0x00020000
    s_mul_i32 s43, s41, 20736
    s_sub_u32 s44, s41, 32
    s_mul_i32 s44, s44, 165888
    s_cmp_ge_u32 s41, 32
    s_cselect_b32 s43, s44, s43
    s_cselect_b32 s45, 2, 0
    s_add_u32 s45, s45, s40
    s_mul_i32 s46, s99, 4608
    s_mov_b32 s52, 0
    s_cmp_eq_u32 s45, 1
    s_cselect_b32 s52, 0, s52
    s_cmp_eq_u32 s45, 2
    s_cselect_b32 s52, 9216, s52
    s_cmp_eq_u32 s45, 3
    s_cselect_b32 s52, 18432, s52
    s_mov_b32 s53, 4608
    s_cmp_eq_u32 s45, 1
    s_cselect_b32 s53, 9216, s53
    s_cmp_eq_u32 s45, 2
    s_cselect_b32 s53, 50688, s53
    s_cmp_eq_u32 s45, 3
    s_cselect_b32 s53, 59904, s53
    s_mov_b32 s54, 10368
    s_cmp_eq_u32 s45, 1
    s_cselect_b32 s54, 4608, s54
    s_cmp_eq_u32 s45, 2
    s_cselect_b32 s54, 92160, s54
    s_cmp_eq_u32 s45, 3
    s_cselect_b32 s54, 101376, s54
    s_mov_b32 s55, 14976
    s_cmp_eq_u32 s45, 1
    s_cselect_b32 s55, 13824, s55
    s_cmp_eq_u32 s45, 2
    s_cselect_b32 s55, 133632, s55
    s_cmp_eq_u32 s45, 3
    s_cselect_b32 s55, 142848, s55
    s_mov_b32 s47, s52
    s_cmp_eq_u32 s99, 1
    s_cselect_b32 s47, s53, s47
    s_cmp_eq_u32 s99, 2
    s_cselect_b32 s47, s54, s47
    s_cmp_eq_u32 s99, 3
    s_cselect_b32 s47, s55, s47
    s_add_u32 s47, s47, s43
    s_add_u32 s48, s46, 0
    s_mov_b32 m0, s48
    s_nop 0
    buffer_load_dwordx4 v3, s[24:27], s47 offen lds
    s_mov_b64 exec, 0xff
    buffer_load_dwordx4 v3, s[24:27], s47 offen offset:1024 lds
    s_mov_b64 exec, -1
    s_mov_b32 s52, 1152
    s_cmp_eq_u32 s45, 1
    s_cselect_b32 s52, 1152, s52
    s_cmp_eq_u32 s45, 2
    s_cselect_b32 s52, 19584, s52
    s_cmp_eq_u32 s45, 3
    s_cselect_b32 s52, 19584, s52
    s_mov_b32 s53, 5760
    s_cmp_eq_u32 s45, 1
    s_cselect_b32 s53, 10368, s53
    s_cmp_eq_u32 s45, 2
    s_cselect_b32 s53, 61056, s53
    s_cmp_eq_u32 s45, 3
    s_cselect_b32 s53, 61056, s53
    s_mov_b32 s54, 11520
    s_cmp_eq_u32 s45, 1
    s_cselect_b32 s54, 5760, s54
    s_cmp_eq_u32 s45, 2
    s_cselect_b32 s54, 102528, s54
    s_cmp_eq_u32 s45, 3
    s_cselect_b32 s54, 102528, s54
    s_mov_b32 s55, 16128
    s_cmp_eq_u32 s45, 1
    s_cselect_b32 s55, 14976, s55
    s_cmp_eq_u32 s45, 2
    s_cselect_b32 s55, 144000, s55
    s_cmp_eq_u32 s45, 3
    s_cselect_b32 s55, 144000, s55
    s_mov_b32 s47, s52
    s_cmp_eq_u32 s99, 1
    s_cselect_b32 s47, s53, s47
    s_cmp_eq_u32 s99, 2
    s_cselect_b32 s47, s54, s47
    s_cmp_eq_u32 s99, 3
    s_cselect_b32 s47, s55, s47
    s_add_u32 s47, s47, s43
    s_add_u32 s48, s46, 1152
    s_mov_b32 m0, s48
    s_nop 0
    buffer_load_dwordx4 v3, s[24:27], s47 offen lds
    s_mov_b64 exec, 0xff
    buffer_load_dwordx4 v3, s[24:27], s47 offen offset:1024 lds
    s_mov_b64 exec, -1
    s_mov_b32 s52, 2304
    s_cmp_eq_u32 s45, 1
    s_cselect_b32 s52, 2304, s52
    s_cmp_eq_u32 s45, 2
    s_cselect_b32 s52, 29952, s52
    s_cmp_eq_u32 s45, 3
    s_cselect_b32 s52, 39168, s52
    s_mov_b32 s53, 6912
    s_cmp_eq_u32 s45, 1
    s_cselect_b32 s53, 11520, s53
    s_cmp_eq_u32 s45, 2
    s_cselect_b32 s53, 71424, s53
    s_cmp_eq_u32 s45, 3
    s_cselect_b32 s53, 80640, s53
    s_mov_b32 s54, 12672
    s_cmp_eq_u32 s45, 1
    s_cselect_b32 s54, 6912, s54
    s_cmp_eq_u32 s45, 2
    s_cselect_b32 s54, 112896, s54
    s_cmp_eq_u32 s45, 3
    s_cselect_b32 s54, 122112, s54
    s_mov_b32 s55, 17280
    s_cmp_eq_u32 s45, 1
    s_cselect_b32 s55, 16128, s55
    s_cmp_eq_u32 s45, 2
    s_cselect_b32 s55, 154368, s55
    s_cmp_eq_u32 s45, 3
    s_cselect_b32 s55, 163584, s55
    s_mov_b32 s47, s52
    s_cmp_eq_u32 s99, 1
    s_cselect_b32 s47, s53, s47
    s_cmp_eq_u32 s99, 2
    s_cselect_b32 s47, s54, s47
    s_cmp_eq_u32 s99, 3
    s_cselect_b32 s47, s55, s47
    s_add_u32 s47, s47, s43
    s_add_u32 s48, s46, 2304
    s_mov_b32 m0, s48
    s_nop 0
    buffer_load_dwordx4 v3, s[24:27], s47 offen lds
    s_mov_b64 exec, 0xff
    buffer_load_dwordx4 v3, s[24:27], s47 offen offset:1024 lds
    s_mov_b64 exec, -1
    s_mov_b32 s52, 3456
    s_cmp_eq_u32 s45, 1
    s_cselect_b32 s52, 3456, s52
    s_cmp_eq_u32 s45, 2
    s_cselect_b32 s52, 40320, s52
    s_cmp_eq_u32 s45, 3
    s_cselect_b32 s52, 40320, s52
    s_mov_b32 s53, 8064
    s_cmp_eq_u32 s45, 1
    s_cselect_b32 s53, 12672, s53
    s_cmp_eq_u32 s45, 2
    s_cselect_b32 s53, 81792, s53
    s_cmp_eq_u32 s45, 3
    s_cselect_b32 s53, 81792, s53
    s_mov_b32 s54, 13824
    s_cmp_eq_u32 s45, 1
    s_cselect_b32 s54, 8064, s54
    s_cmp_eq_u32 s45, 2
    s_cselect_b32 s54, 123264, s54
    s_cmp_eq_u32 s45, 3
    s_cselect_b32 s54, 123264, s54
    s_mov_b32 s55, 18432
    s_cmp_eq_u32 s45, 1
    s_cselect_b32 s55, 17280, s55
    s_cmp_eq_u32 s45, 2
    s_cselect_b32 s55, 164736, s55
    s_cmp_eq_u32 s45, 3
    s_cselect_b32 s55, 164736, s55
    s_mov_b32 s47, s52
    s_cmp_eq_u32 s99, 1
    s_cselect_b32 s47, s53, s47
    s_cmp_eq_u32 s99, 2
    s_cselect_b32 s47, s54, s47
    s_cmp_eq_u32 s99, 3
    s_cselect_b32 s47, s55, s47
    s_add_u32 s47, s47, s43
    s_add_u32 s48, s46, 3456
    s_mov_b32 m0, s48
    s_nop 0
    buffer_load_dwordx4 v3, s[24:27], s47 offen lds
    s_mov_b64 exec, 0xff
    buffer_load_dwordx4 v3, s[24:27], s47 offen offset:1024 lds
    s_mov_b64 exec, -1
    v_mul_u32_u24 v4, 4608, v2
    v_lshl_add_u32 v4, v1, 1, v4
    s_mul_i32 s46, s99, 288
    v_add_u32 v4, s46, v4
    s_lshr_b32 s48, s41, 1
    s_cmp_ge_u32 s48, 13
    s_cselect_b32 s49, 768, 0
    s_mul_i32 s48, s48, 2304
    s_add_u32 s48, s48, s49
    s_mul_i32 s49, s99, 172032
    s_add_u32 s48, s48, s49
    s_and_b32 s49, s41, 1
    s_lshl_b32 s51, s49, 7
    s_add_u32 s51, s51, s48
    s_lshl_b32 s49, s49, 9
    s_add_u32 s48, s48, s49
    v_lshrrev_b32 v20, 1, v2
    v_and_b32 v21, 1, v2
    v_lshlrev_b32 v5, 8, v20
    v_lshl_add_u32 v5, v1, 4, v5
    v_lshl_add_u32 v5, v21, 3, v5
    v_add_u32 v5, s48, v5
    v_lshlrev_b32 v6, 6, v20
    v_lshl_add_u32 v6, v1, 4, v6
    v_lshl_add_u32 v6, v21, 3, v6
    v_add_u32 v6, s51, v6
    v_mov_b32 v7, 0x7fff0000
    v_cmp_gt_u32 vcc, 4, v1
    s_nop 1
    v_cndmask_b32 v6, v7, v6, vcc
    s_waitcnt vmcnt(0)
    s_barrier
    ds_read_u16 v32, v4 offset:0
    ds_read_u16 v33, v4 offset:1152
    ds_read_u16 v34, v4 offset:2304
    ds_read_u16 v35, v4 offset:3456
    ds_read_u16 v36, v4 offset:32
    ds_read_u16 v37, v4 offset:1184
    ds_read_u16 v38, v4 offset:2336
    ds_read_u16 v39, v4 offset:3488
    ds_read_u16 v40, v4 offset:64
    ds_read_u16 v41, v4 offset:1216
    ds_read_u16 v42, v4 offset:2368
    ds_read_u16 v43, v4 offset:3520
    ds_read_u16 v44, v4 offset:72
    ds_read_u16 v45, v4 offset:1224
    ds_read_u16 v46, v4 offset:2376
    ds_read_u16 v47, v4 offset:3528
    s_waitcnt lgkmcnt(12)
    v_lshl_or_b32 v32, v33, 16, v32
    v_lshl_or_b32 v33, v35, 16, v34
    s_mov_b32 s50, 0
    buffer_store_dwordx2 v[32:33], v5, s[28:31], s50 offen offset:0 sc1
    ds_read_u16 v48, v4 offset:104
    ds_read_u16 v49, v4 offset:1256
    ds_read_u16 v50, v4 offset:2408
    ds_read_u16 v51, v4 offset:3560
    s_waitcnt lgkmcnt(12)
    v_lshl_or_b32 v36, v37, 16, v36
    v_lshl_or_b32 v37, v39, 16, v38
    buffer_store_dwordx2 v[36:37], v5, s[28:31], s50 offen offset:1024 sc1
    ds_read_u16 v52, v4 offset:136
    ds_read_u16 v53, v4 offset:1288
    ds_read_u16 v54, v4 offset:2440
    ds_read_u16 v55, v4 offset:3592
    s_waitcnt lgkmcnt(12)
    v_lshl_or_b32 v40, v41, 16, v40
    v_lshl_or_b32 v41, v43, 16, v42
    buffer_store_dwordx2 v[40:41], v6, s[28:31], s50 offen offset:2048 sc1
    ds_read_u16 v56, v4 offset:144
    ds_read_u16 v57, v4 offset:1296
    ds_read_u16 v58, v4 offset:2448
    ds_read_u16 v59, v4 offset:3600
    s_waitcnt lgkmcnt(12)
    v_lshl_or_b32 v44, v45, 16, v44
    v_lshl_or_b32 v45, v47, 16, v46
    s_mov_b32 s50, 43008
    buffer_store_dwordx2 v[44:45], v5, s[28:31], s50 offen offset:0 sc1
    ds_read_u16 v60, v4 offset:176
    ds_read_u16 v61, v4 offset:1328
    ds_read_u16 v62, v4 offset:2480
    ds_read_u16 v63, v4 offset:3632
    s_waitcnt lgkmcnt(12)
    v_lshl_or_b32 v48, v49, 16, v48
    v_lshl_or_b32 v49, v51, 16, v50
    buffer_store_dwordx2 v[48:49], v5, s[28:31], s50 offen offset:1024 sc1
    ds_read_u16 v64, v4 offset:208
    ds_read_u16 v65, v4 offset:1360
    ds_read_u16 v66, v4 offset:2512
    ds_read_u16 v67, v4 offset:3664
    s_waitcnt lgkmcnt(12)
    v_lshl_or_b32 v52, v53, 16, v52
    v_lshl_or_b32 v53, v55, 16, v54
    buffer_store_dwordx2 v[52:53], v6, s[28:31], s50 offen offset:2048 sc1
    ds_read_u16 v68, v4 offset:216
    ds_read_u16 v69, v4 offset:1368
    ds_read_u16 v70, v4 offset:2520
    ds_read_u16 v71, v4 offset:3672
    s_waitcnt lgkmcnt(12)
    v_lshl_or_b32 v56, v57, 16, v56
    v_lshl_or_b32 v57, v59, 16, v58
    s_mov_b32 s50, 86016
    buffer_store_dwordx2 v[56:57], v5, s[28:31], s50 offen offset:0 sc1
    ds_read_u16 v72, v4 offset:248
    ds_read_u16 v73, v4 offset:1400
    ds_read_u16 v74, v4 offset:2552
    ds_read_u16 v75, v4 offset:3704
    s_waitcnt lgkmcnt(12)
    v_lshl_or_b32 v60, v61, 16, v60
    v_lshl_or_b32 v61, v63, 16, v62
    buffer_store_dwordx2 v[60:61], v5, s[28:31], s50 offen offset:1024 sc1
    ds_read_u16 v76, v4 offset:280
    ds_read_u16 v77, v4 offset:1432
    ds_read_u16 v78, v4 offset:2584
    ds_read_u16 v79, v4 offset:3736
    s_waitcnt lgkmcnt(12)
    v_lshl_or_b32 v64, v65, 16, v64
    v_lshl_or_b32 v65, v67, 16, v66
    buffer_store_dwordx2 v[64:65], v6, s[28:31], s50 offen offset:2048 sc1
    s_waitcnt lgkmcnt(8)
    v_lshl_or_b32 v68, v69, 16, v68
    v_lshl_or_b32 v69, v71, 16, v70
    s_mov_b32 s50, 129024
    buffer_store_dwordx2 v[68:69], v5, s[28:31], s50 offen offset:0 sc1
    s_waitcnt lgkmcnt(4)
    v_lshl_or_b32 v72, v73, 16, v72
    v_lshl_or_b32 v73, v75, 16, v74
    buffer_store_dwordx2 v[72:73], v5, s[28:31], s50 offen offset:1024 sc1
    s_waitcnt lgkmcnt(0)
    v_lshl_or_b32 v76, v77, 16, v76
    v_lshl_or_b32 v77, v79, 16, v78
    buffer_store_dwordx2 v[76:77], v6, s[28:31], s50 offen offset:2048 sc1
    s_lshl_b32 s97, s3, 2
    s_lshl_b32 s46, s99, 9
    s_add_u32 s97, s97, s46
    s_add_u32 s97, s97, 147456
    s_branch prep_x
prep_c:
    s_nop 1
    s_cmp_lt_u32 s98, 248
    s_cbranch_scc1 prep_c2
    s_mul_i32 s3, s99, 10240
    s_getpc_b64 s[40:41]
prep_pc:
    s_add_u32 s40, s40, prep_done-prep_pc
    s_addc_u32 s41, s41, 0
    s_add_u32 s40, s40, s3
    s_addc_u32 s41, s41, 0
    v_mov_b32 v4, v3
    global_load_dwordx4 v[8:11], v4, s[40:41] offset:0
    global_load_dwordx4 v[12:15], v4, s[40:41] offset:1024
    global_load_dwordx4 v[16:19], v4, s[40:41] offset:2048
    global_load_dwordx4 v[20:23], v4, s[40:41] offset:3072
    v_add_u32 v4, 4096, v4
    global_load_dwordx4 v[24:27], v4, s[40:41] offset:0
    global_load_dwordx4 v[28:31], v4, s[40:41] offset:1024
    global_load_dwordx4 v[32:35], v4, s[40:41] offset:2048
    global_load_dwordx4 v[36:39], v4, s[40:41] offset:3072
    v_add_u32 v4, 4096, v4
    global_load_dwordx4 v[40:43], v4, s[40:41] offset:0
    global_load_dwordx4 v[44:47], v4, s[40:41] offset:1024
prep_c2:
    s_waitcnt vmcnt(0)
    s_barrier
prep_x:
    s_nop 1
    s_mov_b32 s95, -1
    s_cmp_lt_u32 s98, 128
    s_cbranch_scc1 prep_done
    s_add_u32 s28, s22, 6524928
    s_addc_u32 s29, s23, 0
    s_mov_b32 s30, 2359296
    s_mov_b32 s31, 0x00020000
    s_add_u32 s32, s22, 8884224
    s_addc_u32 s33, s23, 0
    s_mov_b32 s34, 262144
    s_mov_b32 s35, 0x00020000
    s_add_u32 s36, s22, 5865472
    s_addc_u32 s37, s23, 0
    s_mov_b32 s38, 393216
    s_mov_b32 s39, 0x00020000
    v_mul_u32_u24 v4, 1152, v1
    v_lshl_add_u32 v4, v2, 4, v4
    s_lshl_b32 s40, s99, 6
    s_add_u32 s40, s40, 65536
    v_add_u32 v4, s40, v4
    ds_read_b128 v[32:35], v4 offset:0
    ds_read_b128 v[36:39], v4 offset:256
    ds_read_b128 v[40:43], v4 offset:512
    ds_read_b128 v[44:47], v4 offset:768
    ds_read_b128 v[48:51], v4 offset:1024
    v_mov_b32 v7, 1065369472
    v_mov_b32 v8, 0
    v_mov_b32 v9, 0
    v_mov_b32 v10, 0
    v_mov_b32 v11, 0
    v_mov_b32 v12, 0
    v_mov_b32 v13, 0
    v_mov_b32 v14, 0
    v_mov_b32 v15, 0
    s_lshl_b32 s41, s99, 10
    s_add_u32 s41, s41, s73
    s_cmp_lt_u32 s99, 2
    s_cselect_b64 s[42:43], -1, 0
    s_waitcnt lgkmcnt(4)
    v_dot2c_f32_bf16 v8, v32, v7
    v_dot2c_f32_bf16 v9, v32, v32
    v_dot2c_f32_bf16 v8, v33, v7
    v_dot2c_f32_bf16 v9, v33, v33
    v_dot2c_f32_bf16 v8, v34, v7
    v_dot2c_f32_bf16 v9, v34, v34
    v_dot2c_f32_bf16 v8, v35, v7
    v_dot2c_f32_bf16 v9, v35, v35
    buffer_store_dwordx4 v[32:35], v3, s[28:31], s41 offen sc1
    s_add_u32 s41, s41, 4096
    s_waitcnt lgkmcnt(3)
    v_dot2c_f32_bf16 v8, v36, v7
    v_dot2c_f32_bf16 v9, v36, v36
    v_dot2c_f32_bf16 v8, v37, v7
    v_dot2c_f32_bf16 v9, v37, v37
    v_dot2c_f32_bf16 v8, v38, v7
    v_dot2c_f32_bf16 v9, v38, v38
    v_dot2c_f32_bf16 v8, v39, v7
    v_dot2c_f32_bf16 v9, v39, v39
    buffer_store_dwordx4 v[36:39], v3, s[28:31], s41 offen sc1
    s_add_u32 s41, s41, 4096
    s_waitcnt lgkmcnt(2)
    v_dot2c_f32_bf16 v8, v40, v7
    v_dot2c_f32_bf16 v9, v40, v40
    v_dot2c_f32_bf16 v8, v41, v7
    v_dot2c_f32_bf16 v9, v41, v41
    v_dot2c_f32_bf16 v8, v42, v7
    v_dot2c_f32_bf16 v9, v42, v42
    v_dot2c_f32_bf16 v8, v43, v7
    v_dot2c_f32_bf16 v9, v43, v43
    buffer_store_dwordx4 v[40:43], v3, s[28:31], s41 offen sc1
    s_add_u32 s41, s41, 4096
    s_waitcnt lgkmcnt(1)
    v_dot2c_f32_bf16 v8, v44, v7
    v_dot2c_f32_bf16 v9, v44, v44
    v_dot2c_f32_bf16 v8, v45, v7
    v_dot2c_f32_bf16 v9, v45, v45
    v_dot2c_f32_bf16 v8, v46, v7
    v_dot2c_f32_bf16 v9, v46, v46
    v_dot2c_f32_bf16 v8, v47, v7
    v_dot2c_f32_bf16 v9, v47, v47
    buffer_store_dwordx4 v[44:47], v3, s[28:31], s41 offen sc1
    s_add_u32 s41, s41, 4096
    s_waitcnt lgkmcnt(0)
    s_mov_b64 exec, s[42:43]
    s_cbranch_execz prep_x5
    v_dot2c_f32_bf16 v8, v48, v7
    v_dot2c_f32_bf16 v9, v48, v48
    v_dot2c_f32_bf16 v8, v49, v7
    v_dot2c_f32_bf16 v9, v49, v49
    v_dot2c_f32_bf16 v8, v50, v7
    v_dot2c_f32_bf16 v9, v50, v50
    v_dot2c_f32_bf16 v8, v51, v7
    v_dot2c_f32_bf16 v9, v51, v51
    buffer_store_dwordx4 v[48:51], v3, s[28:31], s41 offen sc1
    s_add_u32 s41, s41, 4096
prep_x5:
    s_mov_b64 exec, -1
    s_nop 3
    v_mov_b32 v16, v8
    v_mov_b32 v17, v9
    s_nop 0
    v_permlane16_swap_b32 v8, v16
    v_permlane16_swap_b32 v9, v17
    v_add_f32 v8, v8, v16
    v_add_f32 v9, v9, v17
    v_mov_b32 v16, v8
    v_mov_b32 v17, v9
    s_nop 0
    v_permlane32_swap_b32 v8, v16
    v_permlane32_swap_b32 v9, v17
    v_add_f32 v8, v8, v16
    v_add_f32 v9, v9, v17
    s_lshl_b32 s42, s72, 11
    s_lshl_b32 s43, s99, 9
    s_add_u32 s42, s42, s43
    v_lshlrev_b32 v4, 3, v0
    v_cmp_eq_u32 vcc, 0, v2
    s_nop 1
    v_cndmask_b32 v8, 0, v8, vcc
    v_cndmask_b32 v9, 0, v9, vcc
    buffer_store_dwordx2 v[8:9], v4, s[32:35], s42 offen sc1
    s_mul_i32 s43, s72, 3072
    s_mul_i32 s44, s99, 768
    s_add_u32 s43, s43, s44
    s_mov_b32 exec_hi, 0xffff
    buffer_store_dwordx4 v[12:15], v3, s[36:39], s43 offen sc1
    s_mov_b64 exec, -1
    s_lshr_b32 s95, s72, 3
    s_lshl_b32 s95, s95, 8
    s_and_b32 s43, s72, 7
    s_lshl_b32 s43, s43, 4
    s_add_u32 s95, s95, s43
    s_lshl_b32 s43, s99, 2
    s_add_u32 s95, s95, s43
    s_add_u32 s95, s95, 139264
prep_done:
    s_nop 3
    s_add_u32 s48, s22, 6258688
    s_addc_u32 s49, s23, 0
    s_mov_b32 s50, 266240
    s_mov_b32 s51, 0x00020000
    s_waitcnt vmcnt(0)
    v_mov_b32 v6, 163836
    s_cmp_lg_u32 s99, 0
    s_cbranch_scc1 mega_non2
    v_readfirstlane_b32 s93, v250
    s_nop 0
    s_cmp_eq_u32 s93, 0
    s_cselect_b32 s93, s92, s93
    v_mov_b32 v5, s93
    ds_write_b32 v6, v5
    s_waitcnt lgkmcnt(0)
mega_non2:
    s_barrier
    ds_read_b32 v5, v6
    s_waitcnt lgkmcnt(0)
    v_readfirstlane_b32 s2, v5
    s_cmp_lt_i32 s97, 0
    s_cbranch_scc1 prep_nosig
    v_lshlrev_b32 v6, 8, v0
    s_mov_b32 exec_lo, s96
    s_mov_b32 exec_hi, 0
    buffer_store_dword v5, v6, s[48:51], s97 offen sc1
    s_mov_b64 exec, -1
prep_nosig:
    s_cmp_lt_i32 s95, 0
    s_cbranch_scc1 prep_nosig2
    s_mov_b64 exec, 1
    buffer_store_dword v5, off, s[48:51], s95 sc1
    s_mov_b64 exec, -1
prep_nosig2:
    s_mov_b32 s40, s99
    v_mov_b32 v1, v0
    v_lshrrev_b32 v2, 4, v1
    v_and_b32 v3, 15, v1
    v_lshlrev_b32 v4, 4, v1
    v_add_u32 v7, 0x10000, v4
    v_add_u32 v6, 0x20000, v4
    s_and_b32 s61, s98, 7
    s_lshr_b32 s62, s98, 3
    s_lshl_b32 s41, s61, 1
    s_lshr_b32 s46, s62, 4
    s_add_u32 s41, s41, s46
    s_and_b32 s42, s62, 15
    s_lshl_b32 s43, s41, 3
    s_lshl_b32 s46, s40, 1
    s_add_u32 s43, s43, s46
    s_lshl_b32 s44, s40, 10
    s_movk_i32 s57, 4096
    s_movk_i32 s58, 8192
    s_movk_i32 s59, 12288
    s_movk_i32 s60, 16384
    s_mov_b32 s3, 0
    s_mov_b32 s45, 0
    s_mov_b32 s56, 0
    v_lshrrev_b32 v40, 1, v2
    v_and_b32 v41, 1, v2
    v_mov_b32 v49, 0x7fff0000
    v_lshlrev_b32 v8, 3, v3
    v_lshl_add_u32 v8, v2, 10, v8
    v_accvgpr_write_b32 a200, v8
    v_and_b32 v12, 31, v1
    v_lshlrev_b32 v13, 7, v12
    s_lshl_b32 s62, s42, 10
    s_add_u32 s62, s62, 9146368
    v_add_u32 v15, s62, v13
    s_lshr_b32 s62, s42, 1
    s_lshl_b32 s62, s62, 8
    s_add_u32 s62, s62, 9161728
    v_add_u32 v14, s62, v13
    v_cmp_lt_u32 vcc, 7, v12
    s_nop 1
    v_cndmask_b32 v15, v15, v14, vcc
    s_mul_i32 s62, s42, 36
    s_lshr_b32 s62, s62, 3
    s_lshl_b32 s62, s62, 8
    s_add_u32 s62, s62, 11504384
    v_add_u32 v14, s62, v13
    v_cmp_lt_u32 vcc, 9, v12
    s_nop 1
    v_cndmask_b32 v15, v15, v14, vcc
    v_lshrrev_b32 v16, 5, v1
    v_add_u32 v16, s43, v16
    v_mul_u32_u24 v14, 18432, v16
    v_add_u32 v15, v15, v14
    s_lshl_b32 s63, s42, 7
    s_add_u32 s62, s63, 13864960
    v_lshlrev_b32 v14, 11, v16
    v_add_u32 v14, s62, v14
    v_cmp_lt_u32 vcc, 21, v12
    s_nop 1
    v_cndmask_b32 v15, v15, v14, vcc
    v_accvgpr_write_b32 a201, v15
    s_mul_i32 s61, s40, 5120
    v_mul_u32_u24 v42, 20480, v40
    v_mul_u32_u24 v43, 160, v3
    v_add3_u32 v42, v42, v43, s61
    v_lshl_add_u32 v43, v41, 5, v42
    v_accvgpr_write_b32 a202, v43
    v_mul_u32_u24 v44, 48, v41
    v_add_u32 v42, v42, v44
    v_accvgpr_write_b32 a203, v42
    v_lshlrev_b32 v27, 4, v2
    v_accvgpr_write_b32 a204, v27
    v_add_u32 v27, 162816, v27
    v_accvgpr_write_b32 a205, v27
    s_lshr_b32 s78, s40, 1
    s_and_b32 s79, s40, 1
    s_mul_i32 s61, s78, 20480
    v_lshrrev_b32 v45, 2, v3
    v_lshl_add_u32 v45, v2, 2, v45
    v_mul_u32_u24 v45, 160, v45
    v_and_b32 v46, 3, v3
    v_lshl_add_u32 v45, v46, 3, v45
    v_add_u32 v46, s61, v45
    v_accvgpr_write_b32 a206, v46
    s_lshl_b32 s61, s79, 5
    v_add_u32 v45, s61, v46
    v_accvgpr_write_b32 a207, v45
    s_mul_i32 s61, s78, 6144
    s_mul_i32 s62, s79, 3072
    s_add_u32 s61, s61, s62
    v_mul_u32_u24 v47, 768, v2
    v_lshl_add_u32 v47, v3, 2, v47
    v_add_u32 v47, s61, v47
    s_sub_u32 s61, 9, s79
    v_lshlrev_b32 v48, 2, v2
    v_sub_u32 v48, s61, v48
    v_cmp_le_i32 vcc, 0, v48
    s_nop 1
    v_cndmask_b32 v28, v49, v47, vcc
    v_accvgpr_write_b32 a208, v28
    v_cmp_le_i32 vcc, 1, v48
    s_nop 1
    v_cndmask_b32 v28, v49, v47, vcc
    v_accvgpr_write_b32 a209, v28
    v_cmp_le_i32 vcc, 2, v48
    s_nop 1
    v_cndmask_b32 v28, v49, v47, vcc
    v_accvgpr_write_b32 a210, v28
    v_cmp_le_i32 vcc, 3, v48
    s_nop 1
    v_cndmask_b32 v28, v49, v47, vcc
    v_accvgpr_write_b32 a211, v28
    v_lshlrev_b32 v32, 4, v3
    v_lshl_add_u32 v32, v2, 1, v32
    v_accvgpr_write_b32 a212, v32
    s_lshl_b32 s61, s40, 2
    v_and_b32 v50, 3, v3
    v_add_u32 v50, s61, v50
    v_bfe_u32 v51, v3, 2, 1
    v_lshl_add_u32 v51, v51, 4, v50
    v_cmp_gt_u32 vcc, 9, v50
    s_nop 1
    v_cndmask_b32 v51, 9, v51, vcc
    v_mul_u32_u24 v51, 192, v51
    v_mul_u32_u24 v52, 6144, v40
    v_mul_u32_u24 v53, 96, v41
    v_add3_u32 v51, v51, v52, v53
    v_lshrrev_b32 v52, 3, v3
    v_cmp_eq_u32 vcc, v52, v40
    s_nop 1
    v_cndmask_b32 v51, v49, v51, vcc
    v_cmp_gt_u32 vcc, 10, v50
    s_nop 1
    v_cndmask_b32 v51, v49, v51, vcc
    v_accvgpr_write_b32 a213, v51
    v_cmp_eq_u32 vcc, 0, v41
    s_nop 1
    v_cndmask_b32 v52, 0, 1.0, vcc
    v_accvgpr_write_b32 a214, v52
    v_mul_u32_u24 v42, 29696, v40
    v_lshl_add_u32 v42, v41, 9, v42
    v_lshl_add_u32 v42, v3, 4, v42
    s_add_u32 s61, s44, 56320
    v_add_u32 v43, s61, v42
    v_accvgpr_write_b32 a215, v43
    v_lshlrev_b32 v42, 10, v40
    v_lshl_add_u32 v42, v41, 9, v42
    v_lshl_add_u32 v42, v3, 4, v42
    s_mul_i32 s62, s40, 3072
    s_add_u32 s62, s62, 106496
    v_add_u32 v42, s62, v42
    v_accvgpr_write_b32 a216, v42
    s_lshl_b32 s61, s40, 7
    s_add_u32 s61, s61, 47104
    s_add_u32 s62, s62, 2048
    v_cmp_eq_u32 vcc, 0, v2
    s_add_u32 s63, s61, 0
    v_mov_b32 v42, s63
    s_add_u32 s63, s62, 0
    v_mov_b32 v43, s63
    v_cndmask_b32 v42, v42, v43, vcc
    v_lshl_add_u32 v42, v3, 2, v42
    v_accvgpr_write_b32 a217, v42
    s_add_u32 s63, s61, 29696
    v_mov_b32 v42, s63
    s_add_u32 s63, s62, 128
    v_mov_b32 v43, s63
    v_cndmask_b32 v42, v42, v43, vcc
    v_lshl_add_u32 v42, v3, 2, v42
    v_accvgpr_write_b32 a218, v42
    s_mul_i32 s61, s40, 1280
    s_add_u32 s61, s61, 70656
    v_mul_u32_u24 v44, 320, v41
    v_lshl_add_u32 v44, v40, 3, v44
    v_lshl_add_u32 v44, v3, 4, v44
    v_add_u32 v44, s61, v44
    v_accvgpr_write_b32 a219, v44
    v_bfe_u32 v46, v3, 2, 1
    v_mul_u32_u24 v46, 320, v46
    v_lshrrev_b32 v47, 3, v3
    v_lshl_add_u32 v46, v47, 3, v46
    v_and_b32 v47, 3, v3
    v_lshl_add_u32 v46, v47, 1, v46
    v_add3_u32 v46, v46, s61, 64
    v_add_u32 v46, 192, v46
    v_accvgpr_write_b32 a220, v46
    v_lshrrev_b32 v46, 2, v1
    v_mul_u32_u24 v46, 29696, v46
    v_bfe_u32 v47, v1, 1, 1
    v_mul_u32_u24 v47, 320, v47
    v_add3_u32 v46, v46, v47, s61
    v_and_b32 v47, 1, v1
    v_lshl_add_u32 v46, v47, 4, v46
    v_add_u32 v46, 288, v46
    v_accvgpr_write_b32 a221, v46
    v_lshlrev_b32 v47, 2, v3
    v_accvgpr_write_b32 a222, v47
    v_add_u32 v47, 163328, v47
    v_accvgpr_write_b32 a223, v47
    s_mul_i32 s61, s42, 9
    v_add_u32 v8, s61, v2
    v_cmp_eq_u32 s[72:73], 0, v2
    v_add_u32 v9, 0, v8
    v_lshrrev_b32 v12, 1, v9
    v_lshlrev_b32 v12, 8, v12
    v_and_b32 v20, 1, v9
    v_lshl_add_u32 v12, v20, 3, v12
    v_lshl_add_u32 v12, v3, 4, v12
    v_mul_u32_u24 v20, 1152, v3
    v_lshl_add_u32 v9, v9, 3, v20
    v_accvgpr_write_b32 a224, v12
    v_accvgpr_write_b32 a225, v9
    v_add_u32 v9, 4, v8
    v_lshrrev_b32 v12, 1, v9
    v_lshlrev_b32 v12, 8, v12
    v_and_b32 v20, 1, v9
    v_lshl_add_u32 v12, v20, 3, v12
    v_lshl_add_u32 v12, v3, 4, v12
    v_mul_u32_u24 v20, 1152, v3
    v_lshl_add_u32 v9, v9, 3, v20
    v_accvgpr_write_b32 a226, v12
    v_accvgpr_write_b32 a227, v9
    v_add_u32 v9, 8, v8
    v_lshrrev_b32 v12, 1, v9
    v_lshlrev_b32 v12, 8, v12
    v_and_b32 v20, 1, v9
    v_lshl_add_u32 v12, v20, 3, v12
    v_lshl_add_u32 v12, v3, 4, v12
    v_mul_u32_u24 v20, 1152, v3
    v_lshl_add_u32 v9, v9, 3, v20
    v_cndmask_b32 v12, v49, v12, s[72:73]
    v_cndmask_b32 v9, v49, v9, s[72:73]
    v_accvgpr_write_b32 a228, v12
    v_accvgpr_write_b32 a229, v9
    v_lshlrev_b32 v15, 3, v3
    s_lshl_b32 s61, s42, 7
    v_add_u32 v15, s61, v15
    v_cndmask_b32 v15, v49, v15, s[72:73]
    v_accvgpr_write_b32 a230, v15
    v_lshrrev_b32 v63, 5, v1
    v_and_b32 v59, 31, v1
    s_sub_u32 s61, s41, 2
    v_add_u32 v60, s61, v1
    v_lshlrev_b32 v60, 6, v60
    v_max_i32 v60, 0, v60
    v_min_u32 v60, 0x7c0, v60
    v_accvgpr_write_b32 a231, v60
    v_lshlrev_b32 v61, 2, v59
    v_accvgpr_write_b32 a232, v61
    s_add_u32 s61, s44, 48128
    v_add_u32 v48, s61, v4
    v_accvgpr_write_b32 a233, v48
    s_lshl_b32 s61, s40, 7
    s_add_u32 s61, s61, 46080
    v_add_u32 v48, s61, v61
    v_accvgpr_write_b32 a234, v48
    v_min_u32 v50, 19, v59
    v_lshlrev_b32 v50, 4, v50
    v_mul_u32_u24 v51, 320, v63
    s_mul_i32 s61, s40, 1280
    s_add_u32 s61, s61, 60416
    v_add3_u32 v50, v50, v51, s61
    v_accvgpr_write_b32 a235, v50
    v_lshlrev_b32 v51, 2, v63
    v_sub_u32 v51, v59, v51
    v_accvgpr_write_b32 a236, v51
    v_mov_b32 v52, 0xffff
    v_mov_b32 v53, 0xffff0000
    v_cmp_le_i32 vcc, 0, v51
    s_nop 1
    v_cndmask_b32 v54, 0, v52, vcc
    v_cmp_le_i32 vcc, 1, v51
    s_nop 1
    v_cndmask_b32 v55, 0, v53, vcc
    v_or_b32 v54, v54, v55
    v_accvgpr_write_b32 a237, v54
    v_cmp_le_i32 vcc, 2, v51
    s_nop 1
    v_cndmask_b32 v54, 0, v52, vcc
    v_cmp_le_i32 vcc, 3, v51
    s_nop 1
    v_cndmask_b32 v55, 0, v53, vcc
    v_or_b32 v54, v54, v55
    v_accvgpr_write_b32 a238, v54
    v_cmp_le_i32 vcc, 8, v51
    s_nop 1
    v_cndmask_b32 v54, 0, v52, vcc
    v_cmp_le_i32 vcc, 9, v51
    s_nop 1
    v_cndmask_b32 v55, 0, v53, vcc
    v_or_b32 v54, v54, v55
    v_accvgpr_write_b32 a239, v54
    v_cmp_le_i32 vcc, 10, v51
    s_nop 1
    v_cndmask_b32 v54, 0, v52, vcc
    v_cmp_le_i32 vcc, 11, v51
    s_nop 1
    v_cndmask_b32 v55, 0, v53, vcc
    v_or_b32 v54, v54, v55
    v_accvgpr_write_b32 a240, v54
    v_cmp_le_i32 vcc, 16, v51
    s_nop 1
    v_cndmask_b32 v54, 0, v52, vcc
    v_cmp_le_i32 vcc, 17, v51
    s_nop 1
    v_cndmask_b32 v55, 0, v53, vcc
    v_or_b32 v54, v54, v55
    v_accvgpr_write_b32 a241, v54
    v_cmp_le_i32 vcc, 18, v51
    s_nop 1
    v_cndmask_b32 v54, 0, v52, vcc
    v_cmp_le_i32 vcc, 19, v51
    s_nop 1
    v_cndmask_b32 v55, 0, v53, vcc
    v_or_b32 v54, v54, v55
    v_accvgpr_write_b32 a242, v54
    v_cmp_le_i32 vcc, 24, v51
    s_nop 1
    v_cndmask_b32 v54, 0, v52, vcc
    v_cmp_le_i32 vcc, 25, v51
    s_nop 1
    v_cndmask_b32 v55, 0, v53, vcc
    v_or_b32 v54, v54, v55
    v_accvgpr_write_b32 a243, v54
    v_cmp_le_i32 vcc, 26, v51
    s_nop 1
    v_cndmask_b32 v54, 0, v52, vcc
    v_cmp_le_i32 vcc, 27, v51
    s_nop 1
    v_cndmask_b32 v55, 0, v53, vcc
    v_or_b32 v54, v54, v55
    v_accvgpr_write_b32 a244, v54
    v_lshrrev_b32 v55, 4, v59
    v_mul_u32_u24 v55, 18432, v55
    v_and_b32 v56, 15, v59
    v_lshl_add_u32 v55, v56, 4, v55
    s_lshl_b32 s61, s42, 10
    v_lshl_add_u32 v56, v63, 8, v55
    v_add_u32 v56, s61, v56
    v_accvgpr_write_b32 a245, v56
    s_lshr_b32 s61, s42, 3
    s_add_u32 s61, s61, 16
    s_lshl_b32 s61, s61, 10
    s_bfe_u32 s62, s42, 0x20001
    s_lshl_b32 s62, s62, 8
    s_add_u32 s61, s61, s62
    s_and_b32 s62, s42, 1
    s_lshl_b32 s62, s62, 3
    s_add_u32 s101, s61, s62
    v_add_u32 v55, s101, v55
    v_lshl_add_u32 v55, v63, 16, v55
    v_accvgpr_write_b32 a246, v55
    s_lshl_b32 s61, s41, 12
    s_sub_u32 s61, s61, 8192
    s_lshl_b32 s62, s40, 11
    s_add_u32 s61, s61, s62
    v_add_u32 v64, s61, v4
    v_accvgpr_write_b32 a247, v64
    s_lshl_b32 s61, s41, 9
    s_sub_u32 s61, s61, 1024
    v_add_u32 v64, s61, v4
    v_accvgpr_write_b32 a248, v64
    s_mul_i32 s61, s41, 5120
    s_sub_u32 s61, s61, 10240
    v_add_u32 v64, s61, v4
    v_accvgpr_write_b32 a249, v64
    s_and_b32 s61, s3, 1
    s_mul_i32 s62, s61, 2932736
    s_lshl_b32 s63, s42, 17
    s_add_u32 s62, s62, s63
    s_add_u32 s28, s22, s62
    s_addc_u32 s29, s23, 0
    s_mov_b32 s30, 131072
    s_mov_b32 s31, 0x00020000
    s_cmp_lg_u32 s40, 1
    s_cbranch_scc1 mega_noxt
    s_lshl_b32 s61, s41, 8
    s_lshl_b32 s62, s42, 2
    s_add_u32 s61, s61, s62
    s_add_u32 s61, s61, 65536
    s_getreg_b32 s62, hwreg(HW_REG_XCC_ID, 0, 4)
    s_add_u32 s62, s62, s2
    s_add_u32 s62, s62, 1
    v_mov_b32 v5, s62
    s_mov_b64 exec, 1
    buffer_store_dword v5, off, s[48:51], s61 sc1
    s_mov_b64 exec, -1
mega_noxt:
    v_lshlrev_b32 v8, 2, v1
    s_lshl_b32 s61, s42, 8
    s_add_u32 s61, s61, 135168
    s_mov_b32 s54, s61
    s_cmp_lg_u32 s40, 0
    s_cbranch_scc1 mega_kernel_nodp1
    s_mov_b32 s62, 0
    s_mov_b32 s14, 0xfff
    s_mov_b32 s15, 0x0
mega_kernel_dp2:
    buffer_load_dword v5, v8, s[48:51], s54 offen sc1
    s_add_u32 s62, s62, 1
    s_waitcnt vmcnt(0)
    v_cmp_ne_u32 vcc, s2, v5
    s_nop 0
    s_and_b64 vcc, vcc, s[14:15]
    s_cbranch_scc0 mega_kernel_nodp1
    s_cmp_lt_u32 s62, 262144
    s_sleep 2
    s_cbranch_scc1 mega_kernel_dp2
mega_kernel_nodp1:
    s_barrier
    s_cmp_eq_u32 s40, 0
    s_cbranch_scc1 mega_kernel_nopf3
    s_mul_i32 s52, s44, 4
    s_add_u32 s52, s52, -4096
    s_mov_b32 m0, s52
    s_nop 0
    buffer_load_dwordx4 v4, s[28:31], s52 offen offset:0 lds
    buffer_load_dwordx4 v4, s[28:31], s52 offen offset:1024 lds
    buffer_load_dwordx4 v4, s[28:31], s52 offen offset:2048 lds
    buffer_load_dwordx4 v4, s[28:31], s52 offen offset:3072 lds
    s_mul_i32 s52, s44, 4
    s_add_u32 s52, s52, 8192
    s_mov_b32 m0, s52
    s_nop 0
    buffer_load_dwordx4 v4, s[28:31], s52 offen offset:0 lds
    buffer_load_dwordx4 v4, s[28:31], s52 offen offset:1024 lds
    buffer_load_dwordx4 v4, s[28:31], s52 offen offset:2048 lds
    buffer_load_dwordx4 v4, s[28:31], s52 offen offset:3072 lds
    s_mul_i32 s52, s44, 2
    s_add_u32 s52, s52, 22528
    s_mov_b32 m0, s52
    s_nop 0
    buffer_load_dwordx4 v4, s[28:31], s52 offen offset:0 lds
    buffer_load_dwordx4 v4, s[28:31], s52 offen offset:1024 lds
    s_mul_i32 s52, s44, 4
    s_add_u32 s52, s52, 90112
    s_mov_b32 m0, s52
    s_nop 0
    buffer_load_dwordx4 v4, s[28:31], s52 offen offset:0 lds
    buffer_load_dwordx4 v4, s[28:31], s52 offen offset:1024 lds
    buffer_load_dwordx4 v4, s[28:31], s52 offen offset:2048 lds
    buffer_load_dwordx4 v4, s[28:31], s52 offen offset:3072 lds
mega_kernel_nopf3:
    s_nop 1
    s_cmp_lg_u32 s40, 0
    s_cbranch_scc1 mega_kernel_nodp4
    s_mov_b32 s62, 0
    s_mov_b32 s14, 0xfff000
    s_mov_b32 s15, 0x0
mega_kernel_dp5:
    buffer_load_dword v5, v8, s[48:51], s54 offen sc1
    s_add_u32 s62, s62, 1
    s_waitcnt vmcnt(0)
    v_cmp_ne_u32 vcc, s2, v5
    s_nop 0
    s_and_b64 vcc, vcc, s[14:15]
    s_cbranch_scc0 mega_kernel_nodp4
    s_cmp_lt_u32 s62, 262144
    s_sleep 2
    s_cbranch_scc1 mega_kernel_dp5
mega_kernel_nodp4:
    s_barrier
    s_cmp_eq_u32 s40, 0
    s_cbranch_scc1 mega_kernel_nopf6
    s_mul_i32 s52, s44, 4
    s_add_u32 s52, s52, 26624
    s_mov_b32 m0, s52
    s_nop 0
    buffer_load_dwordx4 v4, s[28:31], s52 offen offset:0 lds
    buffer_load_dwordx4 v4, s[28:31], s52 offen offset:1024 lds
    buffer_load_dwordx4 v4, s[28:31], s52 offen offset:2048 lds
    buffer_load_dwordx4 v4, s[28:31], s52 offen offset:3072 lds
    s_mul_i32 s52, s44, 4
    s_add_u32 s52, s52, 38912
    s_mov_b32 m0, s52
    s_nop 0
    buffer_load_dwordx4 v4, s[28:31], s52 offen offset:0 lds
    buffer_load_dwordx4 v4, s[28:31], s52 offen offset:1024 lds
    buffer_load_dwordx4 v4, s[28:31], s52 offen offset:2048 lds
    buffer_load_dwordx4 v4, s[28:31], s52 offen offset:3072 lds
    s_mul_i32 s52, s44, 2
    s_add_u32 s52, s52, 53248
    s_mov_b32 m0, s52
    s_nop 0
    buffer_load_dwordx4 v4, s[28:31], s52 offen offset:0 lds
    buffer_load_dwordx4 v4, s[28:31], s52 offen offset:1024 lds
    s_mul_i32 s52, s44, 4
    s_add_u32 s52, s52, 102400
    s_mov_b32 m0, s52
    s_nop 0
    buffer_load_dwordx4 v4, s[28:31], s52 offen offset:0 lds
    buffer_load_dwordx4 v4, s[28:31], s52 offen offset:1024 lds
    buffer_load_dwordx4 v4, s[28:31], s52 offen offset:2048 lds
    buffer_load_dwordx4 v4, s[28:31], s52 offen offset:3072 lds
mega_kernel_nopf6:
    s_nop 1
    s_cmp_lg_u32 s40, 0
    s_cbranch_scc1 mega_kernel_nodp7
    s_mov_b32 s62, 0
    s_mov_b32 s14, 0xff000000
    s_mov_b32 s15, 0xf
mega_kernel_dp8:
    buffer_load_dword v5, v8, s[48:51], s54 offen sc1
    s_add_u32 s62, s62, 1
    s_waitcnt vmcnt(0)
    v_cmp_ne_u32 vcc, s2, v5
    s_nop 0
    s_and_b64 vcc, vcc, s[14:15]
    s_cbranch_scc0 mega_kernel_nodp7
    s_cmp_lt_u32 s62, 262144
    s_sleep 2
    s_cbranch_scc1 mega_kernel_dp8
mega_kernel_nodp7:
    s_barrier
    s_cmp_eq_u32 s40, 0
    s_cbranch_scc1 mega_kernel_nopf9
    s_mul_i32 s52, s44, 4
    s_add_u32 s52, s52, 57344
    s_mov_b32 m0, s52
    s_nop 0
    buffer_load_dwordx4 v4, s[28:31], s52 offen offset:0 lds
    buffer_load_dwordx4 v4, s[28:31], s52 offen offset:1024 lds
    buffer_load_dwordx4 v4, s[28:31], s52 offen offset:2048 lds
    buffer_load_dwordx4 v4, s[28:31], s52 offen offset:3072 lds
    s_mul_i32 s52, s44, 4
    s_add_u32 s52, s52, 69632
    s_mov_b32 m0, s52
    s_nop 0
    buffer_load_dwordx4 v4, s[28:31], s52 offen offset:0 lds
    buffer_load_dwordx4 v4, s[28:31], s52 offen offset:1024 lds
    buffer_load_dwordx4 v4, s[28:31], s52 offen offset:2048 lds
    buffer_load_dwordx4 v4, s[28:31], s52 offen offset:3072 lds
    s_mul_i32 s52, s44, 2
    s_add_u32 s52, s52, 83968
    s_mov_b32 m0, s52
    s_nop 0
    buffer_load_dwordx4 v4, s[28:31], s52 offen offset:0 lds
    buffer_load_dwordx4 v4, s[28:31], s52 offen offset:1024 lds
    s_mul_i32 s52, s44, 4
    s_add_u32 s52, s52, 114688
    s_mov_b32 m0, s52
    s_nop 0
    buffer_load_dwordx4 v4, s[28:31], s52 offen offset:0 lds
    buffer_load_dwordx4 v4, s[28:31], s52 offen offset:1024 lds
    buffer_load_dwordx4 v4, s[28:31], s52 offen offset:2048 lds
    buffer_load_dwordx4 v4, s[28:31], s52 offen offset:3072 lds
mega_kernel_nopf9:
    s_nop 1
    s_waitcnt vmcnt(0)
    s_barrier
    v_mov_b32 v176, 0x3f803f80
    v_mov_b32 v177, 0x3f803f80
    v_mov_b32 v178, 0x3f803f80
    v_mov_b32 v179, 0x3f803f80
    s_add_u32 s61, s40, 4
    s_min_u32 s61, s61, 6
    s_lshl_b32 s62, s61, 10
    s_movk_i32 s63, 5120
    s_cmp_ge_u32 s61, 5
    s_cselect_b32 s52, 2048, s63
    s_cselect_b32 s53, 89088, 0
    s_add_u32 s62, s62, s53
    v_add_u32 v180, s44, v4
    v_add_u32 v181, s62, v4
    ds_read_b128 a[144:147], v180
    v_add_u32 v180, s63, v180
    ds_read_b128 a[148:151], v181
    v_add_u32 v181, s52, v181
    ds_read_b128 a[152:155], v180
    v_add_u32 v180, s63, v180
    ds_read_b128 a[156:159], v181
    v_add_u32 v181, s52, v181
    ds_read_b128 a[160:163], v180
    v_add_u32 v180, s63, v180
    ds_read_b128 a[164:167], v181
    v_add_u32 v181, s52, v181
    ds_read_b128 a[168:171], v180
    v_add_u32 v180, s63, v180
    ds_read_b128 a[172:175], v181
    v_add_u32 v181, s52, v181
    ds_read_b128 a[176:179], v180
    v_add_u32 v180, s63, v180
    ds_read_b128 a[180:183], v181
    v_add_u32 v181, s52, v181
    s_waitcnt lgkmcnt(8)
    v_mfma_f32_16x16x32_bf16 v[184:187], a[144:147], v[176:179], 0
    v_mfma_f32_16x16x32_bf16 v[188:191], a[148:151], v[176:179], 0
    ds_read_b128 a[184:187], v180
    v_add_u32 v180, s63, v180
    ds_read_b128 a[188:191], v181
    v_add_u32 v181, s52, v181
    s_waitcnt lgkmcnt(8)
    v_mfma_f32_16x16x32_bf16 v[184:187], a[152:155], v[176:179], v[184:187]
    v_mfma_f32_16x16x32_bf16 v[188:191], a[156:159], v[176:179], v[188:191]
    ds_read_b128 a[144:147], v180
    v_add_u32 v180, s63, v180
    ds_read_b128 a[148:151], v181
    v_add_u32 v181, s52, v181
    s_waitcnt lgkmcnt(8)
    v_mfma_f32_16x16x32_bf16 v[184:187], a[160:163], v[176:179], v[184:187]
    v_mfma_f32_16x16x32_bf16 v[188:191], a[164:167], v[176:179], v[188:191]
    ds_read_b128 a[152:155], v180
    v_add_u32 v180, s63, v180
    ds_read_b128 a[156:159], v181
    v_add_u32 v181, s52, v181
    s_waitcnt lgkmcnt(8)
    v_mfma_f32_16x16x32_bf16 v[184:187], a[168:171], v[176:179], v[184:187]
    v_mfma_f32_16x16x32_bf16 v[188:191], a[172:175], v[176:179], v[188:191]
    ds_read_b128 a[160:163], v180
    v_add_u32 v180, s63, v180
    ds_read_b128 a[164:167], v181
    v_add_u32 v181, s52, v181
    s_waitcnt lgkmcnt(8)
    v_mfma_f32_16x16x32_bf16 v[184:187], a[176:179], v[176:179], v[184:187]
    v_mfma_f32_16x16x32_bf16 v[188:191], a[180:183], v[176:179], v[188:191]
    ds_read_b128 a[168:171], v180
    v_add_u32 v180, s63, v180
    ds_read_b128 a[172:175], v181
    v_add_u32 v181, s52, v181
    s_waitcnt lgkmcnt(8)
    v_mfma_f32_16x16x32_bf16 v[184:187], a[184:187], v[176:179], v[184:187]
    v_mfma_f32_16x16x32_bf16 v[188:191], a[188:191], v[176:179], v[188:191]
    ds_read_b128 a[176:179], v180
    v_add_u32 v180, s63, v180
    ds_read_b128 a[180:183], v181
    v_add_u32 v181, s52, v181
    s_waitcnt lgkmcnt(8)
    v_mfma_f32_16x16x32_bf16 v[184:187], a[144:147], v[176:179], v[184:187]
    v_mfma_f32_16x16x32_bf16 v[188:191], a[148:151], v[176:179], v[188:191]
    ds_read_b128 a[184:187], v180
    v_add_u32 v180, s63, v180
    ds_read_b128 a[188:191], v181
    v_add_u32 v181, s52, v181
    s_waitcnt lgkmcnt(8)
    v_mfma_f32_16x16x32_bf16 v[184:187], a[152:155], v[176:179], v[184:187]
    v_mfma_f32_16x16x32_bf16 v[188:191], a[156:159], v[176:179], v[188:191]
    ds_read_b128 a[144:147], v180
    v_add_u32 v180, s63, v180
    ds_read_b128 a[148:151], v181
    v_add_u32 v181, s52, v181
    s_waitcnt lgkmcnt(8)
    v_mfma_f32_16x16x32_bf16 v[184:187], a[160:163], v[176:179], v[184:187]
    v_mfma_f32_16x16x32_bf16 v[188:191], a[164:167], v[176:179], v[188:191]
    ds_read_b128 a[152:155], v180
    v_add_u32 v180, s63, v180
    ds_read_b128 a[156:159], v181
    v_add_u32 v181, s52, v181
    s_waitcnt lgkmcnt(8)
    v_mfma_f32_16x16x32_bf16 v[184:187], a[168:171], v[176:179], v[184:187]
    v_mfma_f32_16x16x32_bf16 v[188:191], a[172:175], v[176:179], v[188:191]
    ds_read_b128 a[160:163], v180
    v_add_u32 v180, s63, v180
    ds_read_b128 a[164:167], v181
    v_add_u32 v181, s52, v181
    s_waitcnt lgkmcnt(8)
    v_mfma_f32_16x16x32_bf16 v[184:187], a[176:179], v[176:179], v[184:187]
    v_mfma_f32_16x16x32_bf16 v[188:191], a[180:183], v[176:179], v[188:191]
    ds_read_b128 a[168:171], v180
    v_add_u32 v180, s63, v180
    ds_read_b128 a[172:175], v181
    v_add_u32 v181, s52, v181
    s_waitcnt lgkmcnt(8)
    v_mfma_f32_16x16x32_bf16 v[184:187], a[184:187], v[176:179], v[184:187]
    v_mfma_f32_16x16x32_bf16 v[188:191], a[188:191], v[176:179], v[188:191]
    ds_read_b128 a[176:179], v180
    v_add_u32 v180, s63, v180
    ds_read_b128 a[180:183], v181
    v_add_u32 v181, s52, v181
    s_waitcnt lgkmcnt(8)
    v_mfma_f32_16x16x32_bf16 v[184:187], a[144:147], v[176:179], v[184:187]
    v_mfma_f32_16x16x32_bf16 v[188:191], a[148:151], v[176:179], v[188:191]
    ds_read_b128 a[184:187], v180
    v_add_u32 v180, s63, v180
    ds_read_b128 a[188:191], v181
    v_add_u32 v181, s52, v181
    s_waitcnt lgkmcnt(8)
    v_mfma_f32_16x16x32_bf16 v[184:187], a[152:155], v[176:179], v[184:187]
    v_mfma_f32_16x16x32_bf16 v[188:191], a[156:159], v[176:179], v[188:191]
    s_waitcnt lgkmcnt(6)
    v_mfma_f32_16x16x32_bf16 v[184:187], a[160:163], v[176:179], v[184:187]
    v_mfma_f32_16x16x32_bf16 v[188:191], a[164:167], v[176:179], v[188:191]
    s_waitcnt lgkmcnt(4)
    v_mfma_f32_16x16x32_bf16 v[184:187], a[168:171], v[176:179], v[184:187]
    v_mfma_f32_16x16x32_bf16 v[188:191], a[172:175], v[176:179], v[188:191]
    s_waitcnt lgkmcnt(2)
    v_mfma_f32_16x16x32_bf16 v[184:187], a[176:179], v[176:179], v[184:187]
    v_mfma_f32_16x16x32_bf16 v[188:191], a[180:183], v[176:179], v[188:191]
    s_waitcnt lgkmcnt(0)
    v_mfma_f32_16x16x32_bf16 v[184:187], a[184:187], v[176:179], v[184:187]
    v_mfma_f32_16x16x32_bf16 v[188:191], a[188:191], v[176:179], v[188:191]
    v_lshlrev_b32 v180, 4, v2
    s_lshl_b32 s62, s40, 6
    s_lshl_b32 s61, s61, 6
    v_add_u32 v180, 162816, v180
    v_add_u32 v181, s61, v180
    v_add_u32 v180, s62, v180
    s_nop 0
    ds_write_b128 v180, v[184:187]
    ds_write_b128 v181, v[188:191]
    s_lshr_b32 s61, s3, 1
    s_mul_i32 s62, s61, 196608
    s_mul_i32 s63, s42, 12288
    s_add_u32 s62, s62, s63
    s_add_u32 s64, s22, 5865472
    s_addc_u32 s65, s23, 0
    s_add_u32 s64, s64, s62
    s_addc_u32 s65, s65, 0
    s_mov_b32 s66, 12288
    s_mov_b32 s67, 0x00020000
    s_lshl_b32 s61, s61, 12
    s_lshl_b32 s62, s42, 8
    s_add_u32 s76, s61, s62
    s_add_u32 s76, s76, 57344
    s_lshl_b32 s62, s41, 2
    s_add_u32 s78, s76, s62
    s_lshl_b32 s77, s3, 13
    s_lshl_b32 s62, s41, 8
    s_add_u32 s77, s77, s62
    s_add_u32 s77, s77, 200704
    s_lshl_b32 s62, s42, 2
    s_add_u32 s77, s77, s62
    v_add_u32 v34, -2, v3
    v_cmp_lt_u32 s[72:73], 5, v34
    v_cmp_gt_u32 s[74:75], 10, v3
    s_mul_i32 s46, s43, 18432
    s_add_u32 s46, s46, s45
    s_add_u32 s24, s22, 6524928
    s_addc_u32 s25, s23, 0
    s_add_u32 s24, s24, s46
    s_addc_u32 s25, s25, 0
    s_mov_b32 s26, 36864
    s_mov_b32 s27, 0x00020000
    s_lshl_b32 s61, s43, 11
    s_add_u32 s61, s61, s45
    s_add_u32 s32, s22, 8884224
    s_addc_u32 s33, s23, 0
    s_add_u32 s32, s32, s61
    s_addc_u32 s33, s33, 0
    s_mov_b32 s34, 4096
    s_mov_b32 s35, 0x00020000
    s_add_u32 s8, s22, s45
    s_addc_u32 s9, s23, 0
    s_mov_b32 s10, 16486400
    s_mov_b32 s11, 0x00020000
    s_mul_i32 s61, s42, 43008
    s_and_b32 s62, s3, 1
    s_mul_i32 s62, s62, 2932736
    s_add_u32 s61, s61, s62
    s_add_u32 s80, s22, 2097152
    s_addc_u32 s81, s23, 0
    s_add_u32 s80, s80, s61
    s_addc_u32 s81, s81, 0
    s_mov_b32 s82, 43008
    s_mov_b32 s83, 0x00020000
    s_mov_b32 s84, 20480
    s_mov_b32 s85, 24576
    s_mov_b32 s86, 28672
    s_mov_b32 s87, 32768
    s_lshl_b32 s61, s3, 13
    s_lshl_b32 s62, s41, 8
    s_add_u32 s61, s61, s62
    s_sub_u32 s61, s61, 8192
    s_add_u32 s62, s62, 139264
    s_cmp_eq_u32 s3, 0
    s_cselect_b32 s14, -1, 0xffff
    s_mov_b32 s15, 0
    s_cselect_b32 s1, s62, s61
    v_accvgpr_read_b32 v14, a200
    v_accvgpr_read_b32 v15, a201
    v_accvgpr_read_b32 v32, a232
    v_accvgpr_read_b32 v33, a205
    s_add_u32 s68, s22, 9146368
    s_addc_u32 s69, s23, 0
    s_add_u32 s68, s68, s46
    s_addc_u32 s69, s69, 0
    s_mov_b32 s70, 36864
    s_mov_b32 s71, 0x00020000
    s_lshl_b32 s4, s42, 10
    s_add_u32 s5, s4, 18432
    s_add_u32 s6, s101, 18432
mega_a:
    s_nop 3
    s_cmp_lg_u32 s40, 0
    s_cbranch_scc1 mega_kernel_nopoll10
    s_mov_b32 s62, 0
mega_kernel_poll11:
    buffer_load_dword v5, v32, s[48:51], s1 offen sc1
    s_add_u32 s62, s62, 1
    s_waitcnt vmcnt(0)
    v_cmp_ne_u32 vcc, s2, v5
    s_nop 0
    s_and_b64 vcc, vcc, s[14:15]
    s_cbranch_scc0 mega_kernel_nopoll10
    s_cmp_lt_u32 s62, 262144
    s_sleep 1
    s_cbranch_scc1 mega_kernel_poll11
mega_kernel_nopoll10:
    s_waitcnt vmcnt(0) lgkmcnt(0)
    s_barrier
    buffer_load_dwordx4 a[0:3], v4, s[24:27], 0 offen offset:0 sc1
    buffer_load_dwordx4 a[72:75], v4, s[24:27], s60 offen offset:2048 sc1
    buffer_load_dwordx4 a[4:7], v4, s[24:27], 0 offen offset:1024 sc1
    buffer_load_dwordx4 a[76:79], v4, s[24:27], s60 offen offset:3072 sc1
    buffer_load_dwordx4 a[8:11], v4, s[24:27], 0 offen offset:2048 sc1
    buffer_load_dwordx4 a[80:83], v4, s[24:27], s84 offen offset:0 sc1
    buffer_load_dwordx4 a[12:15], v4, s[24:27], 0 offen offset:3072 sc1
    buffer_load_dwordx4 a[84:87], v4, s[24:27], s84 offen offset:1024 sc1
    buffer_load_dwordx4 a[16:19], v4, s[24:27], s57 offen offset:0 sc1
    buffer_load_dwordx4 a[88:91], v4, s[24:27], s84 offen offset:2048 sc1
    buffer_load_dwordx4 a[20:23], v4, s[24:27], s57 offen offset:1024 sc1
    buffer_load_dwordx4 a[92:95], v4, s[24:27], s84 offen offset:3072 sc1
    ds_read_b128 a[144:147], v4 offset:0
    ds_read_b128 a[148:151], v4 offset:1024
    ds_read_b128 a[152:155], v4 offset:2048
    ds_read_b128 a[156:159], v4 offset:3072
    ds_read_b128 a[160:163], v4 offset:4096
    s_waitcnt vmcnt(10)
    s_waitcnt lgkmcnt(3)
    v_mfma_f32_16x16x32_bf16 v[192:195], a[144:147], a[0:3], 0
    ds_read_b128 a[172:175], v4 offset:5120
    v_mfma_f32_16x16x32_bf16 v[224:227], a[144:147], a[72:75], 0
    buffer_load_dwordx4 a[24:27], v4, s[24:27], s57 offen offset:2048 sc1
    v_mfma_f32_16x16x32_bf16 v[196:199], a[148:151], a[0:3], 0
    ds_read_b128 a[176:179], v4 offset:6144
    v_mfma_f32_16x16x32_bf16 v[228:231], a[148:151], a[72:75], 0
    buffer_load_dwordx4 a[96:99], v4, s[24:27], s85 offen offset:0 sc1
    s_waitcnt lgkmcnt(3)
    v_mfma_f32_16x16x32_bf16 v[200:203], a[152:155], a[0:3], 0
    ds_read_b128 a[180:183], v4 offset:7168
    v_mfma_f32_16x16x32_bf16 v[232:235], a[152:155], a[72:75], 0
    buffer_load_dwordx2 v[16:17], v14, s[32:35], 0 offen offset:0 sc1
    v_mfma_f32_16x16x32_bf16 v[204:207], a[156:159], a[0:3], 0
    ds_read_b128 a[184:187], v4 offset:8192
    v_mfma_f32_16x16x32_bf16 v[236:239], a[156:159], a[72:75], 0
    buffer_load_dwordx2 v[18:19], v14, s[32:35], 0 offen offset:128 sc1
    s_waitcnt lgkmcnt(4)
    v_mfma_f32_16x16x32_bf16 v[208:211], a[160:163], a[0:3], 0
    ds_read_b128 a[188:191], v4 offset:9216
    v_mfma_f32_16x16x32_bf16 v[240:243], a[160:163], a[72:75], 0
    buffer_load_dwordx2 v[20:21], v14, s[32:35], 0 offen offset:256 sc1
    s_waitcnt vmcnt(13)
    s_waitcnt lgkmcnt(3)
    v_mfma_f32_16x16x32_bf16 v[192:195], a[172:175], a[4:7], v[192:195]
    ds_read_b128 a[144:147], v4 offset:10240
    v_mfma_f32_16x16x32_bf16 v[224:227], a[172:175], a[76:79], v[224:227]
    buffer_load_dwordx4 a[28:31], v4, s[24:27], s57 offen offset:3072 sc1
    v_mfma_f32_16x16x32_bf16 v[196:199], a[176:179], a[4:7], v[196:199]
    ds_read_b128 a[148:151], v4 offset:11264
    v_mfma_f32_16x16x32_bf16 v[228:231], a[176:179], a[76:79], v[228:231]
    buffer_load_dwordx4 a[100:103], v4, s[24:27], s85 offen offset:1024 sc1
    s_waitcnt lgkmcnt(3)
    v_mfma_f32_16x16x32_bf16 v[200:203], a[180:183], a[4:7], v[200:203]
    ds_read_b128 a[152:155], v4 offset:12288
    v_mfma_f32_16x16x32_bf16 v[232:235], a[180:183], a[76:79], v[232:235]
    buffer_load_dwordx2 v[22:23], v14, s[32:35], 0 offen offset:384 sc1
    v_mfma_f32_16x16x32_bf16 v[204:207], a[184:187], a[4:7], v[204:207]
    ds_read_b128 a[156:159], v4 offset:13312
    v_mfma_f32_16x16x32_bf16 v[236:239], a[184:187], a[76:79], v[236:239]
    buffer_load_dwordx2 v[24:25], v14, s[32:35], 0 offen offset:512 sc1
    s_waitcnt lgkmcnt(4)
    v_mfma_f32_16x16x32_bf16 v[208:211], a[188:191], a[4:7], v[208:211]
    ds_read_b128 a[160:163], v4 offset:14336
    v_mfma_f32_16x16x32_bf16 v[240:243], a[188:191], a[76:79], v[240:243]
    buffer_load_dwordx2 v[26:27], v14, s[32:35], 0 offen offset:640 sc1
    s_waitcnt vmcnt(16)
    s_waitcnt lgkmcnt(3)
    v_mfma_f32_16x16x32_bf16 v[192:195], a[144:147], a[8:11], v[192:195]
    ds_read_b128 a[172:175], v4 offset:15360
    v_mfma_f32_16x16x32_bf16 v[224:227], a[144:147], a[80:83], v[224:227]
    buffer_load_dwordx4 a[32:35], v4, s[24:27], s58 offen offset:0 sc1
    v_mfma_f32_16x16x32_bf16 v[196:199], a[148:151], a[8:11], v[196:199]
    ds_read_b128 a[176:179], v4 offset:16384
    v_mfma_f32_16x16x32_bf16 v[228:231], a[148:151], a[80:83], v[228:231]
    buffer_load_dwordx4 a[104:107], v4, s[24:27], s85 offen offset:2048 sc1
    s_waitcnt lgkmcnt(3)
    v_mfma_f32_16x16x32_bf16 v[200:203], a[152:155], a[8:11], v[200:203]
    ds_read_b128 a[180:183], v4 offset:17408
    v_mfma_f32_16x16x32_bf16 v[232:235], a[152:155], a[80:83], v[232:235]
    buffer_load_dwordx2 v[28:29], v14, s[32:35], 0 offen offset:768 sc1
    v_mfma_f32_16x16x32_bf16 v[204:207], a[156:159], a[8:11], v[204:207]
    ds_read_b128 a[184:187], v4 offset:18432
    v_mfma_f32_16x16x32_bf16 v[236:239], a[156:159], a[80:83], v[236:239]
    buffer_load_dwordx2 v[30:31], v14, s[32:35], 0 offen offset:896 sc1
    s_waitcnt lgkmcnt(4)
    v_mfma_f32_16x16x32_bf16 v[208:211], a[160:163], a[8:11], v[208:211]
    ds_read_b128 a[188:191], v4 offset:19456
    v_mfma_f32_16x16x32_bf16 v[240:243], a[160:163], a[80:83], v[240:243]
    s_waitcnt vmcnt(18)
    s_waitcnt lgkmcnt(3)
    v_mfma_f32_16x16x32_bf16 v[192:195], a[172:175], a[12:15], v[192:195]
    ds_read_b128 a[144:147], v4 offset:20480
    v_mfma_f32_16x16x32_bf16 v[224:227], a[172:175], a[84:87], v[224:227]
    buffer_load_dwordx4 a[36:39], v4, s[24:27], s58 offen offset:1024 sc1
    v_mfma_f32_16x16x32_bf16 v[196:199], a[176:179], a[12:15], v[196:199]
    ds_read_b128 a[148:151], v4 offset:21504
    v_mfma_f32_16x16x32_bf16 v[228:231], a[176:179], a[84:87], v[228:231]
    buffer_load_dwordx4 a[108:111], v4, s[24:27], s85 offen offset:3072 sc1
    s_waitcnt lgkmcnt(3)
    v_mfma_f32_16x16x32_bf16 v[200:203], a[180:183], a[12:15], v[200:203]
    ds_read_b128 a[152:155], v4 offset:22528
    v_mfma_f32_16x16x32_bf16 v[232:235], a[180:183], a[84:87], v[232:235]
    v_mfma_f32_16x16x32_bf16 v[204:207], a[184:187], a[12:15], v[204:207]
    ds_read_b128 a[156:159], v4 offset:23552
    v_mfma_f32_16x16x32_bf16 v[236:239], a[184:187], a[84:87], v[236:239]
    s_waitcnt lgkmcnt(4)
    v_mfma_f32_16x16x32_bf16 v[208:211], a[188:191], a[12:15], v[208:211]
    ds_read_b128 a[160:163], v4 offset:24576
    v_mfma_f32_16x16x32_bf16 v[240:243], a[188:191], a[84:87], v[240:243]
    s_waitcnt vmcnt(18)
    s_waitcnt lgkmcnt(3)
    v_mfma_f32_16x16x32_bf16 v[192:195], a[144:147], a[16:19], v[192:195]
    ds_read_b128 a[172:175], v4 offset:25600
    v_mfma_f32_16x16x32_bf16 v[224:227], a[144:147], a[88:91], v[224:227]
    buffer_load_dwordx4 a[40:43], v4, s[24:27], s58 offen offset:2048 sc1
    v_mfma_f32_16x16x32_bf16 v[196:199], a[148:151], a[16:19], v[196:199]
    ds_read_b128 a[176:179], v4 offset:26624
    v_mfma_f32_16x16x32_bf16 v[228:231], a[148:151], a[88:91], v[228:231]
    buffer_load_dwordx4 a[112:115], v4, s[24:27], s86 offen offset:0 sc1
    s_waitcnt lgkmcnt(3)
    v_mfma_f32_16x16x32_bf16 v[200:203], a[152:155], a[16:19], v[200:203]
    ds_read_b128 a[180:183], v4 offset:27648
    v_mfma_f32_16x16x32_bf16 v[232:235], a[152:155], a[88:91], v[232:235]
    v_mfma_f32_16x16x32_bf16 v[204:207], a[156:159], a[16:19], v[204:207]
    ds_read_b128 a[184:187], v4 offset:28672
    v_mfma_f32_16x16x32_bf16 v[236:239], a[156:159], a[88:91], v[236:239]
    s_waitcnt lgkmcnt(4)
    v_mfma_f32_16x16x32_bf16 v[208:211], a[160:163], a[16:19], v[208:211]
    ds_read_b128 a[188:191], v4 offset:29696
    v_mfma_f32_16x16x32_bf16 v[240:243], a[160:163], a[88:91], v[240:243]
    s_waitcnt vmcnt(18)
    s_waitcnt lgkmcnt(3)
    v_mfma_f32_16x16x32_bf16 v[192:195], a[172:175], a[20:23], v[192:195]
    ds_read_b128 a[144:147], v4 offset:30720
    ds_read_b128 v[40:43], v33 offset:0
    v_mfma_f32_16x16x32_bf16 v[224:227], a[172:175], a[92:95], v[224:227]
    buffer_load_dwordx4 a[44:47], v4, s[24:27], s58 offen offset:3072 sc1
    ds_read_b128 v[44:47], v33 offset:64
    v_mfma_f32_16x16x32_bf16 v[196:199], a[176:179], a[20:23], v[196:199]
    ds_read_b128 a[148:151], v4 offset:31744
    ds_read_b128 v[48:51], v33 offset:128
    v_mfma_f32_16x16x32_bf16 v[228:231], a[176:179], a[92:95], v[228:231]
    buffer_load_dwordx4 a[116:119], v4, s[24:27], s86 offen offset:1024 sc1
    ds_read_b128 v[52:55], v33 offset:192
    s_waitcnt lgkmcnt(7)
    v_mfma_f32_16x16x32_bf16 v[200:203], a[180:183], a[20:23], v[200:203]
    ds_read_b128 a[152:155], v4 offset:32768
    ds_read_b128 v[56:59], v33 offset:256
    v_mfma_f32_16x16x32_bf16 v[232:235], a[180:183], a[92:95], v[232:235]
    ds_read_b128 v[60:63], v33 offset:320
    v_mfma_f32_16x16x32_bf16 v[204:207], a[184:187], a[20:23], v[204:207]
    ds_read_b128 a[156:159], v4 offset:33792
    ds_read_b128 v[64:67], v33 offset:384
    v_mfma_f32_16x16x32_bf16 v[236:239], a[184:187], a[92:95], v[236:239]
    s_waitcnt vmcnt(6)
    s_waitcnt lgkmcnt(11)
    v_mfma_f32_16x16x32_bf16 v[208:211], a[188:191], a[20:23], v[208:211]
    ds_read_b128 a[160:163], v4 offset:34816
    v_mfma_f32_16x16x32_bf16 v[240:243], a[188:191], a[92:95], v[240:243]
    s_waitcnt lgkmcnt(8)
    v_mfma_f32_16x16x32_bf16 v[192:195], a[144:147], a[24:27], v[192:195]
    ds_read_b128 a[172:175], v4 offset:35840
    v_pk_add_f32 v[16:17], v[16:17], v[18:19]
    v_mfma_f32_16x16x32_bf16 v[224:227], a[144:147], a[96:99], v[224:227]
    buffer_load_dwordx4 a[48:51], v4, s[24:27], s59 offen offset:0 sc1
    v_pk_add_f32 v[20:21], v[20:21], v[22:23]
    v_mfma_f32_16x16x32_bf16 v[196:199], a[148:151], a[24:27], v[196:199]
    ds_read_b128 a[176:179], v4 offset:36864
    v_pk_add_f32 v[24:25], v[24:25], v[26:27]
    v_mfma_f32_16x16x32_bf16 v[228:231], a[148:151], a[96:99], v[228:231]
    buffer_load_dwordx4 a[120:123], v4, s[24:27], s86 offen offset:2048 sc1
    v_pk_add_f32 v[28:29], v[28:29], v[30:31]
    s_waitcnt lgkmcnt(4)
    v_mfma_f32_16x16x32_bf16 v[200:203], a[152:155], a[24:27], v[200:203]
    ds_read_b128 a[180:183], v4 offset:37888
    v_pk_add_f32 v[16:17], v[16:17], v[20:21]
    v_mfma_f32_16x16x32_bf16 v[232:235], a[152:155], a[96:99], v[232:235]
    v_pk_add_f32 v[24:25], v[24:25], v[28:29]
    v_mfma_f32_16x16x32_bf16 v[204:207], a[156:159], a[24:27], v[204:207]
    ds_read_b128 a[184:187], v4 offset:38912
    v_mfma_f32_16x16x32_bf16 v[236:239], a[156:159], a[96:99], v[236:239]
    s_waitcnt lgkmcnt(4)
    v_mfma_f32_16x16x32_bf16 v[208:211], a[160:163], a[24:27], v[208:211]
    ds_read_b128 a[188:191], v4 offset:39936
    v_mfma_f32_16x16x32_bf16 v[240:243], a[160:163], a[96:99], v[240:243]
    s_waitcnt lgkmcnt(3)
    v_mfma_f32_16x16x32_bf16 v[192:195], a[172:175], a[28:31], v[192:195]
    ds_read_b128 a[144:147], v4 offset:40960
    v_pk_add_f32 v[16:17], v[16:17], v[24:25]
    v_mfma_f32_16x16x32_bf16 v[224:227], a[172:175], a[100:103], v[224:227]
    buffer_load_dwordx4 a[52:55], v4, s[24:27], s59 offen offset:1024 sc1
    v_mov_b32 v18, v16
    v_mfma_f32_16x16x32_bf16 v[196:199], a[176:179], a[28:31], v[196:199]
    ds_read_b128 a[148:151], v4 offset:41984
    v_mov_b32 v19, v17
    v_mfma_f32_16x16x32_bf16 v[228:231], a[176:179], a[100:103], v[228:231]
    buffer_load_dwordx4 a[124:127], v4, s[24:27], s86 offen offset:3072 sc1
    v_permlane16_swap_b32 v16, v18
    s_waitcnt lgkmcnt(3)
    v_mfma_f32_16x16x32_bf16 v[200:203], a[180:183], a[28:31], v[200:203]
    ds_read_b128 a[152:155], v4 offset:43008
    v_permlane16_swap_b32 v17, v19
    v_mfma_f32_16x16x32_bf16 v[232:235], a[180:183], a[100:103], v[232:235]
    v_add_f32 v16, v16, v18
    v_mfma_f32_16x16x32_bf16 v[204:207], a[184:187], a[28:31], v[204:207]
    ds_read_b128 a[156:159], v4 offset:44032
    v_mfma_f32_16x16x32_bf16 v[236:239], a[184:187], a[100:103], v[236:239]
    s_waitcnt lgkmcnt(4)
    v_mfma_f32_16x16x32_bf16 v[208:211], a[188:191], a[28:31], v[208:211]
    ds_read_b128 a[160:163], v4 offset:45056
    v_mfma_f32_16x16x32_bf16 v[240:243], a[188:191], a[100:103], v[240:243]
    s_waitcnt lgkmcnt(3)
    v_mfma_f32_16x16x32_bf16 v[192:195], a[144:147], a[32:35], v[192:195]
    ds_read_b128 a[172:175], v4 offset:46080
    v_add_f32 v17, v17, v19
    v_mfma_f32_16x16x32_bf16 v[224:227], a[144:147], a[104:107], v[224:227]
    buffer_load_dwordx4 a[56:59], v4, s[24:27], s59 offen offset:2048 sc1
    v_mul_f32 v8, 0x3ae38e39, v16
    v_mfma_f32_16x16x32_bf16 v[196:199], a[148:151], a[32:35], v[196:199]
    ds_read_b128 a[176:179], v4 offset:47104
    v_mul_f32 v9, 0x3ae38e39, v17
    v_mfma_f32_16x16x32_bf16 v[228:231], a[148:151], a[104:107], v[228:231]
    buffer_load_dwordx4 a[128:131], v4, s[24:27], s87 offen offset:0 sc1
    v_fma_f32 v9, -v8, v8, v9
    s_waitcnt lgkmcnt(3)
    v_mfma_f32_16x16x32_bf16 v[200:203], a[152:155], a[32:35], v[200:203]
    ds_read_b128 a[180:183], v4 offset:48128
    v_max_f32 v9, 0, v9
    v_mfma_f32_16x16x32_bf16 v[232:235], a[152:155], a[104:107], v[232:235]
    v_cvt_pk_bf16_f32 v9, v8, v9
    v_mfma_f32_16x16x32_bf16 v[204:207], a[156:159], a[32:35], v[204:207]
    ds_read_b128 a[184:187], v4 offset:49152
    v_mfma_f32_16x16x32_bf16 v[236:239], a[156:159], a[104:107], v[236:239]
    s_waitcnt lgkmcnt(4)
    v_mfma_f32_16x16x32_bf16 v[208:211], a[160:163], a[32:35], v[208:211]
    ds_read_b128 a[188:191], v4 offset:50176
    v_mfma_f32_16x16x32_bf16 v[240:243], a[160:163], a[104:107], v[240:243]
    s_waitcnt vmcnt(10)
    s_waitcnt lgkmcnt(3)
    v_mfma_f32_16x16x32_bf16 v[192:195], a[172:175], a[36:39], v[192:195]
    ds_read_b128 a[144:147], v4 offset:51200
    v_lshlrev_b32 v8, 16, v9
    v_mfma_f32_16x16x32_bf16 v[224:227], a[172:175], a[108:111], v[224:227]
    buffer_load_dwordx4 a[60:63], v4, s[24:27], s59 offen offset:3072 sc1
    v_and_b32 v9, 0xffff0000, v9
    v_mfma_f32_16x16x32_bf16 v[196:199], a[176:179], a[36:39], v[196:199]
    ds_read_b128 a[148:151], v4 offset:52224
    v_add_f32 v9, 0x3727c5ac, v9
    v_mfma_f32_16x16x32_bf16 v[228:231], a[176:179], a[108:111], v[228:231]
    buffer_load_dwordx4 a[132:135], v4, s[24:27], s87 offen offset:1024 sc1
    v_cvt_pk_bf16_f32 v9, v9, v9
    s_waitcnt lgkmcnt(3)
    v_mfma_f32_16x16x32_bf16 v[200:203], a[180:183], a[36:39], v[200:203]
    ds_read_b128 a[152:155], v4 offset:53248
    v_lshlrev_b32 v9, 16, v9
    v_mfma_f32_16x16x32_bf16 v[232:235], a[180:183], a[108:111], v[232:235]
    v_sqrt_f32 v9, v9
    v_mfma_f32_16x16x32_bf16 v[204:207], a[184:187], a[36:39], v[204:207]
    ds_read_b128 a[156:159], v4 offset:54272
    v_mfma_f32_16x16x32_bf16 v[236:239], a[184:187], a[108:111], v[236:239]
    s_waitcnt lgkmcnt(4)
    v_mfma_f32_16x16x32_bf16 v[208:211], a[188:191], a[36:39], v[208:211]
    ds_read_b128 a[160:163], v4 offset:55296
    v_mfma_f32_16x16x32_bf16 v[240:243], a[188:191], a[108:111], v[240:243]
    s_waitcnt vmcnt(10)
    s_waitcnt lgkmcnt(3)
    v_mfma_f32_16x16x32_bf16 v[192:195], a[144:147], a[40:43], v[192:195]
    ds_read_b128 a[172:175], v4 offset:56320
    v_cvt_pk_bf16_f32 v9, v9, v9
    v_mfma_f32_16x16x32_bf16 v[224:227], a[144:147], a[112:115], v[224:227]
    buffer_load_dwordx4 a[64:67], v4, s[24:27], s60 offen offset:0 sc1
    v_lshlrev_b32 v9, 16, v9
    v_mfma_f32_16x16x32_bf16 v[196:199], a[148:151], a[40:43], v[196:199]
    ds_read_b128 a[176:179], v4 offset:57344
    v_rcp_f32 v9, v9
    v_mfma_f32_16x16x32_bf16 v[228:231], a[148:151], a[112:115], v[228:231]
    buffer_load_dwordx4 a[136:139], v4, s[24:27], s87 offen offset:2048 sc1
    v_mov_b32 v10, v8
    s_waitcnt lgkmcnt(3)
    v_mfma_f32_16x16x32_bf16 v[200:203], a[152:155], a[40:43], v[200:203]
    ds_read_b128 a[180:183], v4 offset:58368
    v_mov_b32 v11, v9
    v_mfma_f32_16x16x32_bf16 v[232:235], a[152:155], a[112:115], v[232:235]
    v_permlane32_swap_b32 v8, v10
    v_mfma_f32_16x16x32_bf16 v[204:207], a[156:159], a[40:43], v[204:207]
    ds_read_b128 a[184:187], v4 offset:59392
    v_mfma_f32_16x16x32_bf16 v[236:239], a[156:159], a[112:115], v[236:239]
    s_waitcnt lgkmcnt(4)
    v_mfma_f32_16x16x32_bf16 v[208:211], a[160:163], a[40:43], v[208:211]
    ds_read_b128 a[188:191], v4 offset:60416
    v_mfma_f32_16x16x32_bf16 v[240:243], a[160:163], a[112:115], v[240:243]
    s_waitcnt vmcnt(10)
    s_waitcnt lgkmcnt(3)
    v_mfma_f32_16x16x32_bf16 v[192:195], a[172:175], a[44:47], v[192:195]
    ds_read_b128 a[144:147], v4 offset:61440
    v_permlane32_swap_b32 v9, v11
    v_mfma_f32_16x16x32_bf16 v[224:227], a[172:175], a[116:119], v[224:227]
    buffer_load_dwordx4 a[68:71], v4, s[24:27], s60 offen offset:1024 sc1
    v_mul_f32 v34, 0x3fb8aa3b, v9
    v_mfma_f32_16x16x32_bf16 v[196:199], a[176:179], a[44:47], v[196:199]
    ds_read_b128 a[148:151], v4 offset:62464
    v_mul_f32 v35, 0x3fb8aa3b, v9
    v_mfma_f32_16x16x32_bf16 v[228:231], a[176:179], a[116:119], v[228:231]
    buffer_load_dwordx4 a[140:143], v4, s[24:27], s87 offen offset:3072 sc1
    v_mul_f32 v36, 0x3fb8aa3b, v11
    s_waitcnt lgkmcnt(3)
    v_mfma_f32_16x16x32_bf16 v[200:203], a[180:183], a[44:47], v[200:203]
    ds_read_b128 a[152:155], v4 offset:63488
    v_mul_f32 v37, 0x3fb8aa3b, v11
    v_mfma_f32_16x16x32_bf16 v[232:235], a[180:183], a[116:119], v[232:235]
    buffer_load_dword a255, v15, s[8:11], 0 offen sc1
    v_mfma_f32_16x16x32_bf16 v[204:207], a[184:187], a[44:47], v[204:207]
    ds_read_b128 a[156:159], v4 offset:64512
    v_mfma_f32_16x16x32_bf16 v[236:239], a[184:187], a[116:119], v[236:239]
    s_cmp_eq_u32 s3, 0
    s_cselect_b32 s82, 0, s82
    s_waitcnt lgkmcnt(4)
    v_mfma_f32_16x16x32_bf16 v[208:211], a[188:191], a[44:47], v[208:211]
    ds_read_b128 a[160:163], v7 offset:0
    v_mfma_f32_16x16x32_bf16 v[240:243], a[188:191], a[116:119], v[240:243]
    s_mul_i32 s52, s44, 4
    s_add_u32 s52, s52, 0
    s_add_u32 m0, s52, 131072
    s_nop 0
    buffer_load_dwordx4 v4, s[80:83], s52 offen offset:0 lds
    s_waitcnt vmcnt(12)
    s_waitcnt lgkmcnt(3)
    v_mfma_f32_16x16x32_bf16 v[192:195], a[144:147], a[48:51], v[192:195]
    ds_read_b128 a[172:175], v7 offset:1024
    v_mfma_f32_16x16x32_bf16 v[224:227], a[144:147], a[120:123], v[224:227]
    buffer_load_dwordx4 v4, s[80:83], s52 offen offset:1024 lds
    v_mul_f32 v212, -v8, v60
    v_mfma_f32_16x16x32_bf16 v[196:199], a[148:151], a[48:51], v[196:199]
    ds_read_b128 a[176:179], v7 offset:2048
    v_mul_f32 v213, -v8, v61
    v_mfma_f32_16x16x32_bf16 v[228:231], a[148:151], a[120:123], v[228:231]
    buffer_load_dwordx4 v4, s[80:83], s52 offen offset:2048 lds
    v_mul_f32 v214, -v8, v62
    s_waitcnt lgkmcnt(3)
    v_mfma_f32_16x16x32_bf16 v[200:203], a[152:155], a[48:51], v[200:203]
    ds_read_b128 a[180:183], v7 offset:3072
    v_mul_f32 v215, -v8, v63
    v_mfma_f32_16x16x32_bf16 v[232:235], a[152:155], a[120:123], v[232:235]
    buffer_load_dwordx4 v4, s[80:83], s52 offen offset:3072 lds
    v_mul_f32 v216, -v8, v64
    v_mfma_f32_16x16x32_bf16 v[204:207], a[156:159], a[48:51], v[204:207]
    ds_read_b128 a[184:187], v7 offset:4096
    v_mul_f32 v217, -v8, v65
    v_mfma_f32_16x16x32_bf16 v[236:239], a[156:159], a[120:123], v[236:239]
    s_mul_i32 s52, s44, 4
    s_add_u32 s52, s52, 16384
    s_min_u32 s52, s52, 26624
    s_add_u32 m0, s52, 131072
    s_nop 0
    buffer_load_dwordx4 v4, s[80:83], s52 offen offset:0 lds
    v_mul_f32 v218, -v8, v66
    s_waitcnt lgkmcnt(4)
    v_mfma_f32_16x16x32_bf16 v[208:211], a[160:163], a[48:51], v[208:211]
    ds_read_b128 a[188:191], v7 offset:5120
    v_mul_f32 v219, -v8, v67
    v_mfma_f32_16x16x32_bf16 v[240:243], a[160:163], a[120:123], v[240:243]
    buffer_load_dwordx4 v4, s[80:83], s52 offen offset:1024 lds
    s_waitcnt vmcnt(15)
    s_waitcnt lgkmcnt(3)
    v_mfma_f32_16x16x32_bf16 v[192:195], a[172:175], a[52:55], v[192:195]
    ds_read_b128 a[144:147], v7 offset:6144
    v_fma_f32 v200, -v8, v48, v200
    v_fma_f32 v201, -v8, v49, v201
    v_fma_f32 v202, -v8, v50, v202
    v_fma_f32 v203, -v8, v51, v203
    v_mfma_f32_16x16x32_bf16 v[224:227], a[172:175], a[124:127], v[224:227]
    buffer_load_dwordx4 v4, s[80:83], s52 offen offset:2048 lds
    v_fma_f32 v232, -v10, v48, v232
    v_fma_f32 v233, -v10, v49, v233
    v_fma_f32 v234, -v10, v50, v234
    v_fma_f32 v235, -v10, v51, v235
    v_mfma_f32_16x16x32_bf16 v[196:199], a[176:179], a[52:55], v[196:199]
    ds_read_b128 a[148:151], v7 offset:7168
    v_fma_f32 v204, -v8, v52, v204
    v_fma_f32 v205, -v8, v53, v205
    v_fma_f32 v206, -v8, v54, v206
    v_fma_f32 v207, -v8, v55, v207
    v_mfma_f32_16x16x32_bf16 v[228:231], a[176:179], a[124:127], v[228:231]
    buffer_load_dwordx4 v4, s[80:83], s52 offen offset:3072 lds
    v_fma_f32 v236, -v10, v52, v236
    v_fma_f32 v237, -v10, v53, v237
    v_fma_f32 v238, -v10, v54, v238
    v_fma_f32 v239, -v10, v55, v239
    s_waitcnt lgkmcnt(3)
    v_mfma_f32_16x16x32_bf16 v[200:203], a[180:183], a[52:55], v[200:203]
    ds_read_b128 a[152:155], v7 offset:8192
    v_fma_f32 v208, -v8, v56, v208
    v_fma_f32 v209, -v8, v57, v209
    v_fma_f32 v210, -v8, v58, v210
    v_fma_f32 v211, -v8, v59, v211
    v_mfma_f32_16x16x32_bf16 v[232:235], a[180:183], a[124:127], v[232:235]
    s_mov_b32 s82, 43008
    v_fma_f32 v240, -v10, v56, v240
    v_fma_f32 v241, -v10, v57, v241
    v_fma_f32 v242, -v10, v58, v242
    v_fma_f32 v243, -v10, v59, v243
    v_mfma_f32_16x16x32_bf16 v[204:207], a[184:187], a[52:55], v[204:207]
    ds_read_b128 a[156:159], v7 offset:9216
    v_fma_f32 v192, -v8, v40, v192
    v_fma_f32 v193, -v8, v41, v193
    v_fma_f32 v194, -v8, v42, v194
    v_fma_f32 v195, -v8, v43, v195
    v_mfma_f32_16x16x32_bf16 v[236:239], a[184:187], a[124:127], v[236:239]
    v_fma_f32 v224, -v10, v40, v224
    v_fma_f32 v225, -v10, v41, v225
    v_fma_f32 v226, -v10, v42, v226
    v_fma_f32 v227, -v10, v43, v227
    s_waitcnt lgkmcnt(4)
    v_mfma_f32_16x16x32_bf16 v[208:211], a[188:191], a[52:55], v[208:211]
    ds_read_b128 a[160:163], v7 offset:10240
    v_fma_f32 v196, -v8, v44, v196
    v_fma_f32 v197, -v8, v45, v197
    v_fma_f32 v198, -v8, v46, v198
    v_fma_f32 v199, -v8, v47, v199
    v_mfma_f32_16x16x32_bf16 v[240:243], a[188:191], a[124:127], v[240:243]
    v_fma_f32 v228, -v10, v44, v228
    v_fma_f32 v229, -v10, v45, v229
    v_fma_f32 v230, -v10, v46, v230
    v_fma_f32 v231, -v10, v47, v231
    s_waitcnt vmcnt(15)
    s_waitcnt lgkmcnt(3)
    v_mfma_f32_16x16x32_bf16 v[192:195], a[144:147], a[56:59], v[192:195]
    ds_read_b128 a[172:175], v7 offset:11264
    v_mul_f32 v244, -v10, v60
    v_mfma_f32_16x16x32_bf16 v[224:227], a[144:147], a[128:131], v[224:227]
    v_mul_f32 v245, -v10, v61
    v_mfma_f32_16x16x32_bf16 v[196:199], a[148:151], a[56:59], v[196:199]
    ds_read_b128 a[176:179], v7 offset:12288
    v_mul_f32 v246, -v10, v62
    v_mfma_f32_16x16x32_bf16 v[228:231], a[148:151], a[128:131], v[228:231]
    v_mul_f32 v247, -v10, v63
    s_waitcnt lgkmcnt(3)
    v_mfma_f32_16x16x32_bf16 v[200:203], a[152:155], a[56:59], v[200:203]
    ds_read_b128 a[180:183], v7 offset:13312
    v_mul_f32 v248, -v10, v64
    v_mfma_f32_16x16x32_bf16 v[232:235], a[152:155], a[128:131], v[232:235]
    v_mul_f32 v249, -v10, v65
    v_mfma_f32_16x16x32_bf16 v[204:207], a[156:159], a[56:59], v[204:207]
    ds_read_b128 a[184:187], v7 offset:14336
    v_mul_f32 v250, -v10, v66
    v_mfma_f32_16x16x32_bf16 v[236:239], a[156:159], a[128:131], v[236:239]
    v_mul_f32 v251, -v10, v67
    s_waitcnt lgkmcnt(4)
    v_mfma_f32_16x16x32_bf16 v[208:211], a[160:163], a[56:59], v[208:211]
    ds_read_b128 a[188:191], v7 offset:15360
    v_mfma_f32_16x16x32_bf16 v[240:243], a[160:163], a[128:131], v[240:243]
    s_waitcnt vmcnt(13)
    s_waitcnt lgkmcnt(3)
    v_mfma_f32_16x16x32_bf16 v[192:195], a[172:175], a[60:63], v[192:195]
    ds_read_b128 a[144:147], v7 offset:16384
    v_accvgpr_read_b32 v68, a203
    v_mfma_f32_16x16x32_bf16 v[224:227], a[172:175], a[132:135], v[224:227]
    v_accvgpr_read_b32 v69, a202
    v_mfma_f32_16x16x32_bf16 v[196:199], a[176:179], a[60:63], v[196:199]
    ds_read_b128 a[148:151], v7 offset:17408
    v_accvgpr_read_b32 v70, a206
    v_mfma_f32_16x16x32_bf16 v[228:231], a[176:179], a[132:135], v[228:231]
    v_accvgpr_read_b32 v71, a207
    s_waitcnt lgkmcnt(3)
    v_mfma_f32_16x16x32_bf16 v[200:203], a[180:183], a[60:63], v[200:203]
    ds_read_b128 a[152:155], v7 offset:18432
    v_accvgpr_read_b32 v72, a208
    v_mfma_f32_16x16x32_bf16 v[232:235], a[180:183], a[132:135], v[232:235]
    v_accvgpr_read_b32 v73, a209
    v_mfma_f32_16x16x32_bf16 v[204:207], a[184:187], a[60:63], v[204:207]
    ds_read_b128 a[156:159], v7 offset:19456
    v_accvgpr_read_b32 v74, a210
    v_mfma_f32_16x16x32_bf16 v[236:239], a[184:187], a[132:135], v[236:239]
    v_accvgpr_read_b32 v75, a211
    s_waitcnt lgkmcnt(4)
    v_mfma_f32_16x16x32_bf16 v[208:211], a[188:191], a[60:63], v[208:211]
    ds_read_b128 a[160:163], v7 offset:20480
    v_accvgpr_read_b32 v76, a214
    v_mfma_f32_16x16x32_bf16 v[240:243], a[188:191], a[132:135], v[240:243]
    s_waitcnt vmcnt(11)
    s_waitcnt lgkmcnt(3)
    v_mfma_f32_16x16x32_bf16 v[192:195], a[144:147], a[64:67], v[192:195]
    ds_read_b128 a[172:175], v7 offset:21504
    v_mfma_f32_16x16x32_bf16 v[224:227], a[144:147], a[136:139], v[224:227]
    v_mfma_f32_16x16x32_bf16 v[196:199], a[148:151], a[64:67], v[196:199]
    ds_read_b128 a[176:179], v7 offset:22528
    v_mfma_f32_16x16x32_bf16 v[228:231], a[148:151], a[136:139], v[228:231]
    s_waitcnt lgkmcnt(3)
    v_mfma_f32_16x16x32_bf16 v[200:203], a[152:155], a[64:67], v[200:203]
    ds_read_b128 a[180:183], v7 offset:23552
    v_mfma_f32_16x16x32_bf16 v[232:235], a[152:155], a[136:139], v[232:235]
    v_mfma_f32_16x16x32_bf16 v[204:207], a[156:159], a[64:67], v[204:207]
    ds_read_b128 a[184:187], v7 offset:24576
    v_mfma_f32_16x16x32_bf16 v[236:239], a[156:159], a[136:139], v[236:239]
    s_waitcnt lgkmcnt(4)
    v_mfma_f32_16x16x32_bf16 v[208:211], a[160:163], a[64:67], v[208:211]
    ds_read_b128 a[188:191], v7 offset:25600
    v_mfma_f32_16x16x32_bf16 v[240:243], a[160:163], a[136:139], v[240:243]
    s_waitcnt vmcnt(9)
    s_waitcnt lgkmcnt(3)
    v_mfma_f32_16x16x32_bf16 v[192:195], a[172:175], a[68:71], v[192:195]
    v_mfma_f32_16x16x32_bf16 v[224:227], a[172:175], a[140:143], v[224:227]
    v_mfma_f32_16x16x32_bf16 v[196:199], a[176:179], a[68:71], v[196:199]
    v_mfma_f32_16x16x32_bf16 v[228:231], a[176:179], a[140:143], v[228:231]
    s_waitcnt lgkmcnt(1)
    v_mfma_f32_16x16x32_bf16 v[200:203], a[180:183], a[68:71], v[200:203]
    v_mfma_f32_16x16x32_bf16 v[232:235], a[180:183], a[140:143], v[232:235]
    v_mfma_f32_16x16x32_bf16 v[204:207], a[184:187], a[68:71], v[204:207]
    v_mfma_f32_16x16x32_bf16 v[236:239], a[184:187], a[140:143], v[236:239]
    s_waitcnt lgkmcnt(0)
    v_mfma_f32_16x16x32_bf16 v[208:211], a[188:191], a[68:71], v[208:211]
    v_mfma_f32_16x16x32_bf16 v[240:243], a[188:191], a[140:143], v[240:243]
    v_max3_f32 v112, v192, v193, v194
    v_max3_f32 v152, v224, v225, v226
    v_min3_f32 v114, v192, v193, v194
    v_min3_f32 v154, v224, v225, v226
    v_max3_f32 v112, v112, v195, v196
    v_max3_f32 v152, v152, v227, v228
    v_min3_f32 v114, v114, v195, v196
    v_min3_f32 v154, v154, v227, v228
    v_max3_f32 v112, v112, v197, v198
    v_max3_f32 v152, v152, v229, v230
    v_min3_f32 v114, v114, v197, v198
    v_min3_f32 v154, v154, v229, v230
    v_max3_f32 v112, v112, v199, v200
    v_max3_f32 v152, v152, v231, v232
    v_min3_f32 v114, v114, v199, v200
    v_min3_f32 v154, v154, v231, v232
    v_mov_b32 v116, v112
    v_mov_b32 v156, v152
    v_mov_b32 v117, v114
    v_mov_b32 v157, v154
    v_permlane16_swap_b32 v112, v116
    v_permlane16_swap_b32 v152, v156
    v_permlane16_swap_b32 v114, v117
    v_permlane16_swap_b32 v154, v157
    v_max_f32 v112, v112, v116
    v_max_f32 v152, v152, v156
    v_min_f32 v114, v114, v117
    v_min_f32 v154, v154, v157
    v_mul_f32 v112, v34, v112
    v_mul_f32 v152, v36, v152
    v_mul_f32 v114, v34, v114
    v_mul_f32 v154, v36, v154
    v_pk_fma_f32 v[80:81], v[192:193], v[34:35], v[112:113] op_sel_hi:[1,1,0] neg_lo:[0,0,1] neg_hi:[0,0,1]
    v_pk_fma_f32 v[120:121], v[224:225], v[36:37], v[152:153] op_sel_hi:[1,1,0] neg_lo:[0,0,1] neg_hi:[0,0,1]
    v_pk_fma_f32 v[90:91], v[192:193], v[34:35], v[114:115] op_sel_hi:[1,1,0] neg_lo:[1,0,0] neg_hi:[1,0,0]
    v_pk_fma_f32 v[130:131], v[224:225], v[36:37], v[154:155] op_sel_hi:[1,1,0] neg_lo:[1,0,0] neg_hi:[1,0,0]
    v_pk_fma_f32 v[82:83], v[194:195], v[34:35], v[112:113] op_sel_hi:[1,1,0] neg_lo:[0,0,1] neg_hi:[0,0,1]
    v_pk_fma_f32 v[122:123], v[226:227], v[36:37], v[152:153] op_sel_hi:[1,1,0] neg_lo:[0,0,1] neg_hi:[0,0,1]
    v_pk_fma_f32 v[92:93], v[194:195], v[34:35], v[114:115] op_sel_hi:[1,1,0] neg_lo:[1,0,0] neg_hi:[1,0,0]
    v_pk_fma_f32 v[132:133], v[226:227], v[36:37], v[154:155] op_sel_hi:[1,1,0] neg_lo:[1,0,0] neg_hi:[1,0,0]
    v_pk_fma_f32 v[84:85], v[196:197], v[34:35], v[112:113] op_sel_hi:[1,1,0] neg_lo:[0,0,1] neg_hi:[0,0,1]
    v_pk_fma_f32 v[124:125], v[228:229], v[36:37], v[152:153] op_sel_hi:[1,1,0] neg_lo:[0,0,1] neg_hi:[0,0,1]
    v_pk_fma_f32 v[94:95], v[196:197], v[34:35], v[114:115] op_sel_hi:[1,1,0] neg_lo:[1,0,0] neg_hi:[1,0,0]
    v_pk_fma_f32 v[134:135], v[228:229], v[36:37], v[154:155] op_sel_hi:[1,1,0] neg_lo:[1,0,0] neg_hi:[1,0,0]
    v_pk_fma_f32 v[86:87], v[198:199], v[34:35], v[112:113] op_sel_hi:[1,1,0] neg_lo:[0,0,1] neg_hi:[0,0,1]
    v_pk_fma_f32 v[126:127], v[230:231], v[36:37], v[152:153] op_sel_hi:[1,1,0] neg_lo:[0,0,1] neg_hi:[0,0,1]
    v_pk_fma_f32 v[96:97], v[198:199], v[34:35], v[114:115] op_sel_hi:[1,1,0] neg_lo:[1,0,0] neg_hi:[1,0,0]
    v_pk_fma_f32 v[136:137], v[230:231], v[36:37], v[154:155] op_sel_hi:[1,1,0] neg_lo:[1,0,0] neg_hi:[1,0,0]
    v_pk_fma_f32 v[88:89], v[200:201], v[34:35], v[112:113] op_sel_hi:[1,1,0] neg_lo:[0,0,1] neg_hi:[0,0,1]
    v_pk_fma_f32 v[128:129], v[232:233], v[36:37], v[152:153] op_sel_hi:[1,1,0] neg_lo:[0,0,1] neg_hi:[0,0,1]
    v_pk_fma_f32 v[98:99], v[200:201], v[34:35], v[114:115] op_sel_hi:[1,1,0] neg_lo:[1,0,0] neg_hi:[1,0,0]
    v_pk_fma_f32 v[138:139], v[232:233], v[36:37], v[154:155] op_sel_hi:[1,1,0] neg_lo:[1,0,0] neg_hi:[1,0,0]
    v_exp_f32 v80, v80
    v_exp_f32 v120, v120
    v_exp_f32 v90, v90
    v_exp_f32 v130, v130
    v_exp_f32 v81, v81
    v_exp_f32 v121, v121
    v_exp_f32 v91, v91
    v_exp_f32 v131, v131
    v_exp_f32 v82, v82
    v_exp_f32 v122, v122
    v_exp_f32 v92, v92
    v_exp_f32 v132, v132
    v_exp_f32 v83, v83
    v_exp_f32 v123, v123
    v_exp_f32 v93, v93
    v_exp_f32 v133, v133
    v_exp_f32 v84, v84
    v_exp_f32 v124, v124
    v_exp_f32 v94, v94
    v_exp_f32 v134, v134
    v_exp_f32 v85, v85
    v_exp_f32 v125, v125
    v_exp_f32 v95, v95
    v_exp_f32 v135, v135
    v_exp_f32 v86, v86
    v_exp_f32 v126, v126
    v_exp_f32 v96, v96
    v_exp_f32 v136, v136
    v_exp_f32 v87, v87
    v_exp_f32 v127, v127
    v_exp_f32 v97, v97
    v_exp_f32 v137, v137
    v_exp_f32 v88, v88
    v_exp_f32 v128, v128
    v_exp_f32 v98, v98
    v_exp_f32 v138, v138
    v_pk_add_f32 v[112:113], v[80:81], v[82:83]
    v_pk_add_f32 v[152:153], v[120:121], v[122:123]
    v_pk_add_f32 v[114:115], v[90:91], v[92:93]
    v_pk_add_f32 v[154:155], v[130:131], v[132:133]
    v_pk_add_f32 v[112:113], v[112:113], v[84:85]
    v_pk_add_f32 v[152:153], v[152:153], v[124:125]
    v_pk_add_f32 v[114:115], v[114:115], v[94:95]
    v_pk_add_f32 v[154:155], v[154:155], v[134:135]
    v_pk_add_f32 v[112:113], v[112:113], v[86:87]
    v_pk_add_f32 v[152:153], v[152:153], v[126:127]
    v_pk_add_f32 v[114:115], v[114:115], v[96:97]
    v_pk_add_f32 v[154:155], v[154:155], v[136:137]
    v_add_f32 v112, v112, v113
    v_add_f32 v152, v152, v153
    v_add_f32 v114, v114, v115
    v_add_f32 v154, v154, v155
    v_add_f32 v112, v112, v88
    v_add_f32 v152, v152, v128
    v_add_f32 v114, v114, v98
    v_add_f32 v154, v154, v138
    v_mov_b32 v116, v112
    v_mov_b32 v156, v152
    v_mov_b32 v117, v114
    v_mov_b32 v157, v154
    v_permlane16_swap_b32 v112, v116
    v_permlane16_swap_b32 v152, v156
    v_permlane16_swap_b32 v114, v117
    v_permlane16_swap_b32 v154, v157
    v_add_f32 v112, v112, v116
    v_add_f32 v152, v152, v156
    v_add_f32 v114, v114, v117
    v_add_f32 v154, v154, v157
    v_rcp_f32 v112, v112
    v_rcp_f32 v152, v152
    v_rcp_f32 v114, v114
    v_rcp_f32 v154, v154
    v_pk_mul_f32 v[80:81], v[80:81], v[112:113] op_sel_hi:[1,0]
    v_pk_mul_f32 v[120:121], v[120:121], v[152:153] op_sel_hi:[1,0]
    v_pk_mul_f32 v[90:91], v[90:91], v[114:115] op_sel_hi:[1,0]
    v_pk_mul_f32 v[130:131], v[130:131], v[154:155] op_sel_hi:[1,0]
    v_pk_mul_f32 v[82:83], v[82:83], v[112:113] op_sel_hi:[1,0]
    v_pk_mul_f32 v[122:123], v[122:123], v[152:153] op_sel_hi:[1,0]
    v_pk_mul_f32 v[92:93], v[92:93], v[114:115] op_sel_hi:[1,0]
    v_pk_mul_f32 v[132:133], v[132:133], v[154:155] op_sel_hi:[1,0]
    v_pk_mul_f32 v[84:85], v[84:85], v[112:113] op_sel_hi:[1,0]
    v_pk_mul_f32 v[124:125], v[124:125], v[152:153] op_sel_hi:[1,0]
    v_pk_mul_f32 v[94:95], v[94:95], v[114:115] op_sel_hi:[1,0]
    v_pk_mul_f32 v[134:135], v[134:135], v[154:155] op_sel_hi:[1,0]
    v_pk_mul_f32 v[86:87], v[86:87], v[112:113] op_sel_hi:[1,0]
    v_pk_mul_f32 v[126:127], v[126:127], v[152:153] op_sel_hi:[1,0]
    v_pk_mul_f32 v[96:97], v[96:97], v[114:115] op_sel_hi:[1,0]
    v_pk_mul_f32 v[136:137], v[136:137], v[154:155] op_sel_hi:[1,0]
    v_pk_mul_f32 v[88:89], v[88:89], v[112:113] op_sel_hi:[1,0]
    v_pk_mul_f32 v[128:129], v[128:129], v[152:153] op_sel_hi:[1,0]
    v_pk_mul_f32 v[98:99], v[98:99], v[114:115] op_sel_hi:[1,0]
    v_pk_mul_f32 v[138:139], v[138:139], v[154:155] op_sel_hi:[1,0]
    v_cvt_pk_bf16_f32 v100, v80, v81
    v_cvt_pk_bf16_f32 v140, v120, v121
    v_cvt_pk_bf16_f32 v101, v82, v83
    v_cvt_pk_bf16_f32 v141, v122, v123
    v_cvt_pk_bf16_f32 v102, v84, v85
    v_cvt_pk_bf16_f32 v142, v124, v125
    v_cvt_pk_bf16_f32 v103, v86, v87
    v_cvt_pk_bf16_f32 v143, v126, v127
    v_cvt_pk_bf16_f32 v104, v88, v90
    v_cvt_pk_bf16_f32 v144, v128, v130
    v_cvt_pk_bf16_f32 v105, v91, v92
    v_cvt_pk_bf16_f32 v145, v131, v132
    v_cvt_pk_bf16_f32 v106, v93, v94
    v_cvt_pk_bf16_f32 v146, v133, v134
    v_cvt_pk_bf16_f32 v107, v95, v96
    v_cvt_pk_bf16_f32 v147, v135, v136
    v_cvt_pk_bf16_f32 v108, v97, v98
    v_cvt_pk_bf16_f32 v148, v137, v138
    v_mul_f32 v201, v9, v201
    v_mul_f32 v233, v11, v233
    v_pk_mul_f32 v[202:203], v[202:203], v[8:9] op_sel:[0,1] op_sel_hi:[1,1]
    v_pk_mul_f32 v[234:235], v[234:235], v[10:11] op_sel:[0,1] op_sel_hi:[1,1]
    v_pk_mul_f32 v[204:205], v[204:205], v[8:9] op_sel:[0,1] op_sel_hi:[1,1]
    v_pk_mul_f32 v[236:237], v[236:237], v[10:11] op_sel:[0,1] op_sel_hi:[1,1]
    v_pk_mul_f32 v[206:207], v[206:207], v[8:9] op_sel:[0,1] op_sel_hi:[1,1]
    v_pk_mul_f32 v[238:239], v[238:239], v[10:11] op_sel:[0,1] op_sel_hi:[1,1]
    v_pk_mul_f32 v[208:209], v[208:209], v[8:9] op_sel:[0,1] op_sel_hi:[1,1]
    v_pk_mul_f32 v[240:241], v[240:241], v[10:11] op_sel:[0,1] op_sel_hi:[1,1]
    v_cvt_pk_bf16_f32 v160, v201, v202
    v_cvt_pk_bf16_f32 v168, v233, v234
    v_cvt_pk_bf16_f32 v161, v203, v204
    v_cvt_pk_bf16_f32 v169, v235, v236
    v_cvt_pk_bf16_f32 v162, v205, v206
    v_cvt_pk_bf16_f32 v170, v237, v238
    v_cvt_pk_bf16_f32 v163, v207, v208
    v_cvt_pk_bf16_f32 v171, v239, v240
    v_cvt_pk_bf16_f32 v164, v209, v76
    v_cvt_pk_bf16_f32 v172, v241, v76
    s_cmp_lg_u32 s3, 0
    s_cbranch_scc1 mega_kernel_flc12
    s_cmp_lg_u32 s40, 0
    s_cbranch_scc1 mega_kernel_flc12
    v_min_u32 v176, 35, v1
    v_lshlrev_b32 v176, 2, v176
    v_and_b32 v177, 1, v2
    v_lshlrev_b32 v177, 11, v177
    v_lshl_add_u32 v177, v3, 2, v177
    s_lshl_b32 s52, s42, 8
    s_add_u32 s52, s52, 143360
    s_lshr_b32 s53, s42, 1
    s_lshl_b32 s53, s53, 8
    s_and_b32 s62, s42, 1
    s_lshl_b32 s62, s62, 6
    s_add_u32 s53, s53, s62
    s_add_u32 s53, s53, 139264
    s_lshr_b32 s61, s42, 2
    s_lshl_b32 s61, s61, 9
    s_add_u32 s61, s61, 147456
    s_mov_b32 s62, 0
mega_kernel_flp13:
    buffer_load_dword v178, v176, s[48:51], s52 offen sc1
    buffer_load_dword v179, v177, s[48:51], s53 offen sc1
    buffer_load_dword v180, v176, s[48:51], s61 offen sc1
    buffer_load_dword v181, v176, s[48:51], s61 offen offset:144 sc1
    s_add_u32 s62, s62, 1
    s_waitcnt vmcnt(0)
    v_xor_b32 v178, s2, v178
    v_xor_b32 v179, s2, v179
    v_xor_b32 v180, s2, v180
    v_xor_b32 v181, s2, v181
    v_or3_b32 v178, v178, v179, v180
    v_or_b32 v178, v178, v181
    v_cmp_ne_u32 vcc, 0, v178
    s_nop 0
    s_cmp_eq_u64 vcc, 0
    s_cbranch_scc1 mega_kernel_flc12
    s_cmp_lt_u32 s62, 262144
    s_sleep 2
    s_cbranch_scc1 mega_kernel_flp13
mega_kernel_flc12:
    s_nop 3
    s_barrier
    ds_write_b128 v68, v[100:103] offset:0
    ds_write_b128 v68, v[104:107] offset:16
    ds_write_b32 v68, v108 offset:32
    ds_write_b128 v69, v[160:163] offset:96
    ds_write_b32 v69, v164 offset:112
    ds_write_b128 v68, v[140:143] offset:2560
    ds_write_b128 v68, v[144:147] offset:2576
    ds_write_b32 v68, v148 offset:2592
    ds_write_b128 v69, v[168:171] offset:2656
    ds_write_b32 v69, v172 offset:2672
    s_waitcnt lgkmcnt(0)
    s_barrier
    ds_read_b64_tr_b16 v[80:81], v71 offset:96
    ds_read_b64_tr_b16 v[82:83], v71 offset:2656
    ds_read_b64_tr_b16 v[84:85], v70 offset:0
    ds_read_b64_tr_b16 v[86:87], v70 offset:2560
    ds_read_b64_tr_b16 v[88:89], v70 offset:32
    ds_read_b64_tr_b16 v[90:91], v70 offset:2592
    ds_read_b64_tr_b16 v[92:93], v70 offset:64
    ds_read_b64_tr_b16 v[94:95], v70 offset:2624
    ds_read_b64_tr_b16 v[96:97], v71 offset:5216
    ds_read_b64_tr_b16 v[98:99], v71 offset:7776
    ds_read_b64_tr_b16 v[100:101], v70 offset:5120
    ds_read_b64_tr_b16 v[102:103], v70 offset:7680
    ds_read_b64_tr_b16 v[104:105], v70 offset:5152
    ds_read_b64_tr_b16 v[106:107], v70 offset:7712
    ds_read_b64_tr_b16 v[108:109], v70 offset:5184
    ds_read_b64_tr_b16 v[110:111], v70 offset:7744
    ds_read_b64_tr_b16 v[112:113], v71 offset:10336
    ds_read_b64_tr_b16 v[114:115], v71 offset:12896
    ds_read_b64_tr_b16 v[116:117], v70 offset:10240
    ds_read_b64_tr_b16 v[118:119], v70 offset:12800
    ds_read_b64_tr_b16 v[120:121], v70 offset:10272
    ds_read_b64_tr_b16 v[122:123], v70 offset:12832
    ds_read_b64_tr_b16 v[124:125], v70 offset:10304
    ds_read_b64_tr_b16 v[126:127], v70 offset:12864
    ds_read_b64_tr_b16 v[128:129], v71 offset:15456
    ds_read_b64_tr_b16 v[130:131], v71 offset:18016
    ds_read_b64_tr_b16 v[132:133], v70 offset:15360
    ds_read_b64_tr_b16 v[134:135], v70 offset:17920
    ds_read_b64_tr_b16 v[136:137], v70 offset:15392
    ds_read_b64_tr_b16 v[138:139], v70 offset:17952
    ds_read_b64_tr_b16 v[140:141], v70 offset:15424
    ds_read_b64_tr_b16 v[142:143], v70 offset:17984
    s_waitcnt lgkmcnt(15)
    v_mfma_f32_16x16x32_bf16 v[144:147], v[80:83], v[84:87], 0
    v_mfma_f32_16x16x32_bf16 v[148:151], v[80:83], v[88:91], 0
    v_mfma_f32_16x16x32_bf16 v[152:155], v[80:83], v[92:95], 0
    v_mfma_f32_16x16x32_bf16 v[144:147], v[96:99], v[100:103], v[144:147]
    v_mfma_f32_16x16x32_bf16 v[148:151], v[96:99], v[104:107], v[148:151]
    v_mfma_f32_16x16x32_bf16 v[152:155], v[96:99], v[108:111], v[152:155]
    s_waitcnt lgkmcnt(12)
    v_mfma_f32_16x16x32_bf16 v[144:147], v[112:115], v[116:119], v[144:147]
    s_waitcnt lgkmcnt(10)
    v_mfma_f32_16x16x32_bf16 v[148:151], v[112:115], v[120:123], v[148:151]
    s_waitcnt lgkmcnt(8)
    v_mfma_f32_16x16x32_bf16 v[152:155], v[112:115], v[124:127], v[152:155]
    s_waitcnt lgkmcnt(4)
    v_mfma_f32_16x16x32_bf16 v[144:147], v[128:131], v[132:135], v[144:147]
    s_waitcnt lgkmcnt(2)
    v_mfma_f32_16x16x32_bf16 v[148:151], v[128:131], v[136:139], v[148:151]
    s_waitcnt lgkmcnt(0)
    v_mfma_f32_16x16x32_bf16 v[152:155], v[128:131], v[140:143], v[152:155]
    s_add_u32 s63, s3, 1
    s_and_b32 s61, s63, 1
    s_mul_i32 s62, s61, 2932736
    s_lshl_b32 s63, s42, 17
    s_add_u32 s62, s62, s63
    s_add_u32 s28, s22, s62
    s_addc_u32 s29, s23, 0
    s_mov_b32 s30, 131072
    s_mov_b32 s31, 0x00020000
    ds_read_b128 a[144:147], v7 offset:28672
    ds_read_b128 a[148:151], v7 offset:29696
    s_waitcnt lgkmcnt(0)
    v_mfma_f32_16x16x32_bf16 v[212:215], a[144:147], a[0:3], v[212:215]
    ds_read_b128 a[172:175], v7 offset:30720
    buffer_atomic_add_f32 v144, v72, s[64:67], 0 offen offset:0
    buffer_atomic_add_f32 v145, v73, s[64:67], 0 offen offset:192
    buffer_atomic_add_f32 v146, v74, s[64:67], 0 offen offset:384
    buffer_atomic_add_f32 v147, v75, s[64:67], 0 offen offset:576
    v_mfma_f32_16x16x32_bf16 v[244:247], a[144:147], a[72:75], v[244:247]
    s_mov_b64 exec, s[72:73]
    buffer_atomic_add_f32 v148, v72, s[64:67], 0 offen offset:64
    buffer_atomic_add_f32 v149, v73, s[64:67], 0 offen offset:256
    buffer_atomic_add_f32 v150, v74, s[64:67], 0 offen offset:448
    buffer_atomic_add_f32 v151, v75, s[64:67], 0 offen offset:640
    s_mov_b64 exec, -1
    s_nop 3
    v_mfma_f32_16x16x32_bf16 v[216:219], a[148:151], a[0:3], v[216:219]
    ds_read_b128 a[176:179], v7 offset:31744
    s_mov_b64 exec, s[74:75]
    buffer_atomic_add_f32 v152, v72, s[64:67], 0 offen offset:128
    buffer_atomic_add_f32 v153, v73, s[64:67], 0 offen offset:320
    buffer_atomic_add_f32 v154, v74, s[64:67], 0 offen offset:512
    buffer_atomic_add_f32 v155, v75, s[64:67], 0 offen offset:704
    s_mov_b64 exec, -1
    s_nop 3
    v_mfma_f32_16x16x32_bf16 v[248:251], a[148:151], a[72:75], v[248:251]
    s_waitcnt lgkmcnt(0)
    v_mfma_f32_16x16x32_bf16 v[212:215], a[172:175], a[4:7], v[212:215]
    ds_read_b128 a[144:147], v7 offset:32768
    v_mfma_f32_16x16x32_bf16 v[244:247], a[172:175], a[76:79], v[244:247]
    v_mfma_f32_16x16x32_bf16 v[216:219], a[176:179], a[4:7], v[216:219]
    ds_read_b128 a[148:151], v7 offset:33792
    v_mfma_f32_16x16x32_bf16 v[248:251], a[176:179], a[76:79], v[248:251]
    s_waitcnt lgkmcnt(0)
    v_mfma_f32_16x16x32_bf16 v[212:215], a[144:147], a[8:11], v[212:215]
    ds_read_b128 a[172:175], v7 offset:34816
    s_mul_i32 s52, s44, 4
    s_add_u32 s52, s52, 40960
    s_mov_b32 m0, s52
    s_nop 0
    buffer_load_dwordx4 v4, s[28:31], s52 offen offset:0 lds
    v_mfma_f32_16x16x32_bf16 v[244:247], a[144:147], a[80:83], v[244:247]
    v_mfma_f32_16x16x32_bf16 v[216:219], a[148:151], a[8:11], v[216:219]
    ds_read_b128 a[176:179], v7 offset:35840
    v_mfma_f32_16x16x32_bf16 v[248:251], a[148:151], a[80:83], v[248:251]
    s_waitcnt lgkmcnt(0)
    v_mfma_f32_16x16x32_bf16 v[212:215], a[172:175], a[12:15], v[212:215]
    ds_read_b128 a[144:147], v7 offset:36864
    buffer_load_dwordx4 v4, s[28:31], s52 offen offset:1024 lds
    v_mfma_f32_16x16x32_bf16 v[244:247], a[172:175], a[84:87], v[244:247]
    v_mfma_f32_16x16x32_bf16 v[216:219], a[176:179], a[12:15], v[216:219]
    ds_read_b128 a[148:151], v7 offset:37888
    v_mfma_f32_16x16x32_bf16 v[248:251], a[176:179], a[84:87], v[248:251]
    s_waitcnt lgkmcnt(0)
    v_mfma_f32_16x16x32_bf16 v[212:215], a[144:147], a[16:19], v[212:215]
    ds_read_b128 a[172:175], v7 offset:38912
    buffer_load_dwordx4 v4, s[28:31], s52 offen offset:2048 lds
    v_mfma_f32_16x16x32_bf16 v[244:247], a[144:147], a[88:91], v[244:247]
    v_mfma_f32_16x16x32_bf16 v[216:219], a[148:151], a[16:19], v[216:219]
    ds_read_b128 a[176:179], v7 offset:39936
    v_mfma_f32_16x16x32_bf16 v[248:251], a[148:151], a[88:91], v[248:251]
    s_waitcnt lgkmcnt(0)
    v_mfma_f32_16x16x32_bf16 v[212:215], a[172:175], a[20:23], v[212:215]
    ds_read_b128 a[144:147], v7 offset:40960
    buffer_load_dwordx4 v4, s[28:31], s52 offen offset:3072 lds
    v_mfma_f32_16x16x32_bf16 v[244:247], a[172:175], a[92:95], v[244:247]
    v_mfma_f32_16x16x32_bf16 v[216:219], a[176:179], a[20:23], v[216:219]
    ds_read_b128 a[148:151], v7 offset:41984
    v_mfma_f32_16x16x32_bf16 v[248:251], a[176:179], a[92:95], v[248:251]
    s_waitcnt lgkmcnt(0)
    v_mfma_f32_16x16x32_bf16 v[212:215], a[144:147], a[24:27], v[212:215]
    ds_read_b128 a[172:175], v7 offset:43008
    s_mul_i32 s52, s44, 4
    s_add_u32 s52, s52, 57344
    s_mov_b32 m0, s52
    s_nop 0
    buffer_load_dwordx4 v4, s[28:31], s52 offen offset:0 lds
    v_mfma_f32_16x16x32_bf16 v[244:247], a[144:147], a[96:99], v[244:247]
    v_mfma_f32_16x16x32_bf16 v[216:219], a[148:151], a[24:27], v[216:219]
    ds_read_b128 a[176:179], v7 offset:44032
    v_mfma_f32_16x16x32_bf16 v[248:251], a[148:151], a[96:99], v[248:251]
    s_waitcnt lgkmcnt(0)
    v_mfma_f32_16x16x32_bf16 v[212:215], a[172:175], a[28:31], v[212:215]
    ds_read_b128 a[144:147], v7 offset:45056
    buffer_load_dwordx4 v4, s[28:31], s52 offen offset:1024 lds
    v_mfma_f32_16x16x32_bf16 v[244:247], a[172:175], a[100:103], v[244:247]
    v_mfma_f32_16x16x32_bf16 v[216:219], a[176:179], a[28:31], v[216:219]
    ds_read_b128 a[148:151], v7 offset:46080
    v_mfma_f32_16x16x32_bf16 v[248:251], a[176:179], a[100:103], v[248:251]
    s_waitcnt lgkmcnt(0)
    v_mfma_f32_16x16x32_bf16 v[212:215], a[144:147], a[32:35], v[212:215]
    ds_read_b128 a[172:175], v7 offset:47104
    buffer_load_dwordx4 v4, s[28:31], s52 offen offset:2048 lds
    v_mfma_f32_16x16x32_bf16 v[244:247], a[144:147], a[104:107], v[244:247]
    v_mfma_f32_16x16x32_bf16 v[216:219], a[148:151], a[32:35], v[216:219]
    ds_read_b128 a[176:179], v7 offset:48128
    v_mfma_f32_16x16x32_bf16 v[248:251], a[148:151], a[104:107], v[248:251]
    s_waitcnt lgkmcnt(0)
    v_mfma_f32_16x16x32_bf16 v[212:215], a[172:175], a[36:39], v[212:215]
    ds_read_b128 a[144:147], v7 offset:49152
    buffer_load_dwordx4 v4, s[28:31], s52 offen offset:3072 lds
    v_mfma_f32_16x16x32_bf16 v[244:247], a[172:175], a[108:111], v[244:247]
    v_mfma_f32_16x16x32_bf16 v[216:219], a[176:179], a[36:39], v[216:219]
    ds_read_b128 a[148:151], v7 offset:50176
    v_mfma_f32_16x16x32_bf16 v[248:251], a[176:179], a[108:111], v[248:251]
    s_waitcnt lgkmcnt(0)
    v_mfma_f32_16x16x32_bf16 v[212:215], a[144:147], a[40:43], v[212:215]
    ds_read_b128 a[172:175], v7 offset:51200
    s_mul_i32 s52, s44, 4
    s_add_u32 s52, s52, 73728
    s_mov_b32 m0, s52
    s_nop 0
    buffer_load_dwordx4 v4, s[28:31], s52 offen offset:0 lds
    v_mfma_f32_16x16x32_bf16 v[244:247], a[144:147], a[112:115], v[244:247]
    v_mfma_f32_16x16x32_bf16 v[216:219], a[148:151], a[40:43], v[216:219]
    ds_read_b128 a[176:179], v7 offset:52224
    v_mfma_f32_16x16x32_bf16 v[248:251], a[148:151], a[112:115], v[248:251]
    s_waitcnt lgkmcnt(0)
    v_mfma_f32_16x16x32_bf16 v[212:215], a[172:175], a[44:47], v[212:215]
    ds_read_b128 a[144:147], v7 offset:53248
    buffer_load_dwordx4 v4, s[28:31], s52 offen offset:1024 lds
    v_mfma_f32_16x16x32_bf16 v[244:247], a[172:175], a[116:119], v[244:247]
    v_mfma_f32_16x16x32_bf16 v[216:219], a[176:179], a[44:47], v[216:219]
    ds_read_b128 a[148:151], v7 offset:54272
    v_mfma_f32_16x16x32_bf16 v[248:251], a[176:179], a[116:119], v[248:251]
    s_waitcnt lgkmcnt(0)
    v_mfma_f32_16x16x32_bf16 v[212:215], a[144:147], a[48:51], v[212:215]
    ds_read_b128 a[172:175], v7 offset:55296
    buffer_load_dwordx4 v4, s[28:31], s52 offen offset:2048 lds
    v_mfma_f32_16x16x32_bf16 v[244:247], a[144:147], a[120:123], v[244:247]
    v_mfma_f32_16x16x32_bf16 v[216:219], a[148:151], a[48:51], v[216:219]
    ds_read_b128 a[176:179], v7 offset:56320
    v_mfma_f32_16x16x32_bf16 v[248:251], a[148:151], a[120:123], v[248:251]
    s_waitcnt lgkmcnt(0)
    v_mfma_f32_16x16x32_bf16 v[212:215], a[172:175], a[52:55], v[212:215]
    ds_read_b128 a[144:147], v7 offset:57344
    buffer_load_dwordx4 v4, s[28:31], s52 offen offset:3072 lds
    v_mfma_f32_16x16x32_bf16 v[244:247], a[172:175], a[124:127], v[244:247]
    v_mfma_f32_16x16x32_bf16 v[216:219], a[176:179], a[52:55], v[216:219]
    ds_read_b128 a[148:151], v7 offset:58368
    v_mfma_f32_16x16x32_bf16 v[248:251], a[176:179], a[124:127], v[248:251]
    s_waitcnt lgkmcnt(0)
    v_mfma_f32_16x16x32_bf16 v[212:215], a[144:147], a[56:59], v[212:215]
    ds_read_b128 a[172:175], v7 offset:59392
    s_add_u32 s52, s44, 90112
    s_mov_b32 m0, s52
    s_nop 0
    buffer_load_dwordx4 v4, s[28:31], s52 offen offset:0 lds
    v_mfma_f32_16x16x32_bf16 v[244:247], a[144:147], a[128:131], v[244:247]
    v_mfma_f32_16x16x32_bf16 v[216:219], a[148:151], a[56:59], v[216:219]
    ds_read_b128 a[176:179], v7 offset:60416
    v_mfma_f32_16x16x32_bf16 v[248:251], a[148:151], a[128:131], v[248:251]
    s_waitcnt lgkmcnt(0)
    v_mfma_f32_16x16x32_bf16 v[212:215], a[172:175], a[60:63], v[212:215]
    ds_read_b128 a[144:147], v7 offset:61440
    v_mfma_f32_16x16x32_bf16 v[244:247], a[172:175], a[132:135], v[244:247]
    v_mfma_f32_16x16x32_bf16 v[216:219], a[176:179], a[60:63], v[216:219]
    ds_read_b128 a[148:151], v7 offset:62464
    v_mfma_f32_16x16x32_bf16 v[248:251], a[176:179], a[132:135], v[248:251]
    s_waitcnt lgkmcnt(0)
    v_mfma_f32_16x16x32_bf16 v[212:215], a[144:147], a[64:67], v[212:215]
    ds_read_b128 a[172:175], v7 offset:63488
    v_mfma_f32_16x16x32_bf16 v[244:247], a[144:147], a[136:139], v[244:247]
    v_mfma_f32_16x16x32_bf16 v[216:219], a[148:151], a[64:67], v[216:219]
    ds_read_b128 a[176:179], v7 offset:64512
    v_mfma_f32_16x16x32_bf16 v[248:251], a[148:151], a[136:139], v[248:251]
    s_waitcnt lgkmcnt(0)
    v_mfma_f32_16x16x32_bf16 v[212:215], a[172:175], a[68:71], v[212:215]
    v_mfma_f32_16x16x32_bf16 v[244:247], a[172:175], a[140:143], v[244:247]
    v_mfma_f32_16x16x32_bf16 v[216:219], a[176:179], a[68:71], v[216:219]
    v_mfma_f32_16x16x32_bf16 v[248:251], a[176:179], a[140:143], v[248:251]
    s_mov_b32 s0, s78
    s_waitcnt vmcnt(13) lgkmcnt(0)
    s_barrier
    s_cmp_lg_u32 s40, 0
    s_cbranch_scc1 mega_kernel_nosig14
    v_mov_b32 v5, s2
    s_mov_b64 exec, 1
    buffer_store_dword v5, off, s[48:51], s0 sc1
    s_mov_b64 exec, -1
mega_kernel_nosig14:
    s_nop 3
    s_cmp_lg_u32 s3, 0
    s_cbranch_scc1 mega_kernel_wo015
    s_cmp_eq_u32 s40, 0
    s_cbranch_scc1 mega_kernel_nopf16
    s_mul_i32 s52, s44, 4
    s_add_u32 s52, s52, -4096
    s_add_u32 m0, s52, 131072
    s_nop 0
    buffer_load_dwordx4 v4, s[80:83], s52 offen offset:0 lds
    buffer_load_dwordx4 v4, s[80:83], s52 offen offset:1024 lds
    buffer_load_dwordx4 v4, s[80:83], s52 offen offset:2048 lds
    buffer_load_dwordx4 v4, s[80:83], s52 offen offset:3072 lds
    s_mul_i32 s52, s44, 4
    s_add_u32 s52, s52, 8192
    s_add_u32 m0, s52, 131072
    s_nop 0
    buffer_load_dwordx4 v4, s[80:83], s52 offen offset:0 lds
    buffer_load_dwordx4 v4, s[80:83], s52 offen offset:1024 lds
    buffer_load_dwordx4 v4, s[80:83], s52 offen offset:2048 lds
    buffer_load_dwordx4 v4, s[80:83], s52 offen offset:3072 lds
    s_mul_i32 s52, s44, 2
    s_add_u32 s52, s52, 22528
    s_add_u32 m0, s52, 131072
    s_nop 0
    buffer_load_dwordx4 v4, s[80:83], s52 offen offset:0 lds
    buffer_load_dwordx4 v4, s[80:83], s52 offen offset:1024 lds
mega_kernel_nopf16:
    s_nop 1
mega_kernel_wo015:
    s_cmp_eq_u32 s40, 0
    s_cbranch_scc1 mega_kernel_nopf17
    s_mul_i32 s52, s44, 4
    s_add_u32 s52, s52, 26624
    s_add_u32 m0, s52, 88064
    s_nop 0
    buffer_load_dwordx4 v4, s[80:83], s52 offen offset:0 lds
    buffer_load_dwordx4 v4, s[80:83], s52 offen offset:1024 lds
    buffer_load_dwordx4 v4, s[80:83], s52 offen offset:2048 lds
    buffer_load_dwordx4 v4, s[80:83], s52 offen offset:3072 lds
    s_mul_i32 s52, s44, 4
    s_add_u32 s52, s52, -4096
    s_mov_b32 m0, s52
    s_nop 0
    buffer_load_dwordx4 v4, s[28:31], s52 offen offset:0 lds
    buffer_load_dwordx4 v4, s[28:31], s52 offen offset:1024 lds
    buffer_load_dwordx4 v4, s[28:31], s52 offen offset:2048 lds
    buffer_load_dwordx4 v4, s[28:31], s52 offen offset:3072 lds
    s_mul_i32 s52, s44, 4
    s_add_u32 s52, s52, 8192
    s_mov_b32 m0, s52
    s_nop 0
    buffer_load_dwordx4 v4, s[28:31], s52 offen offset:0 lds
    buffer_load_dwordx4 v4, s[28:31], s52 offen offset:1024 lds
    buffer_load_dwordx4 v4, s[28:31], s52 offen offset:2048 lds
    buffer_load_dwordx4 v4, s[28:31], s52 offen offset:3072 lds
    s_mul_i32 s52, s44, 4
    s_add_u32 s52, s52, 20480
    s_mov_b32 m0, s52
    s_nop 0
    buffer_load_dwordx4 v4, s[28:31], s52 offen offset:0 lds
    buffer_load_dwordx4 v4, s[28:31], s52 offen offset:1024 lds
    buffer_load_dwordx4 v4, s[28:31], s52 offen offset:2048 lds
    buffer_load_dwordx4 v4, s[28:31], s52 offen offset:3072 lds
    s_mul_i32 s52, s44, 2
    s_add_u32 s52, s52, 34816
    s_min_u32 s52, s52, 38912
    s_mov_b32 m0, s52
    s_nop 0
    buffer_load_dwordx4 v4, s[28:31], s52 offen offset:0 lds
    buffer_load_dwordx4 v4, s[28:31], s52 offen offset:1024 lds
    s_add_u32 s52, s44, 93184
    s_min_u32 s52, s52, 95232
    s_mov_b32 m0, s52
    s_nop 0
    buffer_load_dwordx4 v4, s[28:31], s52 offen offset:0 lds
    s_mul_i32 s52, s44, 4
    s_add_u32 s52, s52, 101376
    s_mov_b32 m0, s52
    s_nop 0
    buffer_load_dwordx4 v4, s[28:31], s52 offen offset:0 lds
    buffer_load_dwordx4 v4, s[28:31], s52 offen offset:1024 lds
    buffer_load_dwordx4 v4, s[28:31], s52 offen offset:2048 lds
    buffer_load_dwordx4 v4, s[28:31], s52 offen offset:3072 lds
    s_add_u32 s52, s44, 116736
    s_min_u32 s52, s52, 117760
    s_mov_b32 m0, s52
    s_nop 0
    buffer_load_dwordx4 v4, s[28:31], s52 offen offset:0 lds
mega_kernel_nopf17:
    s_nop 1
    v_max3_f32 v112, v210, v211, v212
    v_max3_f32 v152, v242, v243, v244
    v_min3_f32 v114, v210, v211, v212
    v_min3_f32 v154, v242, v243, v244
    v_max3_f32 v112, v112, v213, v214
    v_max3_f32 v152, v152, v245, v246
    v_min3_f32 v114, v114, v213, v214
    v_min3_f32 v154, v154, v245, v246
    v_max3_f32 v112, v112, v215, v216
    v_max3_f32 v152, v152, v247, v248
    v_min3_f32 v114, v114, v215, v216
    v_min3_f32 v154, v154, v247, v248
    v_max3_f32 v112, v112, v217, v218
    v_max3_f32 v152, v152, v249, v250
    v_min3_f32 v114, v114, v217, v218
    v_min3_f32 v154, v154, v249, v250
    v_mov_b32 v116, v112
    v_mov_b32 v156, v152
    v_mov_b32 v117, v114
    v_mov_b32 v157, v154
    v_permlane16_swap_b32 v112, v116
    v_permlane16_swap_b32 v152, v156
    v_permlane16_swap_b32 v114, v117
    v_permlane16_swap_b32 v154, v157
    v_max_f32 v112, v112, v116
    v_max_f32 v152, v152, v156
    v_min_f32 v114, v114, v117
    v_min_f32 v154, v154, v157
    v_mul_f32 v112, v34, v112
    v_mul_f32 v152, v36, v152
    v_mul_f32 v114, v34, v114
    v_mul_f32 v154, v36, v154
    v_pk_fma_f32 v[80:81], v[210:211], v[34:35], v[112:113] op_sel_hi:[1,1,0] neg_lo:[0,0,1] neg_hi:[0,0,1]
    v_pk_fma_f32 v[120:121], v[242:243], v[36:37], v[152:153] op_sel_hi:[1,1,0] neg_lo:[0,0,1] neg_hi:[0,0,1]
    v_pk_fma_f32 v[90:91], v[210:211], v[34:35], v[114:115] op_sel_hi:[1,1,0] neg_lo:[1,0,0] neg_hi:[1,0,0]
    v_pk_fma_f32 v[130:131], v[242:243], v[36:37], v[154:155] op_sel_hi:[1,1,0] neg_lo:[1,0,0] neg_hi:[1,0,0]
    v_pk_fma_f32 v[82:83], v[212:213], v[34:35], v[112:113] op_sel_hi:[1,1,0] neg_lo:[0,0,1] neg_hi:[0,0,1]
    v_pk_fma_f32 v[122:123], v[244:245], v[36:37], v[152:153] op_sel_hi:[1,1,0] neg_lo:[0,0,1] neg_hi:[0,0,1]
    v_pk_fma_f32 v[92:93], v[212:213], v[34:35], v[114:115] op_sel_hi:[1,1,0] neg_lo:[1,0,0] neg_hi:[1,0,0]
    v_pk_fma_f32 v[132:133], v[244:245], v[36:37], v[154:155] op_sel_hi:[1,1,0] neg_lo:[1,0,0] neg_hi:[1,0,0]
    v_pk_fma_f32 v[84:85], v[214:215], v[34:35], v[112:113] op_sel_hi:[1,1,0] neg_lo:[0,0,1] neg_hi:[0,0,1]
    v_pk_fma_f32 v[124:125], v[246:247], v[36:37], v[152:153] op_sel_hi:[1,1,0] neg_lo:[0,0,1] neg_hi:[0,0,1]
    v_pk_fma_f32 v[94:95], v[214:215], v[34:35], v[114:115] op_sel_hi:[1,1,0] neg_lo:[1,0,0] neg_hi:[1,0,0]
    v_pk_fma_f32 v[134:135], v[246:247], v[36:37], v[154:155] op_sel_hi:[1,1,0] neg_lo:[1,0,0] neg_hi:[1,0,0]
    v_pk_fma_f32 v[86:87], v[216:217], v[34:35], v[112:113] op_sel_hi:[1,1,0] neg_lo:[0,0,1] neg_hi:[0,0,1]
    v_pk_fma_f32 v[126:127], v[248:249], v[36:37], v[152:153] op_sel_hi:[1,1,0] neg_lo:[0,0,1] neg_hi:[0,0,1]
    v_pk_fma_f32 v[96:97], v[216:217], v[34:35], v[114:115] op_sel_hi:[1,1,0] neg_lo:[1,0,0] neg_hi:[1,0,0]
    v_pk_fma_f32 v[136:137], v[248:249], v[36:37], v[154:155] op_sel_hi:[1,1,0] neg_lo:[1,0,0] neg_hi:[1,0,0]
    v_pk_fma_f32 v[88:89], v[218:219], v[34:35], v[112:113] op_sel_hi:[1,1,0] neg_lo:[0,0,1] neg_hi:[0,0,1]
    v_pk_fma_f32 v[128:129], v[250:251], v[36:37], v[152:153] op_sel_hi:[1,1,0] neg_lo:[0,0,1] neg_hi:[0,0,1]
    v_pk_fma_f32 v[98:99], v[218:219], v[34:35], v[114:115] op_sel_hi:[1,1,0] neg_lo:[1,0,0] neg_hi:[1,0,0]
    v_pk_fma_f32 v[138:139], v[250:251], v[36:37], v[154:155] op_sel_hi:[1,1,0] neg_lo:[1,0,0] neg_hi:[1,0,0]
    v_exp_f32 v80, v80
    v_exp_f32 v120, v120
    v_exp_f32 v90, v90
    v_exp_f32 v130, v130
    v_exp_f32 v81, v81
    v_exp_f32 v121, v121
    v_exp_f32 v91, v91
    v_exp_f32 v131, v131
    v_exp_f32 v82, v82
    v_exp_f32 v122, v122
    v_exp_f32 v92, v92
    v_exp_f32 v132, v132
    v_exp_f32 v83, v83
    v_exp_f32 v123, v123
    v_exp_f32 v93, v93
    v_exp_f32 v133, v133
    v_exp_f32 v84, v84
    v_exp_f32 v124, v124
    v_exp_f32 v94, v94
    v_exp_f32 v134, v134
    v_exp_f32 v85, v85
    v_exp_f32 v125, v125
    v_exp_f32 v95, v95
    v_exp_f32 v135, v135
    v_exp_f32 v86, v86
    v_exp_f32 v126, v126
    v_exp_f32 v96, v96
    v_exp_f32 v136, v136
    v_exp_f32 v87, v87
    v_exp_f32 v127, v127
    v_exp_f32 v97, v97
    v_exp_f32 v137, v137
    v_exp_f32 v88, v88
    v_exp_f32 v128, v128
    v_exp_f32 v98, v98
    v_exp_f32 v138, v138
    v_pk_add_f32 v[112:113], v[80:81], v[82:83]
    v_pk_add_f32 v[152:153], v[120:121], v[122:123]
    v_pk_add_f32 v[114:115], v[90:91], v[92:93]
    v_pk_add_f32 v[154:155], v[130:131], v[132:133]
    v_pk_add_f32 v[112:113], v[112:113], v[84:85]
    v_pk_add_f32 v[152:153], v[152:153], v[124:125]
    v_pk_add_f32 v[114:115], v[114:115], v[94:95]
    v_pk_add_f32 v[154:155], v[154:155], v[134:135]
    v_pk_add_f32 v[112:113], v[112:113], v[86:87]
    v_pk_add_f32 v[152:153], v[152:153], v[126:127]
    v_pk_add_f32 v[114:115], v[114:115], v[96:97]
    v_pk_add_f32 v[154:155], v[154:155], v[136:137]
    v_add_f32 v112, v112, v113
    v_add_f32 v152, v152, v153
    v_add_f32 v114, v114, v115
    v_add_f32 v154, v154, v155
    v_add_f32 v112, v112, v88
    v_add_f32 v152, v152, v128
    v_add_f32 v114, v114, v98
    v_add_f32 v154, v154, v138
    v_mov_b32 v116, v112
    v_mov_b32 v156, v152
    v_mov_b32 v117, v114
    v_mov_b32 v157, v154
    v_permlane16_swap_b32 v112, v116
    v_permlane16_swap_b32 v152, v156
    v_permlane16_swap_b32 v114, v117
    v_permlane16_swap_b32 v154, v157
    v_add_f32 v112, v112, v116
    v_add_f32 v152, v152, v156
    v_add_f32 v114, v114, v117
    v_add_f32 v154, v154, v157
    v_rcp_f32 v112, v112
    v_rcp_f32 v152, v152
    v_rcp_f32 v114, v114
    v_rcp_f32 v154, v154
    v_pk_mul_f32 v[80:81], v[80:81], v[112:113] op_sel_hi:[1,0]
    v_pk_mul_f32 v[120:121], v[120:121], v[152:153] op_sel_hi:[1,0]
    v_pk_mul_f32 v[90:91], v[90:91], v[114:115] op_sel_hi:[1,0]
    v_pk_mul_f32 v[130:131], v[130:131], v[154:155] op_sel_hi:[1,0]
    v_pk_mul_f32 v[82:83], v[82:83], v[112:113] op_sel_hi:[1,0]
    v_pk_mul_f32 v[122:123], v[122:123], v[152:153] op_sel_hi:[1,0]
    v_pk_mul_f32 v[92:93], v[92:93], v[114:115] op_sel_hi:[1,0]
    v_pk_mul_f32 v[132:133], v[132:133], v[154:155] op_sel_hi:[1,0]
    v_pk_mul_f32 v[84:85], v[84:85], v[112:113] op_sel_hi:[1,0]
    v_pk_mul_f32 v[124:125], v[124:125], v[152:153] op_sel_hi:[1,0]
    v_pk_mul_f32 v[94:95], v[94:95], v[114:115] op_sel_hi:[1,0]
    v_pk_mul_f32 v[134:135], v[134:135], v[154:155] op_sel_hi:[1,0]
    v_pk_mul_f32 v[86:87], v[86:87], v[112:113] op_sel_hi:[1,0]
    v_pk_mul_f32 v[126:127], v[126:127], v[152:153] op_sel_hi:[1,0]
    v_pk_mul_f32 v[96:97], v[96:97], v[114:115] op_sel_hi:[1,0]
    v_pk_mul_f32 v[136:137], v[136:137], v[154:155] op_sel_hi:[1,0]
    v_pk_mul_f32 v[88:89], v[88:89], v[112:113] op_sel_hi:[1,0]
    v_pk_mul_f32 v[128:129], v[128:129], v[152:153] op_sel_hi:[1,0]
    v_pk_mul_f32 v[98:99], v[98:99], v[114:115] op_sel_hi:[1,0]
    v_pk_mul_f32 v[138:139], v[138:139], v[154:155] op_sel_hi:[1,0]
    v_cvt_pk_bf16_f32 v100, v80, v81
    v_cvt_pk_bf16_f32 v140, v120, v121
    v_cvt_pk_bf16_f32 v101, v82, v83
    v_cvt_pk_bf16_f32 v141, v122, v123
    v_cvt_pk_bf16_f32 v102, v84, v85
    v_cvt_pk_bf16_f32 v142, v124, v125
    v_cvt_pk_bf16_f32 v103, v86, v87
    v_cvt_pk_bf16_f32 v143, v126, v127
    v_cvt_pk_bf16_f32 v104, v88, v90
    v_cvt_pk_bf16_f32 v144, v128, v130
    v_cvt_pk_bf16_f32 v105, v91, v92
    v_cvt_pk_bf16_f32 v145, v131, v132
    v_cvt_pk_bf16_f32 v106, v93, v94
    v_cvt_pk_bf16_f32 v146, v133, v134
    v_cvt_pk_bf16_f32 v107, v95, v96
    v_cvt_pk_bf16_f32 v147, v135, v136
    v_cvt_pk_bf16_f32 v108, v97, v98
    v_cvt_pk_bf16_f32 v148, v137, v138
    v_mov_b32 v109, 0
    v_mov_b32 v110, 0
    v_mov_b32 v111, 0
    v_mov_b32 v149, 0
    v_mov_b32 v150, 0
    v_mov_b32 v151, 0
    v_mov_b32 v25, 0
    v_mov_b32 v26, 0
    v_mov_b32 v27, 0
    v_mov_b32 v37, 0
    v_mov_b32 v38, 0
    v_mov_b32 v39, 0
    v_mov_b32 v49, 0
    v_mov_b32 v50, 0
    v_mov_b32 v51, 0
    v_accvgpr_read_b32 v60, a213
    v_accvgpr_read_b32 v61, a212
    s_mul_i32 s61, s40, 3072
    s_add_u32 s61, s61, 96256
    v_add_u32 v62, s61, v4
    s_cmp_lg_u32 s3, 0
    s_cbranch_scc1 mega_kernel_modeok18
    s_lshl_b32 s61, s41, 8
    s_add_u32 s61, s61, 65536
    v_lshlrev_b32 v9, 2, v3
    s_getreg_b32 s63, hwreg(HW_REG_XCC_ID, 0, 4)
    s_add_u32 s63, s63, 1
    s_mov_b32 s62, 0
mega_kernel_modep19:
    buffer_load_dword v5, v9, s[48:51], s61 offen sc1
    s_add_u32 s62, s62, 1
    s_waitcnt vmcnt(0)
    v_subrev_u32 v5, s2, v5
    v_cmp_ne_u32 vcc, s63, v5
    s_nop 0
    s_cmp_eq_u64 vcc, 0
    s_cselect_b32 s56, 1, 0
    v_add_u32 v5, -1, v5
    v_cmp_lt_u32 vcc, 15, v5
    s_nop 0
    s_cmp_eq_u64 vcc, 0
    s_cbranch_scc1 mega_kernel_modeok18
    s_cmp_lt_u32 s62, 262144
    s_sleep 4
    s_cbranch_scc1 mega_kernel_modep19
mega_kernel_modeok18:
    s_nop 3
    s_mov_b32 s14, 0xffff
    s_mov_b32 s15, 0
    v_lshlrev_b32 v63, 2, v3
    s_cmp_lg_u32 s40, 0
    s_cbranch_scc1 mega_kernel_nopoll20
    s_mov_b32 s62, 0
mega_kernel_poll21:
    buffer_load_dword v5, v63, s[48:51], s76 offen sc1
    s_add_u32 s62, s62, 1
    s_waitcnt vmcnt(0)
    v_cmp_ne_u32 vcc, s2, v5
    s_nop 0
    s_and_b64 vcc, vcc, s[14:15]
    s_cbranch_scc0 mega_kernel_nopoll20
    s_cmp_lt_u32 s62, 262144
    s_sleep 1
    s_cbranch_scc1 mega_kernel_poll21
mega_kernel_nopoll20:
    s_waitcnt vmcnt(0) lgkmcnt(0)
    s_barrier
    s_cmp_ge_u32 s40, 3
    s_cbranch_scc1 mega_kernel_nobuild22
    buffer_load_dwordx4 v[160:163], v60, s[64:67], 0 offen offset:0 sc1
    buffer_load_dwordx4 v[164:167], v60, s[64:67], 0 offen offset:16 sc1
    buffer_load_dwordx4 v[168:171], v60, s[64:67], 0 offen offset:32 sc1
    buffer_load_dwordx4 v[172:175], v60, s[64:67], 0 offen offset:48 sc1
    buffer_load_dwordx2 v[176:177], v60, s[64:67], 0 offen offset:64 sc1
    s_waitcnt vmcnt(0)
    v_cvt_pk_bf16_f32 v180, v160, v161
    v_cvt_pk_bf16_f32 v181, v162, v163
    v_cvt_pk_bf16_f32 v182, v164, v165
    v_cvt_pk_bf16_f32 v183, v166, v167
    v_cvt_pk_bf16_f32 v184, v168, v169
    v_cvt_pk_bf16_f32 v185, v170, v171
    v_cvt_pk_bf16_f32 v186, v172, v173
    v_cvt_pk_bf16_f32 v187, v174, v175
    v_cvt_pk_bf16_f32 v188, v176, v177
    ds_write_b128 v62, v[180:183]
    ds_write_b128 v62, v[184:187] offset:1024
    ds_write_b32 v62, v188 offset:2048
    s_waitcnt lgkmcnt(0)
mega_kernel_nobuild22:
    s_barrier
    ds_read_b128 v[40:43], v7 offset:36864
    ds_read_b128 v[44:47], v7 offset:37888
    ds_read_b32 v48, v7 offset:38912
    ds_read_b128 v[16:19], v7 offset:30720
    ds_read_b128 v[20:23], v7 offset:31744
    ds_read_b32 v24, v7 offset:32768
    ds_read_b128 v[28:31], v7 offset:33792
    ds_read_b128 v[32:35], v7 offset:34816
    ds_read_b32 v36, v7 offset:35840
    s_waitcnt lgkmcnt(6)
    v_mfma_f32_16x16x32_bf16 v[200:203], v[40:43], v[100:103], 0
    v_mfma_f32_16x16x32_bf16 v[232:235], v[40:43], v[140:143], 0
    v_mfma_f32_16x16x32_bf16 v[200:203], v[44:47], v[104:107], v[200:203]
    v_mfma_f32_16x16x32_bf16 v[232:235], v[44:47], v[144:147], v[232:235]
    v_mfma_f32_16x16x32_bf16 v[200:203], v[48:51], v[108:111], v[200:203]
    v_mfma_f32_16x16x32_bf16 v[232:235], v[48:51], v[148:151], v[232:235]
    s_waitcnt lgkmcnt(3)
    v_mfma_f32_16x16x32_bf16 v[192:195], v[16:19], v[100:103], 0
    v_mfma_f32_16x16x32_bf16 v[224:227], v[16:19], v[140:143], 0
    v_mfma_f32_16x16x32_bf16 v[192:195], v[20:23], v[104:107], v[192:195]
    v_mfma_f32_16x16x32_bf16 v[224:227], v[20:23], v[144:147], v[224:227]
    v_mfma_f32_16x16x32_bf16 v[192:195], v[24:27], v[108:111], v[192:195]
    v_mfma_f32_16x16x32_bf16 v[224:227], v[24:27], v[148:151], v[224:227]
    s_waitcnt lgkmcnt(0)
    v_mfma_f32_16x16x32_bf16 v[196:199], v[28:31], v[100:103], 0
    v_mfma_f32_16x16x32_bf16 v[228:231], v[28:31], v[140:143], 0
    v_mfma_f32_16x16x32_bf16 v[196:199], v[32:35], v[104:107], v[196:199]
    v_mfma_f32_16x16x32_bf16 v[228:231], v[32:35], v[144:147], v[228:231]
    v_mfma_f32_16x16x32_bf16 v[196:199], v[36:39], v[108:111], v[196:199]
    v_mfma_f32_16x16x32_bf16 v[228:231], v[36:39], v[148:151], v[228:231]
    v_add_f32 v69, 0x358637bd, v201
    v_add_f32 v77, 0x358637bd, v233
    v_rcp_f32 v69, v69
    v_rcp_f32 v77, v77
    v_mul_f32 v192, v69, v192
    v_mul_f32 v224, v77, v224
    v_mul_f32 v193, v69, v193
    v_mul_f32 v225, v77, v225
    v_mul_f32 v194, v69, v194
    v_mul_f32 v226, v77, v226
    v_mul_f32 v195, v69, v195
    v_mul_f32 v227, v77, v227
    v_mul_f32 v196, v69, v196
    v_mul_f32 v228, v77, v228
    v_mul_f32 v197, v69, v197
    v_mul_f32 v229, v77, v229
    v_mul_f32 v198, v69, v198
    v_mul_f32 v230, v77, v230
    v_mul_f32 v199, v69, v199
    v_mul_f32 v231, v77, v231
    v_mul_f32 v200, v69, v200
    v_mul_f32 v232, v77, v232
    v_cvt_pk_bf16_f32 v64, v192, v193
    v_cvt_pk_bf16_f32 v72, v224, v225
    v_cvt_pk_bf16_f32 v65, v194, v195
    v_cvt_pk_bf16_f32 v73, v226, v227
    v_cvt_pk_bf16_f32 v66, v196, v197
    v_cvt_pk_bf16_f32 v74, v228, v229
    v_cvt_pk_bf16_f32 v67, v198, v199
    v_cvt_pk_bf16_f32 v75, v230, v231
    v_cvt_pk_bf16_f32 v68, v200, v200
    v_cvt_pk_bf16_f32 v76, v232, v232
    s_cmp_eq_u32 s56, 0
    s_cbranch_scc1 mega_kernel_stg23
    buffer_store_dwordx4 v[64:67], v4, s[68:71], s4 offen
    buffer_store_dwordx4 v[72:75], v4, s[68:71], s5 offen
    buffer_store_short v68, v61, s[68:71], s101 offen
    buffer_store_short v76, v61, s[68:71], s6 offen
    s_branch mega_kernel_std24
mega_kernel_stg23:
    buffer_store_dwordx4 v[64:67], v4, s[68:71], s4 offen sc1
    buffer_store_dwordx4 v[72:75], v4, s[68:71], s5 offen sc1
    buffer_store_short v68, v61, s[68:71], s101 offen sc1
    buffer_store_short v76, v61, s[68:71], s6 offen sc1
mega_kernel_std24:
    s_mov_b32 s0, s77
    s_mul_i32 s46, s43, 18432
    s_add_u32 s46, s46, s45
    s_add_u32 s24, s22, 9146368
    s_addc_u32 s25, s23, 0
    s_add_u32 s24, s24, s46
    s_addc_u32 s25, s25, 0
    s_mov_b32 s26, 36864
    s_mov_b32 s27, 0x00020000
    s_add_u32 s32, s22, 6524928
    s_addc_u32 s33, s23, 0
    s_add_u32 s32, s32, s46
    s_addc_u32 s33, s33, 0
    s_mov_b32 s34, 36864
    s_mov_b32 s35, 0x00020000
    v_accvgpr_read_b32 v24, a224
    v_accvgpr_read_b32 v25, a226
    v_accvgpr_read_b32 v26, a228
    s_movk_i32 s88, 18432
    buffer_load_dwordx2 v[32:33], v24, s[32:35], 0 offen sc1
    buffer_load_dwordx2 v[34:35], v25, s[32:35], 0 offen sc1
    buffer_load_dwordx2 v[36:37], v26, s[32:35], 0 offen sc1
    buffer_load_dwordx2 v[40:41], v24, s[32:35], s88 offen sc1
    buffer_load_dwordx2 v[42:43], v25, s[32:35], s88 offen sc1
    buffer_load_dwordx2 v[44:45], v26, s[32:35], s88 offen sc1
    s_add_u32 s61, s46, 4980736
    s_add_u32 s36, s22, 6524928
    s_addc_u32 s37, s23, 0
    s_add_u32 s36, s36, s61
    s_addc_u32 s37, s37, 0
    s_mov_b32 s38, 36864
    s_mov_b32 s39, 0x00020000
    s_lshl_b32 s61, s43, 11
    s_add_u32 s61, s61, s45
    s_add_u32 s61, s61, 4980736
    s_add_u32 s64, s22, 8884224
    s_addc_u32 s65, s23, 0
    s_add_u32 s64, s64, s61
    s_addc_u32 s65, s65, 0
    s_mov_b32 s66, 4096
    s_mov_b32 s67, 0x00020000
    s_mul_i32 s61, s43, 18432
    s_add_u32 s68, s18, s61
    s_addc_u32 s69, s19, 0
    s_mov_b32 s70, 36864
    s_mov_b32 s71, 0x00020000
    s_mov_b32 s84, 20480
    s_mov_b32 s85, 24576
    s_mov_b32 s86, 28672
    s_mov_b32 s87, 32768
    s_add_u32 s92, s22, s45
    s_addc_u32 s93, s23, 0
    s_mov_b32 s94, 16486400
    s_mov_b32 s95, 0x00020000
    v_accvgpr_read_b32 v29, a201
    v_cmp_eq_u32 s[72:73], 0, v2
    v_and_b32 v30, 3, v3
    v_lshlrev_b32 v30, 4, v30
    v_lshl_add_u32 v30, v2, 6, v30
    v_add_u32 v31, 0x20000, v30
    v_add_u32 v30, 0x10000, v30
    v_accvgpr_read_b32 v27, a230
    v_accvgpr_read_b32 v28, a222
    s_lshl_b32 s76, s3, 13
    s_lshl_b32 s62, s41, 8
    s_add_u32 s76, s76, s62
    s_add_u32 s74, s76, 200704
    s_lshl_b32 s62, s42, 2
    s_add_u32 s76, s76, s62
    s_mov_b32 s14, 0xffff
    s_mov_b32 s15, 0
    s_waitcnt vmcnt(6) lgkmcnt(0)
    s_barrier
    s_cmp_lg_u32 s40, 0
    s_cbranch_scc1 mega_kernel_nosig25
    v_mov_b32 v5, s2
    s_mov_b64 exec, 1
    s_cmp_eq_u32 s56, 0
    s_cbranch_scc1 mega_kernel_stg26
    buffer_store_dword v5, off, s[48:51], s0
    s_branch mega_kernel_std27
mega_kernel_stg26:
    buffer_store_dword v5, off, s[48:51], s0 sc1
mega_kernel_std27:
    s_mov_b64 exec, -1
mega_kernel_nosig25:
    s_nop 3
    s_branch mega_out
mega_b:
    s_nop 3
    s_cmp_lg_u32 s3, 1
    s_cbranch_scc1 mega_kernel_nocs28
    s_waitcnt vmcnt(0)
    s_barrier
    v_mov_b32 v176, 0x3f803f80
    v_mov_b32 v177, 0x3f803f80
    v_mov_b32 v178, 0x3f803f80
    v_mov_b32 v179, 0x3f803f80
    s_add_u32 s61, s40, 4
    s_min_u32 s61, s61, 6
    s_lshl_b32 s62, s61, 10
    s_movk_i32 s63, 7168
    s_mov_b32 s52, s63
    v_add_u32 v180, s44, v4
    v_add_u32 v181, s62, v4
    ds_read_b128 a[144:147], v180
    v_add_u32 v180, s63, v180
    ds_read_b128 a[148:151], v181
    v_add_u32 v181, s52, v181
    ds_read_b128 a[152:155], v180
    v_add_u32 v180, s63, v180
    ds_read_b128 a[156:159], v181
    v_add_u32 v181, s52, v181
    ds_read_b128 a[160:163], v180
    v_add_u32 v180, s63, v180
    ds_read_b128 a[164:167], v181
    v_add_u32 v181, s52, v181
    ds_read_b128 a[168:171], v180
    v_add_u32 v180, s63, v180
    ds_read_b128 a[172:175], v181
    v_add_u32 v181, s52, v181
    ds_read_b128 a[176:179], v180
    v_add_u32 v180, s63, v180
    ds_read_b128 a[180:183], v181
    v_add_u32 v181, s52, v181
    s_waitcnt lgkmcnt(8)
    v_mfma_f32_16x16x32_bf16 v[184:187], a[144:147], v[176:179], 0
    v_mfma_f32_16x16x32_bf16 v[188:191], a[148:151], v[176:179], 0
    ds_read_b128 a[184:187], v180
    v_add_u32 v180, s63, v180
    ds_read_b128 a[188:191], v181
    v_add_u32 v181, s52, v181
    s_waitcnt lgkmcnt(8)
    v_mfma_f32_16x16x32_bf16 v[184:187], a[152:155], v[176:179], v[184:187]
    v_mfma_f32_16x16x32_bf16 v[188:191], a[156:159], v[176:179], v[188:191]
    ds_read_b128 a[144:147], v180
    v_add_u32 v180, s63, v180
    ds_read_b128 a[148:151], v181
    v_add_u32 v181, s52, v181
    s_waitcnt lgkmcnt(8)
    v_mfma_f32_16x16x32_bf16 v[184:187], a[160:163], v[176:179], v[184:187]
    v_mfma_f32_16x16x32_bf16 v[188:191], a[164:167], v[176:179], v[188:191]
    ds_read_b128 a[152:155], v180
    v_add_u32 v180, s63, v180
    ds_read_b128 a[156:159], v181
    v_add_u32 v181, s52, v181
    s_waitcnt lgkmcnt(8)
    v_mfma_f32_16x16x32_bf16 v[184:187], a[168:171], v[176:179], v[184:187]
    v_mfma_f32_16x16x32_bf16 v[188:191], a[172:175], v[176:179], v[188:191]
    ds_read_b128 a[160:163], v180
    v_add_u32 v180, s63, v180
    ds_read_b128 a[164:167], v181
    v_add_u32 v181, s52, v181
    s_waitcnt lgkmcnt(8)
    v_mfma_f32_16x16x32_bf16 v[184:187], a[176:179], v[176:179], v[184:187]
    v_mfma_f32_16x16x32_bf16 v[188:191], a[180:183], v[176:179], v[188:191]
    ds_read_b128 a[168:171], v180
    v_add_u32 v180, s63, v180
    ds_read_b128 a[172:175], v181
    v_add_u32 v181, s52, v181
    s_waitcnt lgkmcnt(8)
    v_mfma_f32_16x16x32_bf16 v[184:187], a[184:187], v[176:179], v[184:187]
    v_mfma_f32_16x16x32_bf16 v[188:191], a[188:191], v[176:179], v[188:191]
    ds_read_b128 a[176:179], v180
    v_add_u32 v180, s63, v180
    ds_read_b128 a[180:183], v181
    v_add_u32 v181, s52, v181
    s_waitcnt lgkmcnt(8)
    v_mfma_f32_16x16x32_bf16 v[184:187], a[144:147], v[176:179], v[184:187]
    v_mfma_f32_16x16x32_bf16 v[188:191], a[148:151], v[176:179], v[188:191]
    ds_read_b128 a[184:187], v180
    v_add_u32 v180, s63, v180
    ds_read_b128 a[188:191], v181
    v_add_u32 v181, s52, v181
    s_waitcnt lgkmcnt(8)
    v_mfma_f32_16x16x32_bf16 v[184:187], a[152:155], v[176:179], v[184:187]
    v_mfma_f32_16x16x32_bf16 v[188:191], a[156:159], v[176:179], v[188:191]
    ds_read_b128 a[144:147], v180
    v_add_u32 v180, s63, v180
    ds_read_b128 a[148:151], v181
    v_add_u32 v181, s52, v181
    s_waitcnt lgkmcnt(8)
    v_mfma_f32_16x16x32_bf16 v[184:187], a[160:163], v[176:179], v[184:187]
    v_mfma_f32_16x16x32_bf16 v[188:191], a[164:167], v[176:179], v[188:191]
    ds_read_b128 a[152:155], v180
    v_add_u32 v180, s63, v180
    ds_read_b128 a[156:159], v181
    v_add_u32 v181, s52, v181
    s_waitcnt lgkmcnt(8)
    v_mfma_f32_16x16x32_bf16 v[184:187], a[168:171], v[176:179], v[184:187]
    v_mfma_f32_16x16x32_bf16 v[188:191], a[172:175], v[176:179], v[188:191]
    ds_read_b128 a[160:163], v180
    v_add_u32 v180, s63, v180
    ds_read_b128 a[164:167], v181
    v_add_u32 v181, s52, v181
    s_waitcnt lgkmcnt(8)
    v_mfma_f32_16x16x32_bf16 v[184:187], a[176:179], v[176:179], v[184:187]
    v_mfma_f32_16x16x32_bf16 v[188:191], a[180:183], v[176:179], v[188:191]
    ds_read_b128 a[168:171], v180
    v_add_u32 v180, s63, v180
    ds_read_b128 a[172:175], v181
    v_add_u32 v181, s52, v181
    s_waitcnt lgkmcnt(8)
    v_mfma_f32_16x16x32_bf16 v[184:187], a[184:187], v[176:179], v[184:187]
    v_mfma_f32_16x16x32_bf16 v[188:191], a[188:191], v[176:179], v[188:191]
    ds_read_b128 a[176:179], v180
    v_add_u32 v180, s63, v180
    ds_read_b128 a[180:183], v181
    v_add_u32 v181, s52, v181
    s_waitcnt lgkmcnt(8)
    v_mfma_f32_16x16x32_bf16 v[184:187], a[144:147], v[176:179], v[184:187]
    v_mfma_f32_16x16x32_bf16 v[188:191], a[148:151], v[176:179], v[188:191]
    ds_read_b128 a[184:187], v180
    v_add_u32 v180, s63, v180
    ds_read_b128 a[188:191], v181
    v_add_u32 v181, s52, v181
    s_waitcnt lgkmcnt(8)
    v_mfma_f32_16x16x32_bf16 v[184:187], a[152:155], v[176:179], v[184:187]
    v_mfma_f32_16x16x32_bf16 v[188:191], a[156:159], v[176:179], v[188:191]
    s_waitcnt lgkmcnt(6)
    v_mfma_f32_16x16x32_bf16 v[184:187], a[160:163], v[176:179], v[184:187]
    v_mfma_f32_16x16x32_bf16 v[188:191], a[164:167], v[176:179], v[188:191]
    s_waitcnt lgkmcnt(4)
    v_mfma_f32_16x16x32_bf16 v[184:187], a[168:171], v[176:179], v[184:187]
    v_mfma_f32_16x16x32_bf16 v[188:191], a[172:175], v[176:179], v[188:191]
    s_waitcnt lgkmcnt(2)
    v_mfma_f32_16x16x32_bf16 v[184:187], a[176:179], v[176:179], v[184:187]
    v_mfma_f32_16x16x32_bf16 v[188:191], a[180:183], v[176:179], v[188:191]
    s_waitcnt lgkmcnt(0)
    v_mfma_f32_16x16x32_bf16 v[184:187], a[184:187], v[176:179], v[184:187]
    v_mfma_f32_16x16x32_bf16 v[188:191], a[188:191], v[176:179], v[188:191]
    v_lshlrev_b32 v180, 4, v2
    s_lshl_b32 s62, s40, 6
    s_lshl_b32 s61, s61, 6
    v_add_u32 v180, 163328, v180
    v_add_u32 v181, s61, v180
    v_add_u32 v180, s62, v180
    s_nop 0
    ds_write_b128 v180, v[184:187]
    ds_write_b128 v181, v[188:191]
mega_kernel_nocs28:
    s_nop 3
    s_cmp_lg_u32 s40, 0
    s_cbranch_scc1 mega_kernel_nopoll29
    s_mov_b32 s62, 0
mega_kernel_poll30:
    buffer_load_dword v5, v32, s[48:51], s1 offen sc1
    s_add_u32 s62, s62, 1
    s_waitcnt vmcnt(0)
    v_cmp_ne_u32 vcc, s2, v5
    s_nop 0
    s_and_b64 vcc, vcc, s[14:15]
    s_cbranch_scc0 mega_kernel_nopoll29
    s_cmp_lt_u32 s62, 262144
    s_sleep 1
    s_cbranch_scc1 mega_kernel_poll30
mega_kernel_nopoll29:
    s_waitcnt vmcnt(0) lgkmcnt(0)
    s_barrier
    buffer_load_dwordx4 a[0:3], v4, s[24:27], 0 offen offset:0 sc1
    buffer_load_dwordx4 a[72:75], v4, s[24:27], s60 offen offset:2048 sc1
    buffer_load_dwordx4 a[4:7], v4, s[24:27], 0 offen offset:1024 sc1
    buffer_load_dwordx4 a[76:79], v4, s[24:27], s60 offen offset:3072 sc1
    buffer_load_dwordx4 a[8:11], v4, s[24:27], 0 offen offset:2048 sc1
    buffer_load_dwordx4 a[80:83], v4, s[24:27], s84 offen offset:0 sc1
    buffer_load_dwordx4 a[12:15], v4, s[24:27], 0 offen offset:3072 sc1
    buffer_load_dwordx4 a[84:87], v4, s[24:27], s84 offen offset:1024 sc1
    buffer_load_dwordx4 a[16:19], v4, s[24:27], s57 offen offset:0 sc1
    buffer_load_dwordx4 a[88:91], v4, s[24:27], s84 offen offset:2048 sc1
    buffer_load_dwordx4 a[20:23], v4, s[24:27], s57 offen offset:1024 sc1
    buffer_load_dwordx4 a[92:95], v4, s[24:27], s84 offen offset:3072 sc1
    ds_read_b128 a[144:147], v4 offset:0
    ds_read_b128 a[148:151], v4 offset:1024
    ds_read_b128 a[152:155], v4 offset:2048
    ds_read_b128 a[156:159], v4 offset:3072
    ds_read_b128 a[160:163], v4 offset:4096
    ds_read_b128 a[164:167], v4 offset:5120
    ds_read_b128 a[168:171], v4 offset:6144
    s_waitcnt vmcnt(10)
    s_waitcnt lgkmcnt(5)
    v_mfma_f32_16x16x32_bf16 v[192:195], a[144:147], a[0:3], 0
    ds_read_b128 a[172:175], v4 offset:7168
    v_mfma_f32_16x16x32_bf16 v[224:227], a[144:147], a[72:75], 0
    buffer_load_dwordx4 a[24:27], v4, s[24:27], s57 offen offset:2048 sc1
    v_mfma_f32_16x16x32_bf16 v[196:199], a[148:151], a[0:3], 0
    ds_read_b128 a[176:179], v4 offset:8192
    v_mfma_f32_16x16x32_bf16 v[228:231], a[148:151], a[72:75], 0
    buffer_load_dwordx4 a[96:99], v4, s[24:27], s85 offen offset:0 sc1
    s_waitcnt lgkmcnt(5)
    v_mfma_f32_16x16x32_bf16 v[200:203], a[152:155], a[0:3], 0
    ds_read_b128 a[180:183], v4 offset:9216
    v_mfma_f32_16x16x32_bf16 v[232:235], a[152:155], a[72:75], 0
    buffer_load_dwordx2 v[16:17], v14, s[32:35], 0 offen offset:0 sc1
    v_mfma_f32_16x16x32_bf16 v[204:207], a[156:159], a[0:3], 0
    ds_read_b128 a[184:187], v4 offset:10240
    v_mfma_f32_16x16x32_bf16 v[236:239], a[156:159], a[72:75], 0
    buffer_load_dwordx2 v[18:19], v14, s[32:35], 0 offen offset:128 sc1
    s_waitcnt lgkmcnt(5)
    v_mfma_f32_16x16x32_bf16 v[208:211], a[0:3], a[160:163], 0
    ds_read_b128 a[188:191], v4 offset:11264
    v_mfma_f32_16x16x32_bf16 v[240:243], a[72:75], a[160:163], 0
    buffer_load_dwordx2 v[20:21], v14, s[32:35], 0 offen offset:256 sc1
    v_mfma_f32_16x16x32_bf16 v[212:215], a[0:3], a[164:167], 0
    ds_read_b128 a[192:195], v4 offset:12288
    v_mfma_f32_16x16x32_bf16 v[244:247], a[72:75], a[164:167], 0
    buffer_load_dwordx2 v[22:23], v14, s[32:35], 0 offen offset:384 sc1
    s_waitcnt lgkmcnt(6)
    v_mfma_f32_16x16x32_bf16 v[216:219], a[168:171], a[0:3], 0
    ds_read_b128 a[196:199], v4 offset:13312
    v_mfma_f32_16x16x32_bf16 v[248:251], a[168:171], a[72:75], 0
    buffer_load_dwordx2 v[24:25], v14, s[32:35], 0 offen offset:512 sc1
    s_waitcnt vmcnt(15)
    s_waitcnt lgkmcnt(5)
    v_mfma_f32_16x16x32_bf16 v[192:195], a[172:175], a[4:7], v[192:195]
    ds_read_b128 a[144:147], v4 offset:14336
    v_mfma_f32_16x16x32_bf16 v[224:227], a[172:175], a[76:79], v[224:227]
    buffer_load_dwordx4 a[28:31], v4, s[24:27], s57 offen offset:3072 sc1
    v_mfma_f32_16x16x32_bf16 v[196:199], a[176:179], a[4:7], v[196:199]
    ds_read_b128 a[148:151], v4 offset:15360
    v_mfma_f32_16x16x32_bf16 v[228:231], a[176:179], a[76:79], v[228:231]
    buffer_load_dwordx4 a[100:103], v4, s[24:27], s85 offen offset:1024 sc1
    s_waitcnt lgkmcnt(5)
    v_mfma_f32_16x16x32_bf16 v[200:203], a[180:183], a[4:7], v[200:203]
    ds_read_b128 a[152:155], v4 offset:16384
    v_mfma_f32_16x16x32_bf16 v[232:235], a[180:183], a[76:79], v[232:235]
    buffer_load_dwordx2 v[26:27], v14, s[32:35], 0 offen offset:640 sc1
    v_mfma_f32_16x16x32_bf16 v[204:207], a[184:187], a[4:7], v[204:207]
    ds_read_b128 a[156:159], v4 offset:17408
    v_mfma_f32_16x16x32_bf16 v[236:239], a[184:187], a[76:79], v[236:239]
    buffer_load_dwordx2 v[28:29], v14, s[32:35], 0 offen offset:768 sc1
    s_waitcnt lgkmcnt(5)
    v_mfma_f32_16x16x32_bf16 v[208:211], a[4:7], a[188:191], v[208:211]
    ds_read_b128 a[160:163], v4 offset:18432
    v_mfma_f32_16x16x32_bf16 v[240:243], a[76:79], a[188:191], v[240:243]
    buffer_load_dwordx2 v[30:31], v14, s[32:35], 0 offen offset:896 sc1
    v_mfma_f32_16x16x32_bf16 v[212:215], a[4:7], a[192:195], v[212:215]
    ds_read_b128 a[164:167], v4 offset:19456
    v_mfma_f32_16x16x32_bf16 v[244:247], a[76:79], a[192:195], v[244:247]
    s_waitcnt lgkmcnt(6)
    v_mfma_f32_16x16x32_bf16 v[216:219], a[196:199], a[4:7], v[216:219]
    ds_read_b128 a[168:171], v4 offset:20480
    v_mfma_f32_16x16x32_bf16 v[248:251], a[196:199], a[76:79], v[248:251]
    s_waitcnt vmcnt(18)
    s_waitcnt lgkmcnt(5)
    v_mfma_f32_16x16x32_bf16 v[192:195], a[144:147], a[8:11], v[192:195]
    ds_read_b128 a[172:175], v4 offset:21504
    v_mfma_f32_16x16x32_bf16 v[224:227], a[144:147], a[80:83], v[224:227]
    buffer_load_dwordx4 a[32:35], v4, s[24:27], s58 offen offset:0 sc1
    v_mfma_f32_16x16x32_bf16 v[196:199], a[148:151], a[8:11], v[196:199]
    ds_read_b128 a[176:179], v4 offset:22528
    v_mfma_f32_16x16x32_bf16 v[228:231], a[148:151], a[80:83], v[228:231]
    buffer_load_dwordx4 a[104:107], v4, s[24:27], s85 offen offset:2048 sc1
    s_waitcnt lgkmcnt(5)
    v_mfma_f32_16x16x32_bf16 v[200:203], a[152:155], a[8:11], v[200:203]
    ds_read_b128 a[180:183], v4 offset:23552
    v_mfma_f32_16x16x32_bf16 v[232:235], a[152:155], a[80:83], v[232:235]
    v_mfma_f32_16x16x32_bf16 v[204:207], a[156:159], a[8:11], v[204:207]
    ds_read_b128 a[184:187], v4 offset:24576
    v_mfma_f32_16x16x32_bf16 v[236:239], a[156:159], a[80:83], v[236:239]
    s_waitcnt lgkmcnt(5)
    v_mfma_f32_16x16x32_bf16 v[208:211], a[8:11], a[160:163], v[208:211]
    ds_read_b128 a[188:191], v4 offset:25600
    v_mfma_f32_16x16x32_bf16 v[240:243], a[80:83], a[160:163], v[240:243]
    v_mfma_f32_16x16x32_bf16 v[212:215], a[8:11], a[164:167], v[212:215]
    ds_read_b128 a[192:195], v4 offset:26624
    v_mfma_f32_16x16x32_bf16 v[244:247], a[80:83], a[164:167], v[244:247]
    s_waitcnt lgkmcnt(6)
    v_mfma_f32_16x16x32_bf16 v[216:219], a[168:171], a[8:11], v[216:219]
    ds_read_b128 a[196:199], v4 offset:27648
    v_mfma_f32_16x16x32_bf16 v[248:251], a[168:171], a[80:83], v[248:251]
    s_waitcnt vmcnt(18)
    s_waitcnt lgkmcnt(5)
    v_mfma_f32_16x16x32_bf16 v[192:195], a[172:175], a[12:15], v[192:195]
    ds_read_b128 a[144:147], v4 offset:28672
    v_mfma_f32_16x16x32_bf16 v[224:227], a[172:175], a[84:87], v[224:227]
    buffer_load_dwordx4 a[36:39], v4, s[24:27], s58 offen offset:1024 sc1
    v_mfma_f32_16x16x32_bf16 v[196:199], a[176:179], a[12:15], v[196:199]
    ds_read_b128 a[148:151], v4 offset:29696
    v_mfma_f32_16x16x32_bf16 v[228:231], a[176:179], a[84:87], v[228:231]
    buffer_load_dwordx4 a[108:111], v4, s[24:27], s85 offen offset:3072 sc1
    s_waitcnt lgkmcnt(5)
    v_mfma_f32_16x16x32_bf16 v[200:203], a[180:183], a[12:15], v[200:203]
    ds_read_b128 a[152:155], v4 offset:30720
    v_mfma_f32_16x16x32_bf16 v[232:235], a[180:183], a[84:87], v[232:235]
    v_mfma_f32_16x16x32_bf16 v[204:207], a[184:187], a[12:15], v[204:207]
    ds_read_b128 a[156:159], v4 offset:31744
    v_mfma_f32_16x16x32_bf16 v[236:239], a[184:187], a[84:87], v[236:239]
    s_waitcnt lgkmcnt(5)
    v_mfma_f32_16x16x32_bf16 v[208:211], a[12:15], a[188:191], v[208:211]
    ds_read_b128 a[160:163], v4 offset:32768
    v_mfma_f32_16x16x32_bf16 v[240:243], a[84:87], a[188:191], v[240:243]
    v_mfma_f32_16x16x32_bf16 v[212:215], a[12:15], a[192:195], v[212:215]
    ds_read_b128 a[164:167], v4 offset:33792
    v_mfma_f32_16x16x32_bf16 v[244:247], a[84:87], a[192:195], v[244:247]
    s_waitcnt lgkmcnt(6)
    v_mfma_f32_16x16x32_bf16 v[216:219], a[196:199], a[12:15], v[216:219]
    ds_read_b128 a[168:171], v4 offset:34816
    v_mfma_f32_16x16x32_bf16 v[248:251], a[196:199], a[84:87], v[248:251]
    s_waitcnt vmcnt(18)
    s_waitcnt lgkmcnt(5)
    v_mfma_f32_16x16x32_bf16 v[192:195], a[144:147], a[16:19], v[192:195]
    ds_read_b128 a[172:175], v4 offset:35840
    v_accvgpr_read_b32 v60, a223
    v_mfma_f32_16x16x32_bf16 v[224:227], a[144:147], a[88:91], v[224:227]
    buffer_load_dwordx4 a[40:43], v4, s[24:27], s58 offen offset:2048 sc1
    v_accvgpr_read_b32 v61, a204
    v_mfma_f32_16x16x32_bf16 v[196:199], a[148:151], a[16:19], v[196:199]
    ds_read_b128 a[176:179], v4 offset:36864
    ds_read_b128 v[40:43], v33 offset:0
    v_mfma_f32_16x16x32_bf16 v[228:231], a[148:151], a[88:91], v[228:231]
    buffer_load_dwordx4 a[112:115], v4, s[24:27], s86 offen offset:0 sc1
    ds_read_b128 v[44:47], v33 offset:64
    s_waitcnt lgkmcnt(7)
    v_mfma_f32_16x16x32_bf16 v[200:203], a[152:155], a[16:19], v[200:203]
    ds_read_b128 a[180:183], v4 offset:37888
    ds_read_b128 v[48:51], v33 offset:128
    v_mfma_f32_16x16x32_bf16 v[232:235], a[152:155], a[88:91], v[232:235]
    ds_read_b128 v[52:55], v33 offset:192
    v_mfma_f32_16x16x32_bf16 v[204:207], a[156:159], a[16:19], v[204:207]
    ds_read_b128 a[184:187], v4 offset:38912
    ds_read_b128 v[56:59], v33 offset:384
    v_mfma_f32_16x16x32_bf16 v[236:239], a[156:159], a[88:91], v[236:239]
    ds_read_b32 v62, v60 offset:256
    s_waitcnt lgkmcnt(11)
    v_mfma_f32_16x16x32_bf16 v[208:211], a[16:19], a[160:163], v[208:211]
    ds_read_b128 a[188:191], v4 offset:39936
    ds_read_b32 v63, v60 offset:320
    v_mfma_f32_16x16x32_bf16 v[240:243], a[88:91], a[160:163], v[240:243]
    s_waitcnt vmcnt(6)
    v_mfma_f32_16x16x32_bf16 v[212:215], a[16:19], a[164:167], v[212:215]
    ds_read_b128 a[192:195], v4 offset:40960
    v_mfma_f32_16x16x32_bf16 v[244:247], a[88:91], a[164:167], v[244:247]
    s_waitcnt lgkmcnt(13)
    v_mfma_f32_16x16x32_bf16 v[216:219], a[168:171], a[16:19], v[216:219]
    ds_read_b128 a[196:199], v4 offset:41984
    v_mfma_f32_16x16x32_bf16 v[248:251], a[168:171], a[88:91], v[248:251]
    s_waitcnt lgkmcnt(12)
    v_mfma_f32_16x16x32_bf16 v[192:195], a[172:175], a[20:23], v[192:195]
    ds_read_b128 a[144:147], v4 offset:43008
    v_pk_add_f32 v[16:17], v[16:17], v[18:19]
    v_mfma_f32_16x16x32_bf16 v[224:227], a[172:175], a[92:95], v[224:227]
    buffer_load_dwordx4 a[44:47], v4, s[24:27], s58 offen offset:3072 sc1
    v_pk_add_f32 v[20:21], v[20:21], v[22:23]
    v_mfma_f32_16x16x32_bf16 v[196:199], a[176:179], a[20:23], v[196:199]
    ds_read_b128 a[148:151], v4 offset:44032
    v_pk_add_f32 v[24:25], v[24:25], v[26:27]
    v_mfma_f32_16x16x32_bf16 v[228:231], a[176:179], a[92:95], v[228:231]
    buffer_load_dwordx4 a[116:119], v4, s[24:27], s86 offen offset:1024 sc1
    v_pk_add_f32 v[28:29], v[28:29], v[30:31]
    s_waitcnt lgkmcnt(8)
    v_mfma_f32_16x16x32_bf16 v[200:203], a[180:183], a[20:23], v[200:203]
    ds_read_b128 a[152:155], v4 offset:45056
    v_pk_add_f32 v[16:17], v[16:17], v[20:21]
    v_mfma_f32_16x16x32_bf16 v[232:235], a[180:183], a[92:95], v[232:235]
    v_pk_add_f32 v[24:25], v[24:25], v[28:29]
    v_mfma_f32_16x16x32_bf16 v[204:207], a[184:187], a[20:23], v[204:207]
    ds_read_b128 a[156:159], v4 offset:46080
    v_pk_add_f32 v[16:17], v[16:17], v[24:25]
    v_mfma_f32_16x16x32_bf16 v[236:239], a[184:187], a[92:95], v[236:239]
    v_mov_b32 v18, v16
    s_waitcnt lgkmcnt(5)
    v_mfma_f32_16x16x32_bf16 v[208:211], a[20:23], a[188:191], v[208:211]
    ds_read_b128 a[160:163], v4 offset:47104
    v_mov_b32 v19, v17
    v_mfma_f32_16x16x32_bf16 v[240:243], a[92:95], a[188:191], v[240:243]
    v_permlane16_swap_b32 v16, v18
    v_mfma_f32_16x16x32_bf16 v[212:215], a[20:23], a[192:195], v[212:215]
    ds_read_b128 a[164:167], v4 offset:48128
    v_permlane16_swap_b32 v17, v19
    v_mfma_f32_16x16x32_bf16 v[244:247], a[92:95], a[192:195], v[244:247]
    s_waitcnt lgkmcnt(6)
    v_mfma_f32_16x16x32_bf16 v[216:219], a[196:199], a[20:23], v[216:219]
    ds_read_b128 a[168:171], v4 offset:49152
    v_mfma_f32_16x16x32_bf16 v[248:251], a[196:199], a[92:95], v[248:251]
    s_waitcnt lgkmcnt(5)
    v_mfma_f32_16x16x32_bf16 v[192:195], a[144:147], a[24:27], v[192:195]
    ds_read_b128 a[172:175], v4 offset:50176
    v_add_f32 v16, v16, v18
    v_mfma_f32_16x16x32_bf16 v[224:227], a[144:147], a[96:99], v[224:227]
    buffer_load_dwordx4 a[48:51], v4, s[24:27], s59 offen offset:0 sc1
    v_add_f32 v17, v17, v19
    v_mfma_f32_16x16x32_bf16 v[196:199], a[148:151], a[24:27], v[196:199]
    ds_read_b128 a[176:179], v4 offset:51200
    v_mul_f32 v8, 0x3ae38e39, v16
    v_mfma_f32_16x16x32_bf16 v[228:231], a[148:151], a[96:99], v[228:231]
    buffer_load_dwordx4 a[120:123], v4, s[24:27], s86 offen offset:2048 sc1
    v_mul_f32 v9, 0x3ae38e39, v17
    s_waitcnt lgkmcnt(5)
    v_mfma_f32_16x16x32_bf16 v[200:203], a[152:155], a[24:27], v[200:203]
    ds_read_b128 a[180:183], v4 offset:52224
    v_fma_f32 v9, -v8, v8, v9
    v_mfma_f32_16x16x32_bf16 v[232:235], a[152:155], a[96:99], v[232:235]
    v_max_f32 v9, 0, v9
    v_mfma_f32_16x16x32_bf16 v[204:207], a[156:159], a[24:27], v[204:207]
    ds_read_b128 a[184:187], v4 offset:53248
    v_cvt_pk_bf16_f32 v9, v8, v9
    v_mfma_f32_16x16x32_bf16 v[236:239], a[156:159], a[96:99], v[236:239]
    v_lshlrev_b32 v8, 16, v9
    s_waitcnt lgkmcnt(5)
    v_mfma_f32_16x16x32_bf16 v[208:211], a[24:27], a[160:163], v[208:211]
    ds_read_b128 a[188:191], v4 offset:54272
    v_and_b32 v9, 0xffff0000, v9
    v_mfma_f32_16x16x32_bf16 v[240:243], a[96:99], a[160:163], v[240:243]
    v_add_f32 v9, 0x3727c5ac, v9
    v_mfma_f32_16x16x32_bf16 v[212:215], a[24:27], a[164:167], v[212:215]
    ds_read_b128 a[192:195], v4 offset:55296
    v_cvt_pk_bf16_f32 v9, v9, v9
    v_mfma_f32_16x16x32_bf16 v[244:247], a[96:99], a[164:167], v[244:247]
    s_waitcnt lgkmcnt(6)
    v_mfma_f32_16x16x32_bf16 v[216:219], a[168:171], a[24:27], v[216:219]
    ds_read_b128 a[196:199], v4 offset:56320
    v_mfma_f32_16x16x32_bf16 v[248:251], a[168:171], a[96:99], v[248:251]
    s_waitcnt lgkmcnt(5)
    v_mfma_f32_16x16x32_bf16 v[192:195], a[172:175], a[28:31], v[192:195]
    ds_read_b128 a[144:147], v4 offset:57344
    v_lshlrev_b32 v9, 16, v9
    v_mfma_f32_16x16x32_bf16 v[224:227], a[172:175], a[100:103], v[224:227]
    buffer_load_dwordx4 a[52:55], v4, s[24:27], s59 offen offset:1024 sc1
    v_sqrt_f32 v9, v9
    v_mfma_f32_16x16x32_bf16 v[196:199], a[176:179], a[28:31], v[196:199]
    ds_read_b128 a[148:151], v4 offset:58368
    v_cvt_pk_bf16_f32 v9, v9, v9
    v_mfma_f32_16x16x32_bf16 v[228:231], a[176:179], a[100:103], v[228:231]
    buffer_load_dwordx4 a[124:127], v4, s[24:27], s86 offen offset:3072 sc1
    v_lshlrev_b32 v9, 16, v9
    s_waitcnt lgkmcnt(5)
    v_mfma_f32_16x16x32_bf16 v[200:203], a[180:183], a[28:31], v[200:203]
    ds_read_b128 a[152:155], v4 offset:59392
    v_rcp_f32 v9, v9
    v_mfma_f32_16x16x32_bf16 v[232:235], a[180:183], a[100:103], v[232:235]
    v_mov_b32 v10, v8
    v_mfma_f32_16x16x32_bf16 v[204:207], a[184:187], a[28:31], v[204:207]
    ds_read_b128 a[156:159], v4 offset:60416
    v_mov_b32 v11, v9
    v_mfma_f32_16x16x32_bf16 v[236:239], a[184:187], a[100:103], v[236:239]
    v_permlane32_swap_b32 v8, v10
    s_waitcnt lgkmcnt(5)
    v_mfma_f32_16x16x32_bf16 v[208:211], a[28:31], a[188:191], v[208:211]
    ds_read_b128 a[160:163], v4 offset:61440
    v_permlane32_swap_b32 v9, v11
    v_mfma_f32_16x16x32_bf16 v[240:243], a[100:103], a[188:191], v[240:243]
    ds_bpermute_b32 v66, v61, v8 offset:0
    v_mfma_f32_16x16x32_bf16 v[212:215], a[28:31], a[192:195], v[212:215]
    ds_read_b128 a[164:167], v4 offset:62464
    ds_bpermute_b32 v74, v61, v10 offset:0
    v_mfma_f32_16x16x32_bf16 v[244:247], a[100:103], a[192:195], v[244:247]
    s_waitcnt lgkmcnt(8)
    v_mfma_f32_16x16x32_bf16 v[216:219], a[196:199], a[28:31], v[216:219]
    ds_read_b128 a[168:171], v4 offset:63488
    v_mfma_f32_16x16x32_bf16 v[248:251], a[196:199], a[100:103], v[248:251]
    s_waitcnt vmcnt(10)
    s_waitcnt lgkmcnt(7)
    v_mfma_f32_16x16x32_bf16 v[192:195], a[144:147], a[32:35], v[192:195]
    ds_read_b128 a[172:175], v4 offset:64512
    ds_bpermute_b32 v70, v61, v9 offset:0
    v_mfma_f32_16x16x32_bf16 v[224:227], a[144:147], a[104:107], v[224:227]
    buffer_load_dwordx4 a[56:59], v4, s[24:27], s59 offen offset:2048 sc1
    ds_bpermute_b32 v78, v61, v11 offset:0
    v_mfma_f32_16x16x32_bf16 v[196:199], a[148:151], a[32:35], v[196:199]
    ds_read_b128 a[176:179], v7 offset:0
    ds_bpermute_b32 v67, v61, v8 offset:4
    v_mfma_f32_16x16x32_bf16 v[228:231], a[148:151], a[104:107], v[228:231]
    buffer_load_dwordx4 a[128:131], v4, s[24:27], s87 offen offset:0 sc1
    ds_bpermute_b32 v75, v61, v10 offset:4
    s_waitcnt lgkmcnt(11)
    v_mfma_f32_16x16x32_bf16 v[200:203], a[152:155], a[32:35], v[200:203]
    ds_read_b128 a[180:183], v7 offset:1024
    ds_bpermute_b32 v71, v61, v9 offset:4
    v_mfma_f32_16x16x32_bf16 v[232:235], a[152:155], a[104:107], v[232:235]
    ds_bpermute_b32 v79, v61, v11 offset:4
    v_mfma_f32_16x16x32_bf16 v[204:207], a[156:159], a[32:35], v[204:207]
    ds_read_b128 a[184:187], v7 offset:2048
    ds_bpermute_b32 v68, v61, v8 offset:8
    v_mfma_f32_16x16x32_bf16 v[236:239], a[156:159], a[104:107], v[236:239]
    ds_bpermute_b32 v76, v61, v10 offset:8
    s_waitcnt lgkmcnt(14)
    v_mfma_f32_16x16x32_bf16 v[208:211], a[32:35], a[160:163], v[208:211]
    ds_read_b128 a[188:191], v7 offset:3072
    ds_bpermute_b32 v72, v61, v9 offset:8
    v_mfma_f32_16x16x32_bf16 v[240:243], a[104:107], a[160:163], v[240:243]
    ds_bpermute_b32 v80, v61, v11 offset:8
    v_mfma_f32_16x16x32_bf16 v[212:215], a[32:35], a[164:167], v[212:215]
    ds_read_b128 a[192:195], v7 offset:4096
    ds_bpermute_b32 v69, v61, v8 offset:12
    v_mfma_f32_16x16x32_bf16 v[244:247], a[104:107], a[164:167], v[244:247]
    s_waitcnt lgkmcnt(15)
    v_mfma_f32_16x16x32_bf16 v[216:219], a[168:171], a[32:35], v[216:219]
    ds_read_b128 a[196:199], v7 offset:5120
    v_mfma_f32_16x16x32_bf16 v[248:251], a[168:171], a[104:107], v[248:251]
    s_waitcnt vmcnt(10)
    s_waitcnt lgkmcnt(14)
    v_mfma_f32_16x16x32_bf16 v[192:195], a[172:175], a[36:39], v[192:195]
    ds_read_b128 a[144:147], v7 offset:6144
    ds_bpermute_b32 v77, v61, v10 offset:12
    v_mfma_f32_16x16x32_bf16 v[224:227], a[172:175], a[108:111], v[224:227]
    buffer_load_dwordx4 a[60:63], v4, s[24:27], s59 offen offset:3072 sc1
    ds_bpermute_b32 v73, v61, v9 offset:12
    v_mfma_f32_16x16x32_bf16 v[196:199], a[176:179], a[36:39], v[196:199]
    ds_read_b128 a[148:151], v7 offset:7168
    ds_bpermute_b32 v81, v61, v11 offset:12
    v_mfma_f32_16x16x32_bf16 v[228:231], a[176:179], a[108:111], v[228:231]
    buffer_load_dwordx4 a[132:135], v4, s[24:27], s87 offen offset:1024 sc1
    v_mul_f32 v82, 0x3eae1a93, v9
    s_waitcnt lgkmcnt(13)
    v_mfma_f32_16x16x32_bf16 v[200:203], a[180:183], a[36:39], v[200:203]
    ds_read_b128 a[152:155], v7 offset:8192
    v_mul_f32 v84, 0x3eae1a93, v11
    v_mfma_f32_16x16x32_bf16 v[232:235], a[180:183], a[108:111], v[232:235]
    v_cndmask_b32 v83, v9, v82, s[90:91]
    v_mfma_f32_16x16x32_bf16 v[204:207], a[184:187], a[36:39], v[204:207]
    ds_read_b128 a[156:159], v7 offset:9216
    v_cndmask_b32 v85, v11, v84, s[90:91]
    v_mfma_f32_16x16x32_bf16 v[236:239], a[184:187], a[108:111], v[236:239]
    s_waitcnt lgkmcnt(9)
    v_mfma_f32_16x16x32_bf16 v[208:211], a[36:39], a[188:191], v[208:211]
    ds_read_b128 a[160:163], v7 offset:10240
    v_mfma_f32_16x16x32_bf16 v[240:243], a[108:111], a[188:191], v[240:243]
    v_mfma_f32_16x16x32_bf16 v[212:215], a[36:39], a[192:195], v[212:215]
    ds_read_b128 a[164:167], v7 offset:11264
    v_mfma_f32_16x16x32_bf16 v[244:247], a[108:111], a[192:195], v[244:247]
    s_waitcnt lgkmcnt(9)
    v_mfma_f32_16x16x32_bf16 v[216:219], a[196:199], a[36:39], v[216:219]
    ds_read_b128 a[168:171], v7 offset:12288
    v_mfma_f32_16x16x32_bf16 v[248:251], a[196:199], a[108:111], v[248:251]
    s_waitcnt vmcnt(10)
    s_waitcnt lgkmcnt(6)
    v_mfma_f32_16x16x32_bf16 v[192:195], a[144:147], a[40:43], v[192:195]
    ds_read_b128 a[172:175], v7 offset:13312
    v_mfma_f32_16x16x32_bf16 v[224:227], a[144:147], a[112:115], v[224:227]
    buffer_load_dwordx4 a[64:67], v4, s[24:27], s60 offen offset:0 sc1
    v_mfma_f32_16x16x32_bf16 v[196:199], a[148:151], a[40:43], v[196:199]
    ds_read_b128 a[176:179], v7 offset:14336
    v_mfma_f32_16x16x32_bf16 v[228:231], a[148:151], a[112:115], v[228:231]
    buffer_load_dwordx4 a[136:139], v4, s[24:27], s87 offen offset:2048 sc1
    s_waitcnt lgkmcnt(5)
    v_mfma_f32_16x16x32_bf16 v[200:203], a[152:155], a[40:43], v[200:203]
    ds_read_b128 a[180:183], v7 offset:15360
    v_mfma_f32_16x16x32_bf16 v[232:235], a[152:155], a[112:115], v[232:235]
    v_mfma_f32_16x16x32_bf16 v[204:207], a[156:159], a[40:43], v[204:207]
    ds_read_b128 a[184:187], v7 offset:16384
    v_mfma_f32_16x16x32_bf16 v[236:239], a[156:159], a[112:115], v[236:239]
    s_waitcnt lgkmcnt(5)
    v_mfma_f32_16x16x32_bf16 v[208:211], a[40:43], a[160:163], v[208:211]
    ds_read_b128 a[188:191], v7 offset:17408
    v_mfma_f32_16x16x32_bf16 v[240:243], a[112:115], a[160:163], v[240:243]
    v_mfma_f32_16x16x32_bf16 v[212:215], a[40:43], a[164:167], v[212:215]
    ds_read_b128 a[192:195], v7 offset:18432
    v_mfma_f32_16x16x32_bf16 v[244:247], a[112:115], a[164:167], v[244:247]
    s_waitcnt lgkmcnt(6)
    v_mfma_f32_16x16x32_bf16 v[216:219], a[168:171], a[40:43], v[216:219]
    ds_read_b128 a[196:199], v7 offset:19456
    v_mfma_f32_16x16x32_bf16 v[248:251], a[168:171], a[112:115], v[248:251]
    s_waitcnt vmcnt(10)
    s_waitcnt lgkmcnt(5)
    v_mfma_f32_16x16x32_bf16 v[192:195], a[172:175], a[44:47], v[192:195]
    ds_read_b128 a[144:147], v7 offset:20480
    v_mfma_f32_16x16x32_bf16 v[224:227], a[172:175], a[116:119], v[224:227]
    buffer_load_dwordx4 a[68:71], v4, s[24:27], s60 offen offset:1024 sc1
    v_accvgpr_read_b32 v86, a215
    v_mfma_f32_16x16x32_bf16 v[196:199], a[176:179], a[44:47], v[196:199]
    ds_read_b128 a[148:151], v7 offset:21504
    v_accvgpr_read_b32 v87, a216
    v_mfma_f32_16x16x32_bf16 v[228:231], a[176:179], a[116:119], v[228:231]
    buffer_load_dwordx4 a[140:143], v4, s[24:27], s87 offen offset:3072 sc1
    v_accvgpr_read_b32 v88, a219
    s_waitcnt lgkmcnt(5)
    v_mfma_f32_16x16x32_bf16 v[200:203], a[180:183], a[44:47], v[200:203]
    ds_read_b128 a[152:155], v7 offset:22528
    v_accvgpr_read_b32 v89, a220
    v_mfma_f32_16x16x32_bf16 v[232:235], a[180:183], a[116:119], v[232:235]
    buffer_load_dword a255, v15, s[8:11], 0 offen sc1
    v_accvgpr_read_b32 v90, a221
    v_mfma_f32_16x16x32_bf16 v[204:207], a[184:187], a[44:47], v[204:207]
    ds_read_b128 a[156:159], v7 offset:23552
    v_accvgpr_read_b32 v91, a217
    v_mfma_f32_16x16x32_bf16 v[236:239], a[184:187], a[116:119], v[236:239]
    v_accvgpr_read_b32 v65, a218
    s_waitcnt lgkmcnt(5)
    v_mfma_f32_16x16x32_bf16 v[208:211], a[44:47], a[188:191], v[208:211]
    ds_read_b128 a[160:163], v7 offset:24576
    v_mov_b32 v92, 0x3f803f80
    v_mfma_f32_16x16x32_bf16 v[240:243], a[116:119], a[188:191], v[240:243]
    v_mov_b32 v93, 0x3f803f80
    v_mfma_f32_16x16x32_bf16 v[212:215], a[44:47], a[192:195], v[212:215]
    ds_read_b128 a[164:167], v7 offset:25600
    v_mov_b32 v94, 0x3f803f80
    v_mfma_f32_16x16x32_bf16 v[244:247], a[116:119], a[192:195], v[244:247]
    v_mov_b32 v95, 0x3f803f80
    s_waitcnt lgkmcnt(6)
    v_mfma_f32_16x16x32_bf16 v[216:219], a[196:199], a[44:47], v[216:219]
    ds_read_b128 a[168:171], v7 offset:26624
    v_mfma_f32_16x16x32_bf16 v[248:251], a[196:199], a[116:119], v[248:251]
    s_waitcnt vmcnt(11)
    s_waitcnt lgkmcnt(5)
    v_mfma_f32_16x16x32_bf16 v[192:195], a[144:147], a[48:51], v[192:195]
    ds_read_b128 a[172:175], v7 offset:27648
    v_fma_f32 v204, -v8, v52, v204
    v_fma_f32 v205, -v8, v53, v205
    v_fma_f32 v206, -v8, v54, v206
    v_fma_f32 v207, -v8, v55, v207
    v_mfma_f32_16x16x32_bf16 v[224:227], a[144:147], a[120:123], v[224:227]
    v_fma_f32 v236, -v10, v52, v236
    v_fma_f32 v237, -v10, v53, v237
    v_fma_f32 v238, -v10, v54, v238
    v_fma_f32 v239, -v10, v55, v239
    v_mfma_f32_16x16x32_bf16 v[196:199], a[148:151], a[48:51], v[196:199]
    ds_read_b128 a[176:179], v7 offset:28672
    v_fma_f32 v208, -v66, v62, v208
    v_fma_f32 v209, -v67, v62, v209
    v_fma_f32 v210, -v68, v62, v210
    v_fma_f32 v211, -v69, v62, v211
    v_mfma_f32_16x16x32_bf16 v[228:231], a[148:151], a[120:123], v[228:231]
    v_fma_f32 v240, -v74, v62, v240
    v_fma_f32 v241, -v75, v62, v241
    v_fma_f32 v242, -v76, v62, v242
    v_fma_f32 v243, -v77, v62, v243
    s_waitcnt lgkmcnt(5)
    v_mfma_f32_16x16x32_bf16 v[200:203], a[152:155], a[48:51], v[200:203]
    ds_read_b128 a[180:183], v7 offset:29696
    v_fma_f32 v212, -v66, v63, v212
    v_fma_f32 v213, -v67, v63, v213
    v_fma_f32 v214, -v68, v63, v214
    v_fma_f32 v215, -v69, v63, v215
    v_mfma_f32_16x16x32_bf16 v[232:235], a[152:155], a[120:123], v[232:235]
    v_fma_f32 v244, -v74, v63, v244
    v_fma_f32 v245, -v75, v63, v245
    v_fma_f32 v246, -v76, v63, v246
    v_fma_f32 v247, -v77, v63, v247
    v_mfma_f32_16x16x32_bf16 v[204:207], a[156:159], a[48:51], v[204:207]
    ds_read_b128 a[184:187], v7 offset:30720
    v_fma_f32 v216, -v8, v56, v216
    v_fma_f32 v217, -v8, v57, v217
    v_fma_f32 v218, -v8, v58, v218
    v_fma_f32 v219, -v8, v59, v219
    v_mfma_f32_16x16x32_bf16 v[236:239], a[156:159], a[120:123], v[236:239]
    v_fma_f32 v248, -v10, v56, v248
    v_fma_f32 v249, -v10, v57, v249
    v_fma_f32 v250, -v10, v58, v250
    v_fma_f32 v251, -v10, v59, v251
    s_waitcnt lgkmcnt(5)
    v_mfma_f32_16x16x32_bf16 v[208:211], a[48:51], a[160:163], v[208:211]
    ds_read_b128 a[188:191], v7 offset:31744
    v_fma_f32 v192, -v8, v40, v192
    v_fma_f32 v193, -v8, v41, v193
    v_fma_f32 v194, -v8, v42, v194
    v_fma_f32 v195, -v8, v43, v195
    v_mfma_f32_16x16x32_bf16 v[240:243], a[120:123], a[160:163], v[240:243]
    v_fma_f32 v224, -v10, v40, v224
    v_fma_f32 v225, -v10, v41, v225
    v_fma_f32 v226, -v10, v42, v226
    v_fma_f32 v227, -v10, v43, v227
    v_mfma_f32_16x16x32_bf16 v[212:215], a[48:51], a[164:167], v[212:215]
    ds_read_b128 a[192:195], v7 offset:32768
    v_fma_f32 v196, -v8, v44, v196
    v_fma_f32 v197, -v8, v45, v197
    v_fma_f32 v198, -v8, v46, v198
    v_fma_f32 v199, -v8, v47, v199
    v_mfma_f32_16x16x32_bf16 v[244:247], a[120:123], a[164:167], v[244:247]
    v_fma_f32 v228, -v10, v44, v228
    v_fma_f32 v229, -v10, v45, v229
    v_fma_f32 v230, -v10, v46, v230
    v_fma_f32 v231, -v10, v47, v231
    s_waitcnt lgkmcnt(6)
    v_mfma_f32_16x16x32_bf16 v[216:219], a[168:171], a[48:51], v[216:219]
    ds_read_b128 a[196:199], v7 offset:33792
    v_fma_f32 v200, -v8, v48, v200
    v_fma_f32 v201, -v8, v49, v201
    v_fma_f32 v202, -v8, v50, v202
    v_fma_f32 v203, -v8, v51, v203
    v_mfma_f32_16x16x32_bf16 v[248:251], a[168:171], a[120:123], v[248:251]
    v_fma_f32 v232, -v10, v48, v232
    v_fma_f32 v233, -v10, v49, v233
    v_fma_f32 v234, -v10, v50, v234
    v_fma_f32 v235, -v10, v51, v235
    s_waitcnt vmcnt(9)
    s_waitcnt lgkmcnt(5)
    v_mfma_f32_16x16x32_bf16 v[192:195], a[172:175], a[52:55], v[192:195]
    ds_read_b128 a[144:147], v7 offset:34816
    v_mfma_f32_16x16x32_bf16 v[224:227], a[172:175], a[124:127], v[224:227]
    v_mfma_f32_16x16x32_bf16 v[196:199], a[176:179], a[52:55], v[196:199]
    ds_read_b128 a[148:151], v7 offset:35840
    v_mfma_f32_16x16x32_bf16 v[228:231], a[176:179], a[124:127], v[228:231]
    s_waitcnt lgkmcnt(5)
    v_mfma_f32_16x16x32_bf16 v[200:203], a[180:183], a[52:55], v[200:203]
    ds_read_b128 a[152:155], v7 offset:36864
    v_mfma_f32_16x16x32_bf16 v[232:235], a[180:183], a[124:127], v[232:235]
    v_mfma_f32_16x16x32_bf16 v[204:207], a[184:187], a[52:55], v[204:207]
    ds_read_b128 a[156:159], v7 offset:37888
    v_mfma_f32_16x16x32_bf16 v[236:239], a[184:187], a[124:127], v[236:239]
    s_waitcnt lgkmcnt(5)
    v_mfma_f32_16x16x32_bf16 v[208:211], a[52:55], a[188:191], v[208:211]
    ds_read_b128 a[160:163], v7 offset:38912
    v_mfma_f32_16x16x32_bf16 v[240:243], a[124:127], a[188:191], v[240:243]
    v_mfma_f32_16x16x32_bf16 v[212:215], a[52:55], a[192:195], v[212:215]
    ds_read_b128 a[164:167], v7 offset:39936
    v_mfma_f32_16x16x32_bf16 v[244:247], a[124:127], a[192:195], v[244:247]
    s_waitcnt lgkmcnt(6)
    v_mfma_f32_16x16x32_bf16 v[216:219], a[196:199], a[52:55], v[216:219]
    ds_read_b128 a[168:171], v7 offset:40960
    v_mfma_f32_16x16x32_bf16 v[248:251], a[196:199], a[124:127], v[248:251]
    s_waitcnt vmcnt(7)
    s_waitcnt lgkmcnt(5)
    v_mfma_f32_16x16x32_bf16 v[192:195], a[144:147], a[56:59], v[192:195]
    ds_read_b128 a[172:175], v7 offset:41984
    v_mfma_f32_16x16x32_bf16 v[224:227], a[144:147], a[128:131], v[224:227]
    v_mfma_f32_16x16x32_bf16 v[196:199], a[148:151], a[56:59], v[196:199]
    ds_read_b128 a[176:179], v7 offset:43008
    v_mfma_f32_16x16x32_bf16 v[228:231], a[148:151], a[128:131], v[228:231]
    s_waitcnt lgkmcnt(5)
    v_mfma_f32_16x16x32_bf16 v[200:203], a[152:155], a[56:59], v[200:203]
    ds_read_b128 a[180:183], v7 offset:44032
    v_mfma_f32_16x16x32_bf16 v[232:235], a[152:155], a[128:131], v[232:235]
    v_mfma_f32_16x16x32_bf16 v[204:207], a[156:159], a[56:59], v[204:207]
    ds_read_b128 a[184:187], v7 offset:45056
    v_mfma_f32_16x16x32_bf16 v[236:239], a[156:159], a[128:131], v[236:239]
    s_waitcnt lgkmcnt(5)
    v_mfma_f32_16x16x32_bf16 v[208:211], a[56:59], a[160:163], v[208:211]
    ds_read_b128 a[188:191], v7 offset:46080
    v_mfma_f32_16x16x32_bf16 v[240:243], a[128:131], a[160:163], v[240:243]
    v_mfma_f32_16x16x32_bf16 v[212:215], a[56:59], a[164:167], v[212:215]
    ds_read_b128 a[192:195], v7 offset:47104
    v_mfma_f32_16x16x32_bf16 v[244:247], a[128:131], a[164:167], v[244:247]
    s_waitcnt lgkmcnt(6)
    v_mfma_f32_16x16x32_bf16 v[216:219], a[168:171], a[56:59], v[216:219]
    ds_read_b128 a[196:199], v7 offset:48128
    v_mfma_f32_16x16x32_bf16 v[248:251], a[168:171], a[128:131], v[248:251]
    s_waitcnt vmcnt(5)
    s_waitcnt lgkmcnt(5)
    v_mfma_f32_16x16x32_bf16 v[192:195], a[172:175], a[60:63], v[192:195]
    ds_read_b128 a[144:147], v7 offset:49152
    v_mfma_f32_16x16x32_bf16 v[224:227], a[172:175], a[132:135], v[224:227]
    v_mfma_f32_16x16x32_bf16 v[196:199], a[176:179], a[60:63], v[196:199]
    ds_read_b128 a[148:151], v7 offset:50176
    v_mfma_f32_16x16x32_bf16 v[228:231], a[176:179], a[132:135], v[228:231]
    s_waitcnt lgkmcnt(5)
    v_mfma_f32_16x16x32_bf16 v[200:203], a[180:183], a[60:63], v[200:203]
    ds_read_b128 a[152:155], v7 offset:51200
    v_mfma_f32_16x16x32_bf16 v[232:235], a[180:183], a[132:135], v[232:235]
    v_mfma_f32_16x16x32_bf16 v[204:207], a[184:187], a[60:63], v[204:207]
    ds_read_b128 a[156:159], v7 offset:52224
    v_mfma_f32_16x16x32_bf16 v[236:239], a[184:187], a[132:135], v[236:239]
    s_waitcnt lgkmcnt(5)
    v_mfma_f32_16x16x32_bf16 v[208:211], a[60:63], a[188:191], v[208:211]
    ds_read_b128 a[160:163], v7 offset:53248
    v_mfma_f32_16x16x32_bf16 v[240:243], a[132:135], a[188:191], v[240:243]
    v_mfma_f32_16x16x32_bf16 v[212:215], a[60:63], a[192:195], v[212:215]
    ds_read_b128 a[164:167], v7 offset:54272
    v_mfma_f32_16x16x32_bf16 v[244:247], a[132:135], a[192:195], v[244:247]
    s_waitcnt lgkmcnt(6)
    v_mfma_f32_16x16x32_bf16 v[216:219], a[196:199], a[60:63], v[216:219]
    ds_read_b128 a[168:171], v7 offset:55296
    v_mfma_f32_16x16x32_bf16 v[248:251], a[196:199], a[132:135], v[248:251]
    s_waitcnt vmcnt(3)
    s_waitcnt lgkmcnt(5)
    v_mfma_f32_16x16x32_bf16 v[192:195], a[144:147], a[64:67], v[192:195]
    ds_read_b128 a[172:175], v7 offset:56320
    v_mfma_f32_16x16x32_bf16 v[224:227], a[144:147], a[136:139], v[224:227]
    v_mfma_f32_16x16x32_bf16 v[196:199], a[148:151], a[64:67], v[196:199]
    ds_read_b128 a[176:179], v7 offset:57344
    v_mfma_f32_16x16x32_bf16 v[228:231], a[148:151], a[136:139], v[228:231]
    s_waitcnt lgkmcnt(5)
    v_mfma_f32_16x16x32_bf16 v[200:203], a[152:155], a[64:67], v[200:203]
    ds_read_b128 a[180:183], v7 offset:58368
    v_mfma_f32_16x16x32_bf16 v[232:235], a[152:155], a[136:139], v[232:235]
    v_mfma_f32_16x16x32_bf16 v[204:207], a[156:159], a[64:67], v[204:207]
    ds_read_b128 a[184:187], v7 offset:59392
    v_mfma_f32_16x16x32_bf16 v[236:239], a[156:159], a[136:139], v[236:239]
    s_waitcnt lgkmcnt(5)
    v_mfma_f32_16x16x32_bf16 v[208:211], a[64:67], a[160:163], v[208:211]
    ds_read_b128 a[188:191], v7 offset:60416
    v_mfma_f32_16x16x32_bf16 v[240:243], a[136:139], a[160:163], v[240:243]
    v_mfma_f32_16x16x32_bf16 v[212:215], a[64:67], a[164:167], v[212:215]
    ds_read_b128 a[192:195], v7 offset:61440
    v_mfma_f32_16x16x32_bf16 v[244:247], a[136:139], a[164:167], v[244:247]
    s_waitcnt lgkmcnt(6)
    v_mfma_f32_16x16x32_bf16 v[216:219], a[168:171], a[64:67], v[216:219]
    ds_read_b128 a[196:199], v7 offset:62464
    v_mfma_f32_16x16x32_bf16 v[248:251], a[168:171], a[136:139], v[248:251]
    s_waitcnt vmcnt(1)
    s_waitcnt lgkmcnt(5)
    v_mfma_f32_16x16x32_bf16 v[192:195], a[172:175], a[68:71], v[192:195]
    v_mfma_f32_16x16x32_bf16 v[224:227], a[172:175], a[140:143], v[224:227]
    v_mfma_f32_16x16x32_bf16 v[196:199], a[176:179], a[68:71], v[196:199]
    v_mfma_f32_16x16x32_bf16 v[228:231], a[176:179], a[140:143], v[228:231]
    s_waitcnt lgkmcnt(3)
    v_mfma_f32_16x16x32_bf16 v[200:203], a[180:183], a[68:71], v[200:203]
    v_mfma_f32_16x16x32_bf16 v[232:235], a[180:183], a[140:143], v[232:235]
    v_mfma_f32_16x16x32_bf16 v[204:207], a[184:187], a[68:71], v[204:207]
    v_mfma_f32_16x16x32_bf16 v[236:239], a[184:187], a[140:143], v[236:239]
    s_waitcnt lgkmcnt(1)
    v_mfma_f32_16x16x32_bf16 v[208:211], a[68:71], a[188:191], v[208:211]
    v_mfma_f32_16x16x32_bf16 v[240:243], a[140:143], a[188:191], v[240:243]
    v_mfma_f32_16x16x32_bf16 v[212:215], a[68:71], a[192:195], v[212:215]
    v_mfma_f32_16x16x32_bf16 v[244:247], a[140:143], a[192:195], v[244:247]
    s_waitcnt lgkmcnt(0)
    v_mfma_f32_16x16x32_bf16 v[216:219], a[196:199], a[68:71], v[216:219]
    v_mfma_f32_16x16x32_bf16 v[248:251], a[196:199], a[140:143], v[248:251]
    v_pk_mul_f32 v[200:201], v[200:201], v[8:9] op_sel:[0,1] op_sel_hi:[1,1]
    v_pk_mul_f32 v[232:233], v[232:233], v[10:11] op_sel:[0,1] op_sel_hi:[1,1]
    v_pk_mul_f32 v[202:203], v[202:203], v[8:9] op_sel:[0,1] op_sel_hi:[1,1]
    v_pk_mul_f32 v[234:235], v[234:235], v[10:11] op_sel:[0,1] op_sel_hi:[1,1]
    v_pk_mul_f32 v[204:205], v[204:205], v[8:9] op_sel:[0,1] op_sel_hi:[1,1]
    v_pk_mul_f32 v[236:237], v[236:237], v[10:11] op_sel:[0,1] op_sel_hi:[1,1]
    v_pk_mul_f32 v[206:207], v[206:207], v[8:9] op_sel:[0,1] op_sel_hi:[1,1]
    v_pk_mul_f32 v[238:239], v[238:239], v[10:11] op_sel:[0,1] op_sel_hi:[1,1]
    v_cvt_pk_bf16_f32 v96, v200, v201
    v_cvt_pk_bf16_f32 v128, v232, v233
    v_cvt_pk_bf16_f32 v97, v202, v203
    v_cvt_pk_bf16_f32 v129, v234, v235
    v_cvt_pk_bf16_f32 v98, v204, v205
    v_cvt_pk_bf16_f32 v130, v236, v237
    v_cvt_pk_bf16_f32 v99, v206, v207
    v_cvt_pk_bf16_f32 v131, v238, v239
    v_pk_mul_f32 v[192:193], v[192:193], v[82:83] op_sel_hi:[1,0]
    v_pk_mul_f32 v[224:225], v[224:225], v[84:85] op_sel_hi:[1,0]
    v_pk_mul_f32 v[194:195], v[194:195], v[82:83] op_sel_hi:[1,0]
    v_pk_mul_f32 v[226:227], v[226:227], v[84:85] op_sel_hi:[1,0]
    v_pk_mul_f32 v[196:197], v[196:197], v[82:83] op_sel_hi:[1,0]
    v_pk_mul_f32 v[228:229], v[228:229], v[84:85] op_sel_hi:[1,0]
    v_pk_mul_f32 v[198:199], v[198:199], v[82:83] op_sel_hi:[1,0]
    v_pk_mul_f32 v[230:231], v[230:231], v[84:85] op_sel_hi:[1,0]
    v_cvt_pk_bf16_f32 v100, v192, v193
    v_cvt_pk_bf16_f32 v132, v224, v225
    v_cvt_pk_bf16_f32 v101, v194, v195
    v_cvt_pk_bf16_f32 v133, v226, v227
    v_cvt_pk_bf16_f32 v102, v196, v197
    v_cvt_pk_bf16_f32 v134, v228, v229
    v_cvt_pk_bf16_f32 v103, v198, v199
    v_cvt_pk_bf16_f32 v135, v230, v231
    v_pk_mul_f32 v[208:209], v[208:209], v[70:71]
    v_pk_mul_f32 v[240:241], v[240:241], v[78:79]
    v_pk_mul_f32 v[210:211], v[210:211], v[72:73]
    v_pk_mul_f32 v[242:243], v[242:243], v[80:81]
    v_cvt_pk_bf16_f32 v104, v208, v209
    v_cvt_pk_bf16_f32 v136, v240, v241
    v_cvt_pk_bf16_f32 v105, v210, v211
    v_cvt_pk_bf16_f32 v137, v242, v243
    v_pk_mul_f32 v[212:213], v[212:213], v[70:71]
    v_pk_mul_f32 v[244:245], v[244:245], v[78:79]
    v_pk_mul_f32 v[214:215], v[214:215], v[72:73]
    v_pk_mul_f32 v[246:247], v[246:247], v[80:81]
    v_cvt_pk_bf16_f32 v106, v212, v213
    v_cvt_pk_bf16_f32 v138, v244, v245
    v_cvt_pk_bf16_f32 v107, v214, v215
    v_cvt_pk_bf16_f32 v139, v246, v247
    v_pk_mul_f32 v[216:217], v[216:217], v[82:83] op_sel:[0,1] op_sel_hi:[1,1]
    v_pk_mul_f32 v[248:249], v[248:249], v[84:85] op_sel:[0,1] op_sel_hi:[1,1]
    v_pk_mul_f32 v[218:219], v[218:219], v[82:83] op_sel:[0,1] op_sel_hi:[1,1]
    v_pk_mul_f32 v[250:251], v[250:251], v[84:85] op_sel:[0,1] op_sel_hi:[1,1]
    v_cvt_pk_bf16_f32 v108, v216, v217
    v_cvt_pk_bf16_f32 v140, v248, v249
    v_cvt_pk_bf16_f32 v109, v218, v219
    v_cvt_pk_bf16_f32 v141, v250, v251
    s_barrier
    ds_write_b128 v86, v[96:99] offset:0
    ds_write_b64 v88, v[104:105] offset:0
    ds_write_b64 v88, v[106:107] offset:29696
    ds_write_b128 v86, v[128:131] offset:256
    ds_write_b64 v88, v[136:137] offset:640
    ds_write_b64 v88, v[138:139] offset:30336
    s_mov_b32 exec_hi, 0
    ds_write_b32 v91, v108 offset:0
    ds_write_b32 v65, v109 offset:0
    ds_write_b32 v91, v140 offset:64
    ds_write_b32 v65, v141 offset:64
    s_mov_b32 exec_lo, 0xff
    ds_write_b128 v90, v[92:95] offset:0
    ds_write_b128 v90, v[92:95] offset:640
    s_mov_b32 exec_lo, 0
    s_mov_b32 exec_hi, 0xffff
    ds_write_b16 v89, v108 offset:0
    ds_write_b16_d16_hi v89, v108 offset:16
    ds_write_b16 v89, v109 offset:29696
    ds_write_b16_d16_hi v89, v109 offset:29712
    ds_write_b16 v89, v140 offset:640
    ds_write_b16_d16_hi v89, v140 offset:656
    ds_write_b16 v89, v141 offset:30336
    ds_write_b16_d16_hi v89, v141 offset:30352
    s_mov_b64 exec, -1
    ds_write_b128 v87, v[100:103] offset:0
    ds_write_b128 v87, v[132:135] offset:256
    s_add_u32 s61, s44, 56320
    v_add_u32 v66, s61, v4
    s_mul_i32 s61, s40, 1280
    s_add_u32 s61, s61, 70656
    v_add_u32 v67, s61, v4
    s_lshl_b32 s61, s40, 7
    s_add_u32 s61, s61, 47104
    v_add_u32 v68, s61, v4
    s_waitcnt lgkmcnt(0)
    ds_read_b128 v[160:163], v66 offset:0
    ds_read_b128 v[164:167], v67 offset:0
    ds_read_b128 v[168:171], v67 offset:1024
    ds_read_b128 v[172:175], v68 offset:0
    ds_read_b128 v[176:179], v66 offset:29696
    ds_read_b128 v[180:183], v67 offset:29696
    ds_read_b128 v[184:187], v67 offset:30720
    ds_read_b128 v[188:191], v68 offset:29696
    s_waitcnt lgkmcnt(6)
    buffer_store_dwordx4 v[160:163], v4, s[68:71], s64 offen sc1
    buffer_store_dwordx4 v[164:167], v4, s[76:79], s88 offen sc1
    s_waitcnt lgkmcnt(2)
    buffer_store_dwordx4 v[176:179], v4, s[68:71], s65 offen sc1
    buffer_store_dwordx4 v[180:183], v4, s[76:79], s89 offen sc1
    s_waitcnt lgkmcnt(0)
    s_mov_b64 exec, 0xffff
    buffer_store_dwordx4 v[168:171], v4, s[76:79], s88 offen offset:1024 sc1
    buffer_store_dwordx4 v[184:187], v4, s[76:79], s89 offen offset:1024 sc1
    s_mov_b64 exec, 0xff
    buffer_store_dwordx4 v[172:175], v4, s[72:75], s66 offen sc1
    buffer_store_dwordx4 v[188:191], v4, s[72:75], s67 offen sc1
    s_mov_b64 exec, -1
    s_mov_b32 s0, s92
    s_lshl_b32 s61, s42, 17
    s_add_u32 s61, s61, s16
    s_add_u32 s24, s22, 28545024
    s_addc_u32 s25, s23, 0
    s_add_u32 s24, s24, s61
    s_addc_u32 s25, s25, 0
    s_mov_b32 s26, 65536
    s_mov_b32 s27, 0x00020000
    s_lshl_b32 s61, s42, 14
    s_add_u32 s61, s61, s16
    s_add_u32 s36, s22, 30904320
    s_addc_u32 s37, s23, 0
    s_add_u32 s36, s36, s61
    s_addc_u32 s37, s37, 0
    s_mov_b32 s38, 8192
    s_mov_b32 s39, 0x00020000
    s_lshl_b32 s38, s41, 9
    s_add_u32 s38, s38, 512
    s_mul_i32 s61, s42, 163840
    s_add_u32 s61, s61, s16
    s_add_u32 s32, s22, 31166464
    s_addc_u32 s33, s23, 0
    s_add_u32 s32, s32, s61
    s_addc_u32 s33, s33, 0
    s_mov_b32 s34, 81920
    s_mov_b32 s35, 0x00020000
    s_lshl_b32 s46, s41, 2
    s_add_u32 s46, s46, s40
    s_mul_i32 s61, s46, 36864
    s_add_u32 s61, s61, s45
    s_add_u32 s8, s22, 9146368
    s_addc_u32 s9, s23, 0
    s_add_u32 s8, s8, s61
    s_addc_u32 s9, s9, 0
    s_mov_b32 s10, 36864
    s_mov_b32 s11, 0x00020000
    s_min_u32 s61, s41, 2
    s_lshl_b32 s14, 3, 2
    s_sub_u32 s61, 2, s61
    s_lshl_b32 s14, 3, s61
    s_and_b32 s14, s14, 3
    s_mov_b32 s15, 0
    s_lshl_b32 s47, s3, 13
    s_lshl_b32 s61, s41, 8
    s_add_u32 s47, s47, s61
    s_add_u32 s47, s47, 200704
    s_lshl_b32 s61, s42, 2
    s_add_u32 s47, s47, s61
    v_mov_b32 v13, 0
    v_mov_b32 v14, 0
    v_mov_b32 v15, 0
    v_mov_b32 v245, 0
    v_mov_b32 v246, 0
    v_mov_b32 v247, 0
    v_mov_b32 v21, 0
    v_mov_b32 v22, 0
    v_mov_b32 v23, 0
    v_mov_b32 v29, 0
    v_mov_b32 v30, 0
    v_mov_b32 v31, 0
    v_mov_b32 v37, 0
    v_mov_b32 v38, 0
    v_mov_b32 v39, 0
    v_accvgpr_read_b32 v48, a233
    v_accvgpr_read_b32 v49, a234
    v_accvgpr_read_b32 v50, a235
    v_accvgpr_read_b32 v51, a236
    v_accvgpr_read_b32 v55, a246
    v_accvgpr_read_b32 v56, a245
    v_accvgpr_read_b32 v60, a231
    v_accvgpr_read_b32 v61, a232
    v_accvgpr_read_b32 v64, a247
    v_accvgpr_read_b32 v67, a248
    v_accvgpr_read_b32 v68, a249
    v_accvgpr_read_b32 v40, a237
    v_accvgpr_read_b32 v41, a238
    v_accvgpr_read_b32 v42, a239
    v_accvgpr_read_b32 v43, a240
    v_accvgpr_read_b32 v44, a241
    v_accvgpr_read_b32 v45, a242
    v_accvgpr_read_b32 v46, a243
    v_accvgpr_read_b32 v47, a244
    v_cmp_le_i32 s[64:65], 0, v51
    v_cmp_le_i32 s[66:67], 1, v51
    v_cmp_le_i32 s[68:69], 2, v51
    v_cmp_le_i32 s[70:71], 3, v51
    v_cmp_le_i32 s[72:73], 8, v51
    v_cmp_le_i32 s[74:75], 9, v51
    v_cmp_le_i32 s[76:77], 10, v51
    v_cmp_le_i32 s[78:79], 11, v51
    v_cmp_le_i32 s[80:81], 16, v51
    v_cmp_le_i32 s[82:83], 17, v51
    v_cmp_le_i32 s[84:85], 18, v51
    v_cmp_le_i32 s[86:87], 19, v51
    v_cmp_le_i32 s[88:89], 24, v51
    v_cmp_le_i32 s[90:91], 25, v51
    v_cmp_le_i32 s[92:93], 26, v51
    v_cmp_le_i32 s[94:95], 27, v51
    v_add_u32 v65, 1024, v64
    s_mul_i32 s55, s40, 3072
    s_add_u32 s61, s55, 0
    s_min_u32 s61, s61, 9216
    v_add_u32 v69, s61, v68
    s_add_u32 s61, s55, 1024
    s_min_u32 s61, s61, 9216
    v_add_u32 v70, s61, v68
    s_add_u32 s61, s55, 2048
    s_min_u32 s61, s61, 9216
    v_add_u32 v71, s61, v68
    s_mul_i32 s61, s40, 3072
    s_add_u32 s61, s61, 106496
    v_add_u32 v52, s61, v4
    v_add_u32 v53, s61, v61
    ds_read_b128 v[8:11], v52
    ds_read_b128 v[240:243], v52 offset:1024
    ds_read_b32 v12, v53 offset:2048
    ds_read_b32 v244, v53 offset:2176
    s_sub_i32 s54, 8, s46
    s_waitcnt vmcnt(0) lgkmcnt(0)
    s_barrier
    s_cmp_lg_u32 s40, 0
    s_cbranch_scc1 mega_kernel_nosig31
    v_mov_b32 v5, s2
    s_mov_b64 exec, 1
    buffer_store_dword v5, off, s[48:51], s0 sc1
    s_mov_b64 exec, -1
mega_kernel_nosig31:
    s_nop 3
    s_cmp_lg_u32 s40, 0
    s_cbranch_scc1 mega_kernel_nopoll32
    s_mov_b32 s62, 0
mega_kernel_poll33:
    buffer_load_dword v5, v60, s[48:51], s17 offen sc1
    s_add_u32 s62, s62, 1
    s_waitcnt vmcnt(0)
    v_cmp_ne_u32 vcc, s2, v5
    s_nop 0
    s_and_b64 vcc, vcc, s[14:15]
    s_cbranch_scc0 mega_kernel_nopoll32
    s_cmp_lt_u32 s62, 262144
    s_sleep 1
    s_cbranch_scc1 mega_kernel_poll33
mega_kernel_nopoll32:
    s_waitcnt vmcnt(0) lgkmcnt(0)
    s_barrier
    s_lshl_b32 s61, s40, 11
    s_add_u32 s62, s61, 48128
    s_mov_b32 m0, s62
    s_nop 0
    buffer_load_dwordx4 v64, s[24:27], 0 offen sc1 lds
    s_add_u32 s62, s61, 49152
    s_mov_b32 m0, s62
    s_nop 0
    buffer_load_dwordx4 v65, s[24:27], 0 offen sc1 lds
    s_mov_b32 m0, 46080
    s_nop 0
    buffer_load_dwordx4 v67, s[36:39], 0 offen sc1 lds
    s_add_u32 s62, s55, 0
    s_min_u32 s62, s62, 9216
    s_add_u32 s62, s62, 60416
    s_mov_b32 m0, s62
    s_nop 0
    buffer_load_dwordx4 v69, s[32:35], 0 offen sc1 lds
    s_add_u32 s62, s55, 1024
    s_min_u32 s62, s62, 9216
    s_add_u32 s62, s62, 60416
    s_mov_b32 m0, s62
    s_nop 0
    buffer_load_dwordx4 v70, s[32:35], 0 offen sc1 lds
    s_add_u32 s62, s55, 2048
    s_min_u32 s62, s62, 9216
    s_add_u32 s62, s62, 60416
    s_mov_b32 m0, s62
    s_nop 0
    buffer_load_dwordx4 v71, s[32:35], 0 offen sc1 lds
    s_add_u32 s24, s24, 65536
    s_addc_u32 s25, s25, 0
    s_add_u32 s36, s36, 8192
    s_addc_u32 s37, s37, 0
    s_add_u32 s32, s32, 81920
    s_addc_u32 s33, s33, 0
    s_lshl_b32 s61, s40, 11
    s_add_u32 s62, s61, 77824
    s_mov_b32 m0, s62
    s_nop 0
    buffer_load_dwordx4 v64, s[24:27], 0 offen sc1 lds
    s_add_u32 s62, s61, 78848
    s_mov_b32 m0, s62
    s_nop 0
    buffer_load_dwordx4 v65, s[24:27], 0 offen sc1 lds
    s_mov_b32 m0, 75776
    s_nop 0
    buffer_load_dwordx4 v67, s[36:39], 0 offen sc1 lds
    s_add_u32 s62, s55, 0
    s_min_u32 s62, s62, 9216
    s_add_u32 s62, s62, 90112
    s_mov_b32 m0, s62
    s_nop 0
    buffer_load_dwordx4 v69, s[32:35], 0 offen sc1 lds
    s_add_u32 s62, s55, 1024
    s_min_u32 s62, s62, 9216
    s_add_u32 s62, s62, 90112
    s_mov_b32 m0, s62
    s_nop 0
    buffer_load_dwordx4 v70, s[32:35], 0 offen sc1 lds
    s_add_u32 s62, s55, 2048
    s_min_u32 s62, s62, 9216
    s_add_u32 s62, s62, 90112
    s_mov_b32 m0, s62
    s_nop 0
    buffer_load_dwordx4 v71, s[32:35], 0 offen sc1 lds
    v_cmp_gt_u32 vcc, 32, v1
    s_nop 1
    v_cndmask_b32 v12, 0, v12, vcc
    v_cndmask_b32 v244, 0, v244, vcc
    s_mul_i32 s61, s42, 43008
    s_and_b32 s62, s3, 1
    s_mul_i32 s62, s62, 2932736
    s_add_u32 s61, s61, s62
    s_add_u32 s4, s22, 2097152
    s_addc_u32 s5, s23, 0
    s_add_u32 s4, s4, s61
    s_addc_u32 s5, s5, 0
    s_mov_b32 s6, 43008
    s_mov_b32 s7, 0x00020000
    s_add_u32 s63, s3, 1
    s_and_b32 s61, s63, 1
    s_mul_i32 s62, s61, 2932736
    s_lshl_b32 s63, s42, 17
    s_add_u32 s62, s62, s63
    s_add_u32 s28, s22, s62
    s_addc_u32 s29, s23, 0
    s_mov_b32 s30, 131072
    s_mov_b32 s31, 0x00020000
    s_cmp_gt_i32 s54, 0
    s_cselect_b32 s61, 0xf149f2ca, 0
    v_mov_b32 v208, s61
    v_mov_b32 v209, s61
    v_mov_b32 v210, s61
    v_mov_b32 v211, s61
    v_mov_b32 v212, s61
    v_mov_b32 v213, s61
    v_mov_b32 v214, s61
    v_mov_b32 v215, s61
    v_mov_b32 v216, s61
    v_mov_b32 v217, s61
    v_mov_b32 v218, s61
    v_mov_b32 v219, s61
    v_mov_b32 v220, s61
    v_mov_b32 v221, s61
    v_mov_b32 v222, s61
    v_mov_b32 v223, s61
    s_waitcnt vmcnt(9)
    s_barrier
    ds_read_b128 v[16:19], v48 offset:0
    ds_read_b32 v20, v49 offset:0
    ds_read_b128 v[24:27], v48 offset:1024
    ds_read_b32 v28, v49 offset:128
    ds_read_b128 v[32:35], v48 offset:2048
    ds_read_b32 v36, v49 offset:256
    s_waitcnt lgkmcnt(4)
    v_mfma_f32_32x32x16_bf16 v[64:79], v[16:19], v[8:11], v[208:223]
    v_mfma_f32_32x32x16_bf16 v[64:79], v[20:23], v[12:15], v[64:79]
    ds_read_b128 v[16:19], v48 offset:3072
    ds_read_b32 v20, v49 offset:384
    s_cmp_eq_u32 s54, 1
    s_cbranch_scc1 mega_kernel_cz34
mega_kernel_cz34_back:
    s_waitcnt lgkmcnt(4)
    v_mfma_f32_32x32x16_bf16 v[80:95], v[24:27], v[8:11], v[208:223]
    v_mfma_f32_32x32x16_bf16 v[80:95], v[28:31], v[12:15], v[80:95]
    ds_read_b128 v[24:27], v48 offset:4096
    ds_read_b32 v28, v49 offset:512
    s_cmp_eq_u32 s54, 2
    s_cbranch_scc1 mega_kernel_cz35
mega_kernel_cz35_back:
    s_waitcnt lgkmcnt(4)
    v_mfma_f32_32x32x16_bf16 v[96:111], v[32:35], v[8:11], v[208:223]
    v_mfma_f32_32x32x16_bf16 v[96:111], v[36:39], v[12:15], v[96:111]
    s_nop 4
    v_max3_f32 v57, v80, v81, v82
    v_max_f32 v57, v57, v83
    v_max3_f32 v57, v57, v84, v85
    v_max3_f32 v57, v57, v86, v87
    v_max3_f32 v57, v57, v88, v89
    v_max3_f32 v57, v57, v90, v91
    v_max3_f32 v57, v57, v92, v93
    v_max3_f32 v57, v57, v94, v95
    ds_read_b128 v[32:35], v48 offset:5120
    ds_read_b32 v36, v49 offset:640
    s_cmp_eq_u32 s54, 3
    s_cbranch_scc1 mega_kernel_cz36
mega_kernel_cz36_back:
    s_waitcnt lgkmcnt(4)
    v_mfma_f32_32x32x16_bf16 v[112:127], v[16:19], v[8:11], v[208:223]
    v_mfma_f32_32x32x16_bf16 v[112:127], v[20:23], v[12:15], v[112:127]
    v_max3_f32 v57, v57, v96, v97
    v_max3_f32 v57, v57, v98, v99
    v_max3_f32 v57, v57, v100, v101
    v_max3_f32 v57, v57, v102, v103
    v_max3_f32 v57, v57, v104, v105
    v_max3_f32 v57, v57, v106, v107
    v_max3_f32 v57, v57, v108, v109
    v_max3_f32 v57, v57, v110, v111
    ds_read_b128 v[16:19], v48 offset:6144
    ds_read_b32 v20, v49 offset:768
    s_cmp_eq_u32 s54, 4
    s_cbranch_scc1 mega_kernel_cz37
mega_kernel_cz37_back:
    s_waitcnt lgkmcnt(4)
    v_mfma_f32_32x32x16_bf16 v[128:143], v[24:27], v[8:11], v[208:223]
    v_mfma_f32_32x32x16_bf16 v[128:143], v[28:31], v[12:15], v[128:143]
    v_max3_f32 v57, v57, v112, v113
    v_max3_f32 v57, v57, v114, v115
    v_max3_f32 v57, v57, v116, v117
    v_max3_f32 v57, v57, v118, v119
    v_max3_f32 v57, v57, v120, v121
    v_max3_f32 v57, v57, v122, v123
    v_max3_f32 v57, v57, v124, v125
    v_max3_f32 v57, v57, v126, v127
    ds_read_b128 v[24:27], v48 offset:7168
    ds_read_b32 v28, v49 offset:896
    s_cmp_eq_u32 s54, 5
    s_cbranch_scc1 mega_kernel_cz38
mega_kernel_cz38_back:
    s_waitcnt lgkmcnt(4)
    v_mfma_f32_32x32x16_bf16 v[144:159], v[32:35], v[8:11], v[208:223]
    v_mfma_f32_32x32x16_bf16 v[144:159], v[36:39], v[12:15], v[144:159]
    v_max3_f32 v57, v57, v128, v129
    v_max3_f32 v57, v57, v130, v131
    v_max3_f32 v57, v57, v132, v133
    v_max3_f32 v57, v57, v134, v135
    v_max3_f32 v57, v57, v136, v137
    v_max3_f32 v57, v57, v138, v139
    v_max3_f32 v57, v57, v140, v141
    v_max3_f32 v57, v57, v142, v143
    ds_read_b128 v[32:35], v48 offset:8192
    ds_read_b32 v36, v49 offset:1024
    s_cmp_eq_u32 s54, 6
    s_cbranch_scc1 mega_kernel_cz39
mega_kernel_cz39_back:
    s_waitcnt lgkmcnt(4)
    v_mfma_f32_32x32x16_bf16 v[160:175], v[16:19], v[8:11], v[208:223]
    v_mfma_f32_32x32x16_bf16 v[160:175], v[20:23], v[12:15], v[160:175]
    v_max3_f32 v57, v57, v144, v145
    v_max3_f32 v57, v57, v146, v147
    v_max3_f32 v57, v57, v148, v149
    v_max3_f32 v57, v57, v150, v151
    v_max3_f32 v57, v57, v152, v153
    v_max3_f32 v57, v57, v154, v155
    v_max3_f32 v57, v57, v156, v157
    v_max3_f32 v57, v57, v158, v159
    s_cmp_eq_u32 s54, 7
    s_cbranch_scc1 mega_kernel_cz40
mega_kernel_cz40_back:
    s_waitcnt lgkmcnt(2)
    v_mfma_f32_32x32x16_bf16 v[176:191], v[24:27], v[8:11], v[208:223]
    v_mfma_f32_32x32x16_bf16 v[176:191], v[28:31], v[12:15], v[176:191]
    v_max3_f32 v57, v57, v160, v161
    v_max3_f32 v57, v57, v162, v163
    v_max3_f32 v57, v57, v164, v165
    v_max3_f32 v57, v57, v166, v167
    v_max3_f32 v57, v57, v168, v169
    v_max3_f32 v57, v57, v170, v171
    v_max3_f32 v57, v57, v172, v173
    v_max3_f32 v57, v57, v174, v175
    s_cmp_eq_u32 s54, 8
    s_cbranch_scc1 mega_kernel_cz41
mega_kernel_cz41_back:
    s_waitcnt lgkmcnt(0)
    v_mfma_f32_32x32x16_bf16 v[192:207], v[32:35], v[8:11], v[208:223]
    v_mfma_f32_32x32x16_bf16 v[192:207], v[36:39], v[12:15], v[192:207]
    v_max3_f32 v57, v57, v176, v177
    v_max3_f32 v57, v57, v178, v179
    v_max3_f32 v57, v57, v180, v181
    v_max3_f32 v57, v57, v182, v183
    v_max3_f32 v57, v57, v184, v185
    v_max3_f32 v57, v57, v186, v187
    v_max3_f32 v57, v57, v188, v189
    v_max3_f32 v57, v57, v190, v191
    s_waitcnt vmcnt(6)
    s_barrier
    ds_read_b128 a[0:3], v50 offset:1280
    ds_read_b128 a[4:7], v50 offset:1920
    ds_read_b128 a[8:11], v50 offset:2560
    ds_read_b128 a[12:15], v50 offset:3200
    v_cndmask_b32 v192, v64, v192, s[64:65]
    v_cndmask_b32 v193, v65, v193, s[66:67]
    v_cndmask_b32 v194, v66, v194, s[68:69]
    v_cndmask_b32 v195, v67, v195, s[70:71]
    v_cndmask_b32 v196, v68, v196, s[72:73]
    v_cndmask_b32 v197, v69, v197, s[74:75]
    v_cndmask_b32 v198, v70, v198, s[76:77]
    v_cndmask_b32 v199, v71, v199, s[78:79]
    v_cndmask_b32 v200, v72, v200, s[80:81]
    v_cndmask_b32 v201, v73, v201, s[82:83]
    v_cndmask_b32 v202, v74, v202, s[84:85]
    v_cndmask_b32 v203, v75, v203, s[86:87]
    v_cndmask_b32 v204, v76, v204, s[88:89]
    v_cndmask_b32 v205, v77, v205, s[90:91]
    v_cndmask_b32 v206, v78, v206, s[92:93]
    v_cndmask_b32 v207, v79, v207, s[94:95]
    v_max3_f32 v57, v57, v192, v193
    v_max3_f32 v57, v57, v194, v195
    v_max3_f32 v57, v57, v196, v197
    v_max3_f32 v57, v57, v198, v199
    v_max3_f32 v57, v57, v200, v201
    v_max3_f32 v57, v57, v202, v203
    v_max3_f32 v57, v57, v204, v205
    v_max3_f32 v57, v57, v206, v207
    v_mov_b32 v58, v57
    s_nop 1
    v_permlane32_swap_b32 v57, v58
    v_max_f32 v57, v57, v58
    v_sub_f32 v58, 0, v57
    v_sub_f32 v59, 0, v57
    v_pk_add_f32 v[80:81], v[80:81], v[58:59]
    v_pk_add_f32 v[82:83], v[82:83], v[58:59]
    v_pk_add_f32 v[84:85], v[84:85], v[58:59]
    v_pk_add_f32 v[86:87], v[86:87], v[58:59]
    v_exp_f32 v80, v80
    v_exp_f32 v81, v81
    v_exp_f32 v82, v82
    v_exp_f32 v83, v83
    v_exp_f32 v84, v84
    v_exp_f32 v85, v85
    v_exp_f32 v86, v86
    v_exp_f32 v87, v87
    s_mul_i32 s52, s44, 4
    s_add_u32 s52, s52, 0
    s_add_u32 m0, s52, 131072
    s_nop 0
    buffer_load_dwordx4 v4, s[4:7], s52 offen offset:0 lds
    v_cvt_pk_bf16_f32 v80, v80, v81
    v_cvt_pk_bf16_f32 v81, v82, v83
    v_cvt_pk_bf16_f32 v82, v84, v85
    v_cvt_pk_bf16_f32 v83, v86, v87
    v_pk_add_f32 v[88:89], v[88:89], v[58:59]
    v_pk_add_f32 v[90:91], v[90:91], v[58:59]
    v_pk_add_f32 v[92:93], v[92:93], v[58:59]
    v_pk_add_f32 v[94:95], v[94:95], v[58:59]
    v_exp_f32 v88, v88
    v_exp_f32 v89, v89
    v_exp_f32 v90, v90
    v_exp_f32 v91, v91
    v_exp_f32 v92, v92
    v_exp_f32 v93, v93
    v_exp_f32 v94, v94
    v_exp_f32 v95, v95
    buffer_load_dwordx4 v4, s[4:7], s52 offen offset:1024 lds
    v_cvt_pk_bf16_f32 v84, v88, v89
    v_cvt_pk_bf16_f32 v85, v90, v91
    v_cvt_pk_bf16_f32 v86, v92, v93
    v_cvt_pk_bf16_f32 v87, v94, v95
    v_pk_add_f32 v[96:97], v[96:97], v[58:59]
    v_pk_add_f32 v[98:99], v[98:99], v[58:59]
    v_pk_add_f32 v[100:101], v[100:101], v[58:59]
    v_pk_add_f32 v[102:103], v[102:103], v[58:59]
    v_exp_f32 v96, v96
    v_exp_f32 v97, v97
    v_exp_f32 v98, v98
    v_exp_f32 v99, v99
    v_exp_f32 v100, v100
    v_exp_f32 v101, v101
    v_exp_f32 v102, v102
    v_exp_f32 v103, v103
    s_waitcnt lgkmcnt(3)
    v_mfma_f32_32x32x16_bf16 v[224:239], a[0:3], v[80:83], 0
    ds_read_b128 a[0:3], v50 offset:3840
    buffer_load_dwordx4 v4, s[4:7], s52 offen offset:2048 lds
    v_cvt_pk_bf16_f32 v96, v96, v97
    v_cvt_pk_bf16_f32 v97, v98, v99
    v_cvt_pk_bf16_f32 v98, v100, v101
    v_cvt_pk_bf16_f32 v99, v102, v103
    v_pk_add_f32 v[104:105], v[104:105], v[58:59]
    v_pk_add_f32 v[106:107], v[106:107], v[58:59]
    v_pk_add_f32 v[108:109], v[108:109], v[58:59]
    v_pk_add_f32 v[110:111], v[110:111], v[58:59]
    v_exp_f32 v104, v104
    v_exp_f32 v105, v105
    v_exp_f32 v106, v106
    v_exp_f32 v107, v107
    v_exp_f32 v108, v108
    v_exp_f32 v109, v109
    v_exp_f32 v110, v110
    v_exp_f32 v111, v111
    s_waitcnt lgkmcnt(3)
    v_mfma_f32_32x32x16_bf16 v[224:239], a[4:7], v[84:87], v[224:239]
    ds_read_b128 a[4:7], v50 offset:4480
    buffer_load_dwordx4 v4, s[4:7], s52 offen offset:3072 lds
    v_cvt_pk_bf16_f32 v100, v104, v105
    v_cvt_pk_bf16_f32 v101, v106, v107
    v_cvt_pk_bf16_f32 v102, v108, v109
    v_cvt_pk_bf16_f32 v103, v110, v111
    v_pk_add_f32 v[112:113], v[112:113], v[58:59]
    v_pk_add_f32 v[114:115], v[114:115], v[58:59]
    v_pk_add_f32 v[116:117], v[116:117], v[58:59]
    v_pk_add_f32 v[118:119], v[118:119], v[58:59]
    v_exp_f32 v112, v112
    v_exp_f32 v113, v113
    v_exp_f32 v114, v114
    v_exp_f32 v115, v115
    v_exp_f32 v116, v116
    v_exp_f32 v117, v117
    v_exp_f32 v118, v118
    v_exp_f32 v119, v119
    s_waitcnt lgkmcnt(3)
    v_mfma_f32_32x32x16_bf16 v[224:239], a[8:11], v[96:99], v[224:239]
    ds_read_b128 a[8:11], v50 offset:5120
    s_mul_i32 s52, s44, 4
    s_add_u32 s52, s52, 16384
    s_min_u32 s52, s52, 26624
    s_add_u32 m0, s52, 131072
    s_nop 0
    buffer_load_dwordx4 v4, s[4:7], s52 offen offset:0 lds
    v_cvt_pk_bf16_f32 v112, v112, v113
    v_cvt_pk_bf16_f32 v113, v114, v115
    v_cvt_pk_bf16_f32 v114, v116, v117
    v_cvt_pk_bf16_f32 v115, v118, v119
    v_pk_add_f32 v[120:121], v[120:121], v[58:59]
    v_pk_add_f32 v[122:123], v[122:123], v[58:59]
    v_pk_add_f32 v[124:125], v[124:125], v[58:59]
    v_pk_add_f32 v[126:127], v[126:127], v[58:59]
    v_exp_f32 v120, v120
    v_exp_f32 v121, v121
    v_exp_f32 v122, v122
    v_exp_f32 v123, v123
    v_exp_f32 v124, v124
    v_exp_f32 v125, v125
    v_exp_f32 v126, v126
    v_exp_f32 v127, v127
    s_waitcnt lgkmcnt(3)
    v_mfma_f32_32x32x16_bf16 v[224:239], a[12:15], v[100:103], v[224:239]
    ds_read_b128 a[12:15], v50 offset:5760
    buffer_load_dwordx4 v4, s[4:7], s52 offen offset:1024 lds
    v_cvt_pk_bf16_f32 v116, v120, v121
    v_cvt_pk_bf16_f32 v117, v122, v123
    v_cvt_pk_bf16_f32 v118, v124, v125
    v_cvt_pk_bf16_f32 v119, v126, v127
    v_pk_add_f32 v[128:129], v[128:129], v[58:59]
    v_pk_add_f32 v[130:131], v[130:131], v[58:59]
    v_pk_add_f32 v[132:133], v[132:133], v[58:59]
    v_pk_add_f32 v[134:135], v[134:135], v[58:59]
    v_exp_f32 v128, v128
    v_exp_f32 v129, v129
    v_exp_f32 v130, v130
    v_exp_f32 v131, v131
    v_exp_f32 v132, v132
    v_exp_f32 v133, v133
    v_exp_f32 v134, v134
    v_exp_f32 v135, v135
    s_waitcnt lgkmcnt(3)
    v_mfma_f32_32x32x16_bf16 v[224:239], a[0:3], v[112:115], v[224:239]
    ds_read_b128 a[0:3], v50 offset:6400
    buffer_load_dwordx4 v4, s[4:7], s52 offen offset:2048 lds
    v_cvt_pk_bf16_f32 v128, v128, v129
    v_cvt_pk_bf16_f32 v129, v130, v131
    v_cvt_pk_bf16_f32 v130, v132, v133
    v_cvt_pk_bf16_f32 v131, v134, v135
    v_pk_add_f32 v[136:137], v[136:137], v[58:59]
    v_pk_add_f32 v[138:139], v[138:139], v[58:59]
    v_pk_add_f32 v[140:141], v[140:141], v[58:59]
    v_pk_add_f32 v[142:143], v[142:143], v[58:59]
    v_exp_f32 v136, v136
    v_exp_f32 v137, v137
    v_exp_f32 v138, v138
    v_exp_f32 v139, v139
    v_exp_f32 v140, v140
    v_exp_f32 v141, v141
    v_exp_f32 v142, v142
    v_exp_f32 v143, v143
    s_waitcnt lgkmcnt(3)
    v_mfma_f32_32x32x16_bf16 v[224:239], a[4:7], v[116:119], v[224:239]
    ds_read_b128 a[4:7], v50 offset:7040
    buffer_load_dwordx4 v4, s[4:7], s52 offen offset:3072 lds
    v_cvt_pk_bf16_f32 v132, v136, v137
    v_cvt_pk_bf16_f32 v133, v138, v139
    v_cvt_pk_bf16_f32 v134, v140, v141
    v_cvt_pk_bf16_f32 v135, v142, v143
    v_pk_add_f32 v[144:145], v[144:145], v[58:59]
    v_pk_add_f32 v[146:147], v[146:147], v[58:59]
    v_pk_add_f32 v[148:149], v[148:149], v[58:59]
    v_pk_add_f32 v[150:151], v[150:151], v[58:59]
    v_exp_f32 v144, v144
    v_exp_f32 v145, v145
    v_exp_f32 v146, v146
    v_exp_f32 v147, v147
    v_exp_f32 v148, v148
    v_exp_f32 v149, v149
    v_exp_f32 v150, v150
    v_exp_f32 v151, v151
    s_waitcnt lgkmcnt(3)
    v_mfma_f32_32x32x16_bf16 v[224:239], a[8:11], v[128:131], v[224:239]
    ds_read_b128 a[8:11], v50 offset:7680
    s_mul_i32 s52, s44, 3
    s_add_u32 s52, s52, 30720
    s_add_u32 m0, s52, 88064
    s_nop 0
    buffer_load_dwordx4 v4, s[4:7], s52 offen offset:0 lds
    v_cvt_pk_bf16_f32 v144, v144, v145
    v_cvt_pk_bf16_f32 v145, v146, v147
    v_cvt_pk_bf16_f32 v146, v148, v149
    v_cvt_pk_bf16_f32 v147, v150, v151
    v_pk_add_f32 v[152:153], v[152:153], v[58:59]
    v_pk_add_f32 v[154:155], v[154:155], v[58:59]
    v_pk_add_f32 v[156:157], v[156:157], v[58:59]
    v_pk_add_f32 v[158:159], v[158:159], v[58:59]
    v_exp_f32 v152, v152
    v_exp_f32 v153, v153
    v_exp_f32 v154, v154
    v_exp_f32 v155, v155
    v_exp_f32 v156, v156
    v_exp_f32 v157, v157
    v_exp_f32 v158, v158
    v_exp_f32 v159, v159
    s_waitcnt lgkmcnt(3)
    v_mfma_f32_32x32x16_bf16 v[224:239], a[12:15], v[132:135], v[224:239]
    ds_read_b128 a[12:15], v50 offset:8320
    buffer_load_dwordx4 v4, s[4:7], s52 offen offset:1024 lds
    v_cvt_pk_bf16_f32 v148, v152, v153
    v_cvt_pk_bf16_f32 v149, v154, v155
    v_cvt_pk_bf16_f32 v150, v156, v157
    v_cvt_pk_bf16_f32 v151, v158, v159
    v_pk_add_f32 v[160:161], v[160:161], v[58:59]
    v_pk_add_f32 v[162:163], v[162:163], v[58:59]
    v_pk_add_f32 v[164:165], v[164:165], v[58:59]
    v_pk_add_f32 v[166:167], v[166:167], v[58:59]
    v_exp_f32 v160, v160
    v_exp_f32 v161, v161
    v_exp_f32 v162, v162
    v_exp_f32 v163, v163
    v_exp_f32 v164, v164
    v_exp_f32 v165, v165
    v_exp_f32 v166, v166
    v_exp_f32 v167, v167
    s_waitcnt lgkmcnt(3)
    v_mfma_f32_32x32x16_bf16 v[224:239], a[0:3], v[144:147], v[224:239]
    ds_read_b128 a[0:3], v50 offset:8960
    buffer_load_dwordx4 v4, s[4:7], s52 offen offset:2048 lds
    v_cvt_pk_bf16_f32 v160, v160, v161
    v_cvt_pk_bf16_f32 v161, v162, v163
    v_cvt_pk_bf16_f32 v162, v164, v165
    v_cvt_pk_bf16_f32 v163, v166, v167
    v_pk_add_f32 v[168:169], v[168:169], v[58:59]
    v_pk_add_f32 v[170:171], v[170:171], v[58:59]
    v_pk_add_f32 v[172:173], v[172:173], v[58:59]
    v_pk_add_f32 v[174:175], v[174:175], v[58:59]
    v_exp_f32 v168, v168
    v_exp_f32 v169, v169
    v_exp_f32 v170, v170
    v_exp_f32 v171, v171
    v_exp_f32 v172, v172
    v_exp_f32 v173, v173
    v_exp_f32 v174, v174
    v_exp_f32 v175, v175
    s_waitcnt lgkmcnt(3)
    v_mfma_f32_32x32x16_bf16 v[224:239], a[4:7], v[148:151], v[224:239]
    ds_read_b128 a[4:7], v50 offset:9600
    s_mul_i32 s52, s44, 4
    s_add_u32 s52, s52, 0
    s_mov_b32 m0, s52
    s_nop 0
    buffer_load_dwordx4 v4, s[28:31], s52 offen offset:0 lds
    v_cvt_pk_bf16_f32 v164, v168, v169
    v_cvt_pk_bf16_f32 v165, v170, v171
    v_cvt_pk_bf16_f32 v166, v172, v173
    v_cvt_pk_bf16_f32 v167, v174, v175
    v_pk_add_f32 v[176:177], v[176:177], v[58:59]
    v_pk_add_f32 v[178:179], v[178:179], v[58:59]
    v_pk_add_f32 v[180:181], v[180:181], v[58:59]
    v_pk_add_f32 v[182:183], v[182:183], v[58:59]
    v_exp_f32 v176, v176
    v_exp_f32 v177, v177
    v_exp_f32 v178, v178
    v_exp_f32 v179, v179
    v_exp_f32 v180, v180
    v_exp_f32 v181, v181
    v_exp_f32 v182, v182
    v_exp_f32 v183, v183
    s_waitcnt lgkmcnt(3)
    v_mfma_f32_32x32x16_bf16 v[224:239], a[8:11], v[160:163], v[224:239]
    ds_read_b128 a[8:11], v50 offset:10240
    buffer_load_dwordx4 v4, s[28:31], s52 offen offset:1024 lds
    v_cvt_pk_bf16_f32 v176, v176, v177
    v_cvt_pk_bf16_f32 v177, v178, v179
    v_cvt_pk_bf16_f32 v178, v180, v181
    v_cvt_pk_bf16_f32 v179, v182, v183
    v_pk_add_f32 v[184:185], v[184:185], v[58:59]
    v_pk_add_f32 v[186:187], v[186:187], v[58:59]
    v_pk_add_f32 v[188:189], v[188:189], v[58:59]
    v_pk_add_f32 v[190:191], v[190:191], v[58:59]
    v_exp_f32 v184, v184
    v_exp_f32 v185, v185
    v_exp_f32 v186, v186
    v_exp_f32 v187, v187
    v_exp_f32 v188, v188
    v_exp_f32 v189, v189
    v_exp_f32 v190, v190
    v_exp_f32 v191, v191
    s_waitcnt lgkmcnt(3)
    v_mfma_f32_32x32x16_bf16 v[224:239], a[12:15], v[164:167], v[224:239]
    ds_read_b128 a[12:15], v50 offset:10880
    buffer_load_dwordx4 v4, s[28:31], s52 offen offset:2048 lds
    v_cvt_pk_bf16_f32 v180, v184, v185
    v_cvt_pk_bf16_f32 v181, v186, v187
    v_cvt_pk_bf16_f32 v182, v188, v189
    v_cvt_pk_bf16_f32 v183, v190, v191
    v_pk_add_f32 v[192:193], v[192:193], v[58:59]
    v_pk_add_f32 v[194:195], v[194:195], v[58:59]
    v_pk_add_f32 v[196:197], v[196:197], v[58:59]
    v_pk_add_f32 v[198:199], v[198:199], v[58:59]
    v_exp_f32 v192, v192
    v_exp_f32 v193, v193
    v_exp_f32 v194, v194
    v_exp_f32 v195, v195
    v_exp_f32 v196, v196
    v_exp_f32 v197, v197
    v_exp_f32 v198, v198
    v_exp_f32 v199, v199
    s_waitcnt lgkmcnt(3)
    v_mfma_f32_32x32x16_bf16 v[224:239], a[0:3], v[176:179], v[224:239]
    ds_read_b128 a[0:3], v50 offset:0
    buffer_load_dwordx4 v4, s[28:31], s52 offen offset:3072 lds
    v_cvt_pk_bf16_f32 v192, v192, v193
    v_cvt_pk_bf16_f32 v193, v194, v195
    v_cvt_pk_bf16_f32 v194, v196, v197
    v_cvt_pk_bf16_f32 v195, v198, v199
    v_pk_add_f32 v[200:201], v[200:201], v[58:59]
    v_pk_add_f32 v[202:203], v[202:203], v[58:59]
    v_pk_add_f32 v[204:205], v[204:205], v[58:59]
    v_pk_add_f32 v[206:207], v[206:207], v[58:59]
    v_exp_f32 v200, v200
    v_exp_f32 v201, v201
    v_exp_f32 v202, v202
    v_exp_f32 v203, v203
    v_exp_f32 v204, v204
    v_exp_f32 v205, v205
    v_exp_f32 v206, v206
    v_exp_f32 v207, v207
    s_waitcnt lgkmcnt(3)
    v_mfma_f32_32x32x16_bf16 v[224:239], a[4:7], v[180:183], v[224:239]
    ds_read_b128 a[4:7], v50 offset:640
    s_add_u32 s52, s44, 16384
    s_mov_b32 m0, s52
    s_nop 0
    buffer_load_dwordx4 v4, s[28:31], s52 offen offset:0 lds
    v_cvt_pk_bf16_f32 v196, v200, v201
    v_cvt_pk_bf16_f32 v197, v202, v203
    v_cvt_pk_bf16_f32 v198, v204, v205
    v_cvt_pk_bf16_f32 v199, v206, v207
    v_bfi_b32 v64, v40, 0, v192
    v_bfi_b32 v65, v41, 0, v193
    v_bfi_b32 v66, v42, 0, v194
    v_bfi_b32 v67, v43, 0, v195
    v_bfi_b32 v68, v44, 0, v196
    v_bfi_b32 v69, v45, 0, v197
    v_bfi_b32 v70, v46, 0, v198
    v_bfi_b32 v71, v47, 0, v199
    v_and_b32 v192, v40, v192
    v_and_b32 v193, v41, v193
    v_and_b32 v194, v42, v194
    v_and_b32 v195, v43, v195
    v_and_b32 v196, v44, v196
    v_and_b32 v197, v45, v197
    v_and_b32 v198, v46, v198
    v_and_b32 v199, v47, v199
    s_waitcnt lgkmcnt(3)
    v_mfma_f32_32x32x16_bf16 v[224:239], a[8:11], v[192:195], v[224:239]
    s_waitcnt lgkmcnt(2)
    v_mfma_f32_32x32x16_bf16 v[224:239], a[12:15], v[196:199], v[224:239]
    s_waitcnt lgkmcnt(1)
    v_mfma_f32_32x32x16_bf16 v[224:239], a[0:3], v[64:67], v[224:239]
    s_waitcnt lgkmcnt(0)
    v_mfma_f32_32x32x16_bf16 v[224:239], a[4:7], v[68:71], v[224:239]
    s_nop 11
    v_rcp_f32 v58, v236
    v_rcp_f32 v59, v236
    s_nop 0
    v_pk_mul_f32 v[224:225], v[224:225], v[58:59]
    v_pk_mul_f32 v[226:227], v[226:227], v[58:59]
    v_pk_mul_f32 v[228:229], v[228:229], v[58:59]
    v_pk_mul_f32 v[230:231], v[230:231], v[58:59]
    v_pk_mul_f32 v[232:233], v[232:233], v[58:59]
    v_cvt_pk_bf16_f32 v248, v224, v225
    v_cvt_pk_bf16_f32 v249, v226, v227
    v_cvt_pk_bf16_f32 v250, v228, v229
    v_cvt_pk_bf16_f32 v251, v230, v231
    v_cvt_pk_bf16_f32 v252, v232, v233
    s_cmp_gt_i32 s54, 0
    s_cselect_b32 s61, 0xf149f2ca, 0
    v_mov_b32 v208, s61
    v_mov_b32 v209, s61
    v_mov_b32 v210, s61
    v_mov_b32 v211, s61
    v_mov_b32 v212, s61
    v_mov_b32 v213, s61
    v_mov_b32 v214, s61
    v_mov_b32 v215, s61
    v_mov_b32 v216, s61
    v_mov_b32 v217, s61
    v_mov_b32 v218, s61
    v_mov_b32 v219, s61
    v_mov_b32 v220, s61
    v_mov_b32 v221, s61
    v_mov_b32 v222, s61
    v_mov_b32 v223, s61
    s_waitcnt vmcnt(16)
    s_barrier
    s_mul_i32 s52, s44, 4
    s_add_u32 s52, s52, 20480
    s_mov_b32 m0, s52
    s_nop 0
    buffer_load_dwordx4 v4, s[28:31], s52 offen offset:0 lds
    buffer_load_dwordx4 v4, s[28:31], s52 offen offset:1024 lds
    ds_read_b128 v[16:19], v48 offset:29696
    ds_read_b32 v20, v49 offset:29696
    ds_read_b128 v[24:27], v48 offset:30720
    ds_read_b32 v28, v49 offset:29824
    ds_read_b128 v[32:35], v48 offset:31744
    ds_read_b32 v36, v49 offset:29952
    s_waitcnt lgkmcnt(4)
    v_mfma_f32_32x32x16_bf16 v[64:79], v[16:19], v[240:243], v[208:223]
    v_mfma_f32_32x32x16_bf16 v[64:79], v[20:23], v[244:247], v[64:79]
    ds_read_b128 v[16:19], v48 offset:32768
    ds_read_b32 v20, v49 offset:30080
    s_cmp_eq_u32 s54, 1
    s_cbranch_scc1 mega_kernel_cz42
mega_kernel_cz42_back:
    s_waitcnt lgkmcnt(4)
    v_mfma_f32_32x32x16_bf16 v[80:95], v[24:27], v[240:243], v[208:223]
    v_mfma_f32_32x32x16_bf16 v[80:95], v[28:31], v[244:247], v[80:95]
    ds_read_b128 v[24:27], v48 offset:33792
    ds_read_b32 v28, v49 offset:30208
    s_cmp_eq_u32 s54, 2
    s_cbranch_scc1 mega_kernel_cz43
mega_kernel_cz43_back:
    s_waitcnt lgkmcnt(4)
    v_mfma_f32_32x32x16_bf16 v[96:111], v[32:35], v[240:243], v[208:223]
    v_mfma_f32_32x32x16_bf16 v[96:111], v[36:39], v[244:247], v[96:111]
    s_nop 4
    v_max3_f32 v57, v80, v81, v82
    v_max_f32 v57, v57, v83
    v_max3_f32 v57, v57, v84, v85
    v_max3_f32 v57, v57, v86, v87
    v_max3_f32 v57, v57, v88, v89
    v_max3_f32 v57, v57, v90, v91
    v_max3_f32 v57, v57, v92, v93
    v_max3_f32 v57, v57, v94, v95
    ds_read_b128 v[32:35], v48 offset:34816
    ds_read_b32 v36, v49 offset:30336
    s_cmp_eq_u32 s54, 3
    s_cbranch_scc1 mega_kernel_cz44
mega_kernel_cz44_back:
    s_waitcnt lgkmcnt(4)
    v_mfma_f32_32x32x16_bf16 v[112:127], v[16:19], v[240:243], v[208:223]
    v_mfma_f32_32x32x16_bf16 v[112:127], v[20:23], v[244:247], v[112:127]
    v_max3_f32 v57, v57, v96, v97
    v_max3_f32 v57, v57, v98, v99
    v_max3_f32 v57, v57, v100, v101
    v_max3_f32 v57, v57, v102, v103
    v_max3_f32 v57, v57, v104, v105
    v_max3_f32 v57, v57, v106, v107
    v_max3_f32 v57, v57, v108, v109
    v_max3_f32 v57, v57, v110, v111
    ds_read_b128 v[16:19], v48 offset:35840
    ds_read_b32 v20, v49 offset:30464
    s_cmp_eq_u32 s54, 4
    s_cbranch_scc1 mega_kernel_cz45
mega_kernel_cz45_back:
    s_waitcnt lgkmcnt(4)
    v_mfma_f32_32x32x16_bf16 v[128:143], v[24:27], v[240:243], v[208:223]
    v_mfma_f32_32x32x16_bf16 v[128:143], v[28:31], v[244:247], v[128:143]
    v_max3_f32 v57, v57, v112, v113
    v_max3_f32 v57, v57, v114, v115
    v_max3_f32 v57, v57, v116, v117
    v_max3_f32 v57, v57, v118, v119
    v_max3_f32 v57, v57, v120, v121
    v_max3_f32 v57, v57, v122, v123
    v_max3_f32 v57, v57, v124, v125
    v_max3_f32 v57, v57, v126, v127
    ds_read_b128 v[24:27], v48 offset:36864
    ds_read_b32 v28, v49 offset:30592
    s_cmp_eq_u32 s54, 5
    s_cbranch_scc1 mega_kernel_cz46
mega_kernel_cz46_back:
    s_waitcnt lgkmcnt(4)
    v_mfma_f32_32x32x16_bf16 v[144:159], v[32:35], v[240:243], v[208:223]
    v_mfma_f32_32x32x16_bf16 v[144:159], v[36:39], v[244:247], v[144:159]
    v_max3_f32 v57, v57, v128, v129
    v_max3_f32 v57, v57, v130, v131
    v_max3_f32 v57, v57, v132, v133
    v_max3_f32 v57, v57, v134, v135
    v_max3_f32 v57, v57, v136, v137
    v_max3_f32 v57, v57, v138, v139
    v_max3_f32 v57, v57, v140, v141
    v_max3_f32 v57, v57, v142, v143
    ds_read_b128 v[32:35], v48 offset:37888
    ds_read_b32 v36, v49 offset:30720
    s_cmp_eq_u32 s54, 6
    s_cbranch_scc1 mega_kernel_cz47
mega_kernel_cz47_back:
    s_waitcnt lgkmcnt(4)
    v_mfma_f32_32x32x16_bf16 v[160:175], v[16:19], v[240:243], v[208:223]
    v_mfma_f32_32x32x16_bf16 v[160:175], v[20:23], v[244:247], v[160:175]
    v_max3_f32 v57, v57, v144, v145
    v_max3_f32 v57, v57, v146, v147
    v_max3_f32 v57, v57, v148, v149
    v_max3_f32 v57, v57, v150, v151
    v_max3_f32 v57, v57, v152, v153
    v_max3_f32 v57, v57, v154, v155
    v_max3_f32 v57, v57, v156, v157
    v_max3_f32 v57, v57, v158, v159
    s_cmp_eq_u32 s54, 7
    s_cbranch_scc1 mega_kernel_cz48
mega_kernel_cz48_back:
    s_waitcnt lgkmcnt(2)
    v_mfma_f32_32x32x16_bf16 v[176:191], v[24:27], v[240:243], v[208:223]
    v_mfma_f32_32x32x16_bf16 v[176:191], v[28:31], v[244:247], v[176:191]
    v_max3_f32 v57, v57, v160, v161
    v_max3_f32 v57, v57, v162, v163
    v_max3_f32 v57, v57, v164, v165
    v_max3_f32 v57, v57, v166, v167
    v_max3_f32 v57, v57, v168, v169
    v_max3_f32 v57, v57, v170, v171
    v_max3_f32 v57, v57, v172, v173
    v_max3_f32 v57, v57, v174, v175
    s_cmp_eq_u32 s54, 8
    s_cbranch_scc1 mega_kernel_cz49
mega_kernel_cz49_back:
    s_waitcnt lgkmcnt(0)
    v_mfma_f32_32x32x16_bf16 v[192:207], v[32:35], v[240:243], v[208:223]
    v_mfma_f32_32x32x16_bf16 v[192:207], v[36:39], v[244:247], v[192:207]
    v_max3_f32 v57, v57, v176, v177
    v_max3_f32 v57, v57, v178, v179
    v_max3_f32 v57, v57, v180, v181
    v_max3_f32 v57, v57, v182, v183
    v_max3_f32 v57, v57, v184, v185
    v_max3_f32 v57, v57, v186, v187
    v_max3_f32 v57, v57, v188, v189
    v_max3_f32 v57, v57, v190, v191
    ds_read_b128 a[0:3], v50 offset:30976
    ds_read_b128 a[4:7], v50 offset:31616
    ds_read_b128 a[8:11], v50 offset:32256
    ds_read_b128 a[12:15], v50 offset:32896
    v_cndmask_b32 v192, v64, v192, s[64:65]
    v_cndmask_b32 v193, v65, v193, s[66:67]
    v_cndmask_b32 v194, v66, v194, s[68:69]
    v_cndmask_b32 v195, v67, v195, s[70:71]
    v_cndmask_b32 v196, v68, v196, s[72:73]
    v_cndmask_b32 v197, v69, v197, s[74:75]
    v_cndmask_b32 v198, v70, v198, s[76:77]
    v_cndmask_b32 v199, v71, v199, s[78:79]
    v_cndmask_b32 v200, v72, v200, s[80:81]
    v_cndmask_b32 v201, v73, v201, s[82:83]
    v_cndmask_b32 v202, v74, v202, s[84:85]
    v_cndmask_b32 v203, v75, v203, s[86:87]
    v_cndmask_b32 v204, v76, v204, s[88:89]
    v_cndmask_b32 v205, v77, v205, s[90:91]
    v_cndmask_b32 v206, v78, v206, s[92:93]
    v_cndmask_b32 v207, v79, v207, s[94:95]
    v_max3_f32 v57, v57, v192, v193
    v_max3_f32 v57, v57, v194, v195
    v_max3_f32 v57, v57, v196, v197
    v_max3_f32 v57, v57, v198, v199
    v_max3_f32 v57, v57, v200, v201
    v_max3_f32 v57, v57, v202, v203
    v_max3_f32 v57, v57, v204, v205
    v_max3_f32 v57, v57, v206, v207
    v_mov_b32 v58, v57
    s_nop 1
    v_permlane32_swap_b32 v57, v58
    v_max_f32 v57, v57, v58
    v_sub_f32 v58, 0, v57
    v_sub_f32 v59, 0, v57
    v_pk_add_f32 v[80:81], v[80:81], v[58:59]
    v_pk_add_f32 v[82:83], v[82:83], v[58:59]
    v_pk_add_f32 v[84:85], v[84:85], v[58:59]
    v_pk_add_f32 v[86:87], v[86:87], v[58:59]
    v_exp_f32 v80, v80
    v_exp_f32 v81, v81
    v_exp_f32 v82, v82
    v_exp_f32 v83, v83
    v_exp_f32 v84, v84
    v_exp_f32 v85, v85
    v_exp_f32 v86, v86
    v_exp_f32 v87, v87
    buffer_load_dwordx4 v4, s[28:31], s52 offen offset:2048 lds
    v_cvt_pk_bf16_f32 v80, v80, v81
    v_cvt_pk_bf16_f32 v81, v82, v83
    v_cvt_pk_bf16_f32 v82, v84, v85
    v_cvt_pk_bf16_f32 v83, v86, v87
    v_pk_add_f32 v[88:89], v[88:89], v[58:59]
    v_pk_add_f32 v[90:91], v[90:91], v[58:59]
    v_pk_add_f32 v[92:93], v[92:93], v[58:59]
    v_pk_add_f32 v[94:95], v[94:95], v[58:59]
    v_exp_f32 v88, v88
    v_exp_f32 v89, v89
    v_exp_f32 v90, v90
    v_exp_f32 v91, v91
    v_exp_f32 v92, v92
    v_exp_f32 v93, v93
    v_exp_f32 v94, v94
    v_exp_f32 v95, v95
    buffer_load_dwordx4 v4, s[28:31], s52 offen offset:3072 lds
    v_cvt_pk_bf16_f32 v84, v88, v89
    v_cvt_pk_bf16_f32 v85, v90, v91
    v_cvt_pk_bf16_f32 v86, v92, v93
    v_cvt_pk_bf16_f32 v87, v94, v95
    v_pk_add_f32 v[96:97], v[96:97], v[58:59]
    v_pk_add_f32 v[98:99], v[98:99], v[58:59]
    v_pk_add_f32 v[100:101], v[100:101], v[58:59]
    v_pk_add_f32 v[102:103], v[102:103], v[58:59]
    v_exp_f32 v96, v96
    v_exp_f32 v97, v97
    v_exp_f32 v98, v98
    v_exp_f32 v99, v99
    v_exp_f32 v100, v100
    v_exp_f32 v101, v101
    v_exp_f32 v102, v102
    v_exp_f32 v103, v103
    s_waitcnt lgkmcnt(3)
    v_mfma_f32_32x32x16_bf16 v[224:239], a[0:3], v[80:83], 0
    ds_read_b128 a[0:3], v50 offset:33536
    s_mul_i32 s52, s44, 4
    s_add_u32 s52, s52, 36864
    s_mov_b32 m0, s52
    s_nop 0
    buffer_load_dwordx4 v4, s[28:31], s52 offen offset:0 lds
    v_cvt_pk_bf16_f32 v96, v96, v97
    v_cvt_pk_bf16_f32 v97, v98, v99
    v_cvt_pk_bf16_f32 v98, v100, v101
    v_cvt_pk_bf16_f32 v99, v102, v103
    v_pk_add_f32 v[104:105], v[104:105], v[58:59]
    v_pk_add_f32 v[106:107], v[106:107], v[58:59]
    v_pk_add_f32 v[108:109], v[108:109], v[58:59]
    v_pk_add_f32 v[110:111], v[110:111], v[58:59]
    v_exp_f32 v104, v104
    v_exp_f32 v105, v105
    v_exp_f32 v106, v106
    v_exp_f32 v107, v107
    v_exp_f32 v108, v108
    v_exp_f32 v109, v109
    v_exp_f32 v110, v110
    v_exp_f32 v111, v111
    s_waitcnt lgkmcnt(3)
    v_mfma_f32_32x32x16_bf16 v[224:239], a[4:7], v[84:87], v[224:239]
    ds_read_b128 a[4:7], v50 offset:34176
    buffer_load_dwordx4 v4, s[28:31], s52 offen offset:1024 lds
    v_cvt_pk_bf16_f32 v100, v104, v105
    v_cvt_pk_bf16_f32 v101, v106, v107
    v_cvt_pk_bf16_f32 v102, v108, v109
    v_cvt_pk_bf16_f32 v103, v110, v111
    v_pk_add_f32 v[112:113], v[112:113], v[58:59]
    v_pk_add_f32 v[114:115], v[114:115], v[58:59]
    v_pk_add_f32 v[116:117], v[116:117], v[58:59]
    v_pk_add_f32 v[118:119], v[118:119], v[58:59]
    v_exp_f32 v112, v112
    v_exp_f32 v113, v113
    v_exp_f32 v114, v114
    v_exp_f32 v115, v115
    v_exp_f32 v116, v116
    v_exp_f32 v117, v117
    v_exp_f32 v118, v118
    v_exp_f32 v119, v119
    s_waitcnt lgkmcnt(3)
    v_mfma_f32_32x32x16_bf16 v[224:239], a[8:11], v[96:99], v[224:239]
    ds_read_b128 a[8:11], v50 offset:34816
    buffer_load_dwordx4 v4, s[28:31], s52 offen offset:2048 lds
    v_cvt_pk_bf16_f32 v112, v112, v113
    v_cvt_pk_bf16_f32 v113, v114, v115
    v_cvt_pk_bf16_f32 v114, v116, v117
    v_cvt_pk_bf16_f32 v115, v118, v119
    v_pk_add_f32 v[120:121], v[120:121], v[58:59]
    v_pk_add_f32 v[122:123], v[122:123], v[58:59]
    v_pk_add_f32 v[124:125], v[124:125], v[58:59]
    v_pk_add_f32 v[126:127], v[126:127], v[58:59]
    v_exp_f32 v120, v120
    v_exp_f32 v121, v121
    v_exp_f32 v122, v122
    v_exp_f32 v123, v123
    v_exp_f32 v124, v124
    v_exp_f32 v125, v125
    v_exp_f32 v126, v126
    v_exp_f32 v127, v127
    s_waitcnt lgkmcnt(3)
    v_mfma_f32_32x32x16_bf16 v[224:239], a[12:15], v[100:103], v[224:239]
    ds_read_b128 a[12:15], v50 offset:35456
    buffer_load_dwordx4 v4, s[28:31], s52 offen offset:3072 lds
    v_cvt_pk_bf16_f32 v116, v120, v121
    v_cvt_pk_bf16_f32 v117, v122, v123
    v_cvt_pk_bf16_f32 v118, v124, v125
    v_cvt_pk_bf16_f32 v119, v126, v127
    v_pk_add_f32 v[128:129], v[128:129], v[58:59]
    v_pk_add_f32 v[130:131], v[130:131], v[58:59]
    v_pk_add_f32 v[132:133], v[132:133], v[58:59]
    v_pk_add_f32 v[134:135], v[134:135], v[58:59]
    v_exp_f32 v128, v128
    v_exp_f32 v129, v129
    v_exp_f32 v130, v130
    v_exp_f32 v131, v131
    v_exp_f32 v132, v132
    v_exp_f32 v133, v133
    v_exp_f32 v134, v134
    v_exp_f32 v135, v135
    s_waitcnt lgkmcnt(3)
    v_mfma_f32_32x32x16_bf16 v[224:239], a[0:3], v[112:115], v[224:239]
    ds_read_b128 a[0:3], v50 offset:36096
    s_mul_i32 s52, s44, 4
    s_add_u32 s52, s52, 53248
    s_mov_b32 m0, s52
    s_nop 0
    buffer_load_dwordx4 v4, s[28:31], s52 offen offset:0 lds
    v_cvt_pk_bf16_f32 v128, v128, v129
    v_cvt_pk_bf16_f32 v129, v130, v131
    v_cvt_pk_bf16_f32 v130, v132, v133
    v_cvt_pk_bf16_f32 v131, v134, v135
    v_pk_add_f32 v[136:137], v[136:137], v[58:59]
    v_pk_add_f32 v[138:139], v[138:139], v[58:59]
    v_pk_add_f32 v[140:141], v[140:141], v[58:59]
    v_pk_add_f32 v[142:143], v[142:143], v[58:59]
    v_exp_f32 v136, v136
    v_exp_f32 v137, v137
    v_exp_f32 v138, v138
    v_exp_f32 v139, v139
    v_exp_f32 v140, v140
    v_exp_f32 v141, v141
    v_exp_f32 v142, v142
    v_exp_f32 v143, v143
    s_waitcnt lgkmcnt(3)
    v_mfma_f32_32x32x16_bf16 v[224:239], a[4:7], v[116:119], v[224:239]
    ds_read_b128 a[4:7], v50 offset:36736
    buffer_load_dwordx4 v4, s[28:31], s52 offen offset:1024 lds
    v_cvt_pk_bf16_f32 v132, v136, v137
    v_cvt_pk_bf16_f32 v133, v138, v139
    v_cvt_pk_bf16_f32 v134, v140, v141
    v_cvt_pk_bf16_f32 v135, v142, v143
    v_pk_add_f32 v[144:145], v[144:145], v[58:59]
    v_pk_add_f32 v[146:147], v[146:147], v[58:59]
    v_pk_add_f32 v[148:149], v[148:149], v[58:59]
    v_pk_add_f32 v[150:151], v[150:151], v[58:59]
    v_exp_f32 v144, v144
    v_exp_f32 v145, v145
    v_exp_f32 v146, v146
    v_exp_f32 v147, v147
    v_exp_f32 v148, v148
    v_exp_f32 v149, v149
    v_exp_f32 v150, v150
    v_exp_f32 v151, v151
    s_waitcnt lgkmcnt(3)
    v_mfma_f32_32x32x16_bf16 v[224:239], a[8:11], v[128:131], v[224:239]
    ds_read_b128 a[8:11], v50 offset:37376
    buffer_load_dwordx4 v4, s[28:31], s52 offen offset:2048 lds
    v_cvt_pk_bf16_f32 v144, v144, v145
    v_cvt_pk_bf16_f32 v145, v146, v147
    v_cvt_pk_bf16_f32 v146, v148, v149
    v_cvt_pk_bf16_f32 v147, v150, v151
    v_pk_add_f32 v[152:153], v[152:153], v[58:59]
    v_pk_add_f32 v[154:155], v[154:155], v[58:59]
    v_pk_add_f32 v[156:157], v[156:157], v[58:59]
    v_pk_add_f32 v[158:159], v[158:159], v[58:59]
    v_exp_f32 v152, v152
    v_exp_f32 v153, v153
    v_exp_f32 v154, v154
    v_exp_f32 v155, v155
    v_exp_f32 v156, v156
    v_exp_f32 v157, v157
    v_exp_f32 v158, v158
    v_exp_f32 v159, v159
    s_waitcnt lgkmcnt(3)
    v_mfma_f32_32x32x16_bf16 v[224:239], a[12:15], v[132:135], v[224:239]
    ds_read_b128 a[12:15], v50 offset:38016
    buffer_load_dwordx4 v4, s[28:31], s52 offen offset:3072 lds
    v_cvt_pk_bf16_f32 v148, v152, v153
    v_cvt_pk_bf16_f32 v149, v154, v155
    v_cvt_pk_bf16_f32 v150, v156, v157
    v_cvt_pk_bf16_f32 v151, v158, v159
    v_pk_add_f32 v[160:161], v[160:161], v[58:59]
    v_pk_add_f32 v[162:163], v[162:163], v[58:59]
    v_pk_add_f32 v[164:165], v[164:165], v[58:59]
    v_pk_add_f32 v[166:167], v[166:167], v[58:59]
    v_exp_f32 v160, v160
    v_exp_f32 v161, v161
    v_exp_f32 v162, v162
    v_exp_f32 v163, v163
    v_exp_f32 v164, v164
    v_exp_f32 v165, v165
    v_exp_f32 v166, v166
    v_exp_f32 v167, v167
    s_waitcnt lgkmcnt(3)
    v_mfma_f32_32x32x16_bf16 v[224:239], a[0:3], v[144:147], v[224:239]
    ds_read_b128 a[0:3], v50 offset:38656
    s_mul_i32 s52, s44, 2
    s_add_u32 s52, s52, 69632
    s_min_u32 s52, s52, 73728
    s_mov_b32 m0, s52
    s_nop 0
    buffer_load_dwordx4 v4, s[28:31], s52 offen offset:0 lds
    v_cvt_pk_bf16_f32 v160, v160, v161
    v_cvt_pk_bf16_f32 v161, v162, v163
    v_cvt_pk_bf16_f32 v162, v164, v165
    v_cvt_pk_bf16_f32 v163, v166, v167
    v_pk_add_f32 v[168:169], v[168:169], v[58:59]
    v_pk_add_f32 v[170:171], v[170:171], v[58:59]
    v_pk_add_f32 v[172:173], v[172:173], v[58:59]
    v_pk_add_f32 v[174:175], v[174:175], v[58:59]
    v_exp_f32 v168, v168
    v_exp_f32 v169, v169
    v_exp_f32 v170, v170
    v_exp_f32 v171, v171
    v_exp_f32 v172, v172
    v_exp_f32 v173, v173
    v_exp_f32 v174, v174
    v_exp_f32 v175, v175
    s_waitcnt lgkmcnt(3)
    v_mfma_f32_32x32x16_bf16 v[224:239], a[4:7], v[148:151], v[224:239]
    ds_read_b128 a[4:7], v50 offset:39296
    buffer_load_dwordx4 v4, s[28:31], s52 offen offset:1024 lds
    v_cvt_pk_bf16_f32 v164, v168, v169
    v_cvt_pk_bf16_f32 v165, v170, v171
    v_cvt_pk_bf16_f32 v166, v172, v173
    v_cvt_pk_bf16_f32 v167, v174, v175
    v_pk_add_f32 v[176:177], v[176:177], v[58:59]
    v_pk_add_f32 v[178:179], v[178:179], v[58:59]
    v_pk_add_f32 v[180:181], v[180:181], v[58:59]
    v_pk_add_f32 v[182:183], v[182:183], v[58:59]
    v_exp_f32 v176, v176
    v_exp_f32 v177, v177
    v_exp_f32 v178, v178
    v_exp_f32 v179, v179
    v_exp_f32 v180, v180
    v_exp_f32 v181, v181
    v_exp_f32 v182, v182
    v_exp_f32 v183, v183
    s_waitcnt lgkmcnt(3)
    v_mfma_f32_32x32x16_bf16 v[224:239], a[8:11], v[160:163], v[224:239]
    ds_read_b128 a[8:11], v50 offset:39936
    s_mul_i32 s52, s44, 4
    s_add_u32 s52, s52, 105472
    s_min_u32 s52, s52, 114688
    s_mov_b32 m0, s52
    s_nop 0
    buffer_load_dwordx4 v4, s[28:31], s52 offen offset:0 lds
    v_cvt_pk_bf16_f32 v176, v176, v177
    v_cvt_pk_bf16_f32 v177, v178, v179
    v_cvt_pk_bf16_f32 v178, v180, v181
    v_cvt_pk_bf16_f32 v179, v182, v183
    v_pk_add_f32 v[184:185], v[184:185], v[58:59]
    v_pk_add_f32 v[186:187], v[186:187], v[58:59]
    v_pk_add_f32 v[188:189], v[188:189], v[58:59]
    v_pk_add_f32 v[190:191], v[190:191], v[58:59]
    v_exp_f32 v184, v184
    v_exp_f32 v185, v185
    v_exp_f32 v186, v186
    v_exp_f32 v187, v187
    v_exp_f32 v188, v188
    v_exp_f32 v189, v189
    v_exp_f32 v190, v190
    v_exp_f32 v191, v191
    s_waitcnt lgkmcnt(3)
    v_mfma_f32_32x32x16_bf16 v[224:239], a[12:15], v[164:167], v[224:239]
    ds_read_b128 a[12:15], v50 offset:40576
    buffer_load_dwordx4 v4, s[28:31], s52 offen offset:1024 lds
    v_cvt_pk_bf16_f32 v180, v184, v185
    v_cvt_pk_bf16_f32 v181, v186, v187
    v_cvt_pk_bf16_f32 v182, v188, v189
    v_cvt_pk_bf16_f32 v183, v190, v191
    v_pk_add_f32 v[192:193], v[192:193], v[58:59]
    v_pk_add_f32 v[194:195], v[194:195], v[58:59]
    v_pk_add_f32 v[196:197], v[196:197], v[58:59]
    v_pk_add_f32 v[198:199], v[198:199], v[58:59]
    v_exp_f32 v192, v192
    v_exp_f32 v193, v193
    v_exp_f32 v194, v194
    v_exp_f32 v195, v195
    v_exp_f32 v196, v196
    v_exp_f32 v197, v197
    v_exp_f32 v198, v198
    v_exp_f32 v199, v199
    s_waitcnt lgkmcnt(3)
    v_mfma_f32_32x32x16_bf16 v[224:239], a[0:3], v[176:179], v[224:239]
    ds_read_b128 a[0:3], v50 offset:29696
    buffer_load_dwordx4 v4, s[28:31], s52 offen offset:2048 lds
    v_cvt_pk_bf16_f32 v192, v192, v193
    v_cvt_pk_bf16_f32 v193, v194, v195
    v_cvt_pk_bf16_f32 v194, v196, v197
    v_cvt_pk_bf16_f32 v195, v198, v199
    v_pk_add_f32 v[200:201], v[200:201], v[58:59]
    v_pk_add_f32 v[202:203], v[202:203], v[58:59]
    v_pk_add_f32 v[204:205], v[204:205], v[58:59]
    v_pk_add_f32 v[206:207], v[206:207], v[58:59]
    v_exp_f32 v200, v200
    v_exp_f32 v201, v201
    v_exp_f32 v202, v202
    v_exp_f32 v203, v203
    v_exp_f32 v204, v204
    v_exp_f32 v205, v205
    v_exp_f32 v206, v206
    v_exp_f32 v207, v207
    s_waitcnt lgkmcnt(3)
    v_mfma_f32_32x32x16_bf16 v[224:239], a[4:7], v[180:183], v[224:239]
    ds_read_b128 a[4:7], v50 offset:30336
    buffer_load_dwordx4 v4, s[28:31], s52 offen offset:3072 lds
    v_cvt_pk_bf16_f32 v196, v200, v201
    v_cvt_pk_bf16_f32 v197, v202, v203
    v_cvt_pk_bf16_f32 v198, v204, v205
    v_cvt_pk_bf16_f32 v199, v206, v207
    v_bfi_b32 v64, v40, 0, v192
    v_bfi_b32 v65, v41, 0, v193
    v_bfi_b32 v66, v42, 0, v194
    v_bfi_b32 v67, v43, 0, v195
    v_bfi_b32 v68, v44, 0, v196
    v_bfi_b32 v69, v45, 0, v197
    v_bfi_b32 v70, v46, 0, v198
    v_bfi_b32 v71, v47, 0, v199
    v_and_b32 v192, v40, v192
    v_and_b32 v193, v41, v193
    v_and_b32 v194, v42, v194
    v_and_b32 v195, v43, v195
    v_and_b32 v196, v44, v196
    v_and_b32 v197, v45, v197
    v_and_b32 v198, v46, v198
    v_and_b32 v199, v47, v199
    s_waitcnt lgkmcnt(3)
    v_mfma_f32_32x32x16_bf16 v[224:239], a[8:11], v[192:195], v[224:239]
    s_waitcnt lgkmcnt(2)
    v_mfma_f32_32x32x16_bf16 v[224:239], a[12:15], v[196:199], v[224:239]
    s_waitcnt lgkmcnt(1)
    v_mfma_f32_32x32x16_bf16 v[224:239], a[0:3], v[64:67], v[224:239]
    s_waitcnt lgkmcnt(0)
    v_mfma_f32_32x32x16_bf16 v[224:239], a[4:7], v[68:71], v[224:239]
    s_nop 11
    v_rcp_f32 v58, v236
    v_rcp_f32 v59, v236
    s_nop 0
    v_pk_mul_f32 v[224:225], v[224:225], v[58:59]
    v_pk_mul_f32 v[226:227], v[226:227], v[58:59]
    v_pk_mul_f32 v[228:229], v[228:229], v[58:59]
    v_pk_mul_f32 v[230:231], v[230:231], v[58:59]
    v_pk_mul_f32 v[232:233], v[232:233], v[58:59]
    v_cvt_pk_bf16_f32 v16, v224, v225
    v_cvt_pk_bf16_f32 v17, v226, v227
    v_cvt_pk_bf16_f32 v18, v228, v229
    v_cvt_pk_bf16_f32 v19, v230, v231
    v_cvt_pk_bf16_f32 v20, v232, v233
    s_cmp_eq_u32 s56, 0
    s_cbranch_scc1 mega_kernel_stg50
    buffer_store_dwordx4 v[248:251], v56, s[8:11], 0 offen
    buffer_store_dword v252, v55, s[8:11], 0 offen
    buffer_store_dwordx4 v[16:19], v56, s[8:11], 0 offen offset:512
    buffer_store_dword v20, v55, s[8:11], 0 offen offset:4
    s_branch mega_kernel_std51
mega_kernel_stg50:
    buffer_store_dwordx4 v[248:251], v56, s[8:11], 0 offen sc1
    buffer_store_dword v252, v55, s[8:11], 0 offen sc1
    buffer_store_dwordx4 v[16:19], v56, s[8:11], 0 offen offset:512 sc1
    buffer_store_dword v20, v55, s[8:11], 0 offen offset:4 sc1
mega_kernel_std51:
    s_mov_b32 s0, s47
    s_mul_i32 s46, s43, 18432
    s_add_u32 s46, s46, s45
    s_add_u32 s24, s22, 9146368
    s_addc_u32 s25, s23, 0
    s_add_u32 s24, s24, s46
    s_addc_u32 s25, s25, 0
    s_mov_b32 s26, 36864
    s_mov_b32 s27, 0x00020000
    s_add_u32 s32, s22, 6524928
    s_addc_u32 s33, s23, 0
    s_add_u32 s32, s32, s46
    s_addc_u32 s33, s33, 0
    s_mov_b32 s34, 36864
    s_mov_b32 s35, 0x00020000
    v_accvgpr_read_b32 v24, a224
    v_accvgpr_read_b32 v25, a226
    v_accvgpr_read_b32 v26, a228
    s_movk_i32 s88, 18432
    buffer_load_dwordx2 v[32:33], v24, s[32:35], 0 offen sc1
    buffer_load_dwordx2 v[34:35], v25, s[32:35], 0 offen sc1
    buffer_load_dwordx2 v[36:37], v26, s[32:35], 0 offen sc1
    buffer_load_dwordx2 v[40:41], v24, s[32:35], s88 offen sc1
    buffer_load_dwordx2 v[42:43], v25, s[32:35], s88 offen sc1
    buffer_load_dwordx2 v[44:45], v26, s[32:35], s88 offen sc1
    s_add_u32 s61, s46, 4980736
    s_add_u32 s36, s22, 6524928
    s_addc_u32 s37, s23, 0
    s_add_u32 s36, s36, s61
    s_addc_u32 s37, s37, 0
    s_mov_b32 s38, 36864
    s_mov_b32 s39, 0x00020000
    s_lshl_b32 s61, s43, 11
    s_add_u32 s61, s61, s45
    s_add_u32 s61, s61, 4980736
    s_add_u32 s64, s22, 8884224
    s_addc_u32 s65, s23, 0
    s_add_u32 s64, s64, s61
    s_addc_u32 s65, s65, 0
    s_mov_b32 s66, 4096
    s_mov_b32 s67, 0x00020000
    s_mul_i32 s61, s43, 18432
    s_add_u32 s68, s18, s61
    s_addc_u32 s69, s19, 0
    s_mov_b32 s70, 36864
    s_mov_b32 s71, 0x00020000
    s_mov_b32 s84, 20480
    s_mov_b32 s85, 24576
    s_mov_b32 s86, 28672
    s_mov_b32 s87, 32768
    s_add_u32 s92, s22, s45
    s_addc_u32 s93, s23, 0
    s_mov_b32 s94, 16486400
    s_mov_b32 s95, 0x00020000
    v_accvgpr_read_b32 v29, a201
    v_cmp_eq_u32 s[72:73], 0, v2
    v_and_b32 v30, 3, v3
    v_lshlrev_b32 v30, 4, v30
    v_lshl_add_u32 v30, v2, 6, v30
    v_add_u32 v31, 0x20000, v30
    v_add_u32 v30, 0x10000, v30
    v_accvgpr_read_b32 v27, a230
    v_accvgpr_read_b32 v28, a222
    s_lshl_b32 s76, s3, 13
    s_lshl_b32 s62, s41, 8
    s_add_u32 s76, s76, s62
    s_add_u32 s74, s76, 200704
    s_lshl_b32 s62, s42, 2
    s_add_u32 s76, s76, s62
    s_mov_b32 s14, 0xffff
    s_mov_b32 s15, 0
    s_waitcnt vmcnt(6) lgkmcnt(0)
    s_barrier
    s_cmp_lg_u32 s40, 0
    s_cbranch_scc1 mega_kernel_nosig52
    v_mov_b32 v5, s2
    s_mov_b64 exec, 1
    s_cmp_eq_u32 s56, 0
    s_cbranch_scc1 mega_kernel_stg53
    buffer_store_dword v5, off, s[48:51], s0
    s_branch mega_kernel_std54
mega_kernel_stg53:
    buffer_store_dword v5, off, s[48:51], s0 sc1
mega_kernel_std54:
    s_mov_b64 exec, -1
mega_kernel_nosig52:
    s_nop 3
mega_out:
    s_nop 3
    s_cmp_lg_u32 s40, 0
    s_cbranch_scc1 mega_kernel_nopoll55
    s_mov_b32 s62, 0
mega_kernel_poll56:
    buffer_load_dword v5, v28, s[48:51], s74 offen sc1
    s_add_u32 s62, s62, 1
    s_waitcnt vmcnt(0)
    v_cmp_ne_u32 vcc, s2, v5
    s_nop 0
    s_and_b64 vcc, vcc, s[14:15]
    s_cbranch_scc0 mega_kernel_nopoll55
    s_cmp_lt_u32 s62, 262144
    s_sleep 1
    s_cbranch_scc1 mega_kernel_poll56
mega_kernel_nopoll55:
    s_waitcnt vmcnt(0) lgkmcnt(0)
    s_barrier
    buffer_load_dwordx4 a[0:3], v4, s[24:27], 0 offen offset:0 sc1
    buffer_load_dwordx4 a[72:75], v4, s[24:27], s60 offen offset:2048 sc1
    buffer_load_dwordx4 a[4:7], v4, s[24:27], 0 offen offset:1024 sc1
    buffer_load_dwordx4 a[76:79], v4, s[24:27], s60 offen offset:3072 sc1
    buffer_load_dwordx4 a[8:11], v4, s[24:27], 0 offen offset:2048 sc1
    buffer_load_dwordx4 a[80:83], v4, s[24:27], s84 offen offset:0 sc1
    buffer_load_dwordx4 a[12:15], v4, s[24:27], 0 offen offset:3072 sc1
    buffer_load_dwordx4 a[84:87], v4, s[24:27], s84 offen offset:1024 sc1
    buffer_load_dwordx4 a[16:19], v4, s[24:27], s57 offen offset:0 sc1
    buffer_load_dwordx4 a[88:91], v4, s[24:27], s84 offen offset:2048 sc1
    buffer_load_dwordx4 a[20:23], v4, s[24:27], s57 offen offset:1024 sc1
    buffer_load_dwordx4 a[92:95], v4, s[24:27], s84 offen offset:3072 sc1
    buffer_load_dwordx4 a[24:27], v4, s[24:27], s57 offen offset:2048 sc1
    buffer_load_dwordx4 a[96:99], v4, s[24:27], s85 offen offset:0 sc1
    buffer_load_dwordx4 a[28:31], v4, s[24:27], s57 offen offset:3072 sc1
    buffer_load_dwordx4 a[100:103], v4, s[24:27], s85 offen offset:1024 sc1
    buffer_load_dwordx4 a[32:35], v4, s[24:27], s58 offen offset:0 sc1
    buffer_load_dwordx4 a[104:107], v4, s[24:27], s85 offen offset:2048 sc1
    ds_read_b128 a[144:147], v6 offset:0
    ds_read_b128 a[148:151], v6 offset:1024
    ds_read_b128 a[152:155], v31 offset:2048
    v_lshlrev_b32 v192, 16, v32
    v_and_b32 v193, 0xffff0000, v32
    v_lshlrev_b32 v194, 16, v33
    v_and_b32 v195, 0xffff0000, v33
    v_lshlrev_b32 v224, 16, v40
    v_and_b32 v225, 0xffff0000, v40
    v_lshlrev_b32 v226, 16, v41
    v_and_b32 v227, 0xffff0000, v41
    v_lshlrev_b32 v196, 16, v34
    v_and_b32 v197, 0xffff0000, v34
    v_lshlrev_b32 v198, 16, v35
    v_and_b32 v199, 0xffff0000, v35
    v_lshlrev_b32 v228, 16, v42
    v_and_b32 v229, 0xffff0000, v42
    v_lshlrev_b32 v230, 16, v43
    v_and_b32 v231, 0xffff0000, v43
    v_lshlrev_b32 v200, 16, v36
    v_and_b32 v201, 0xffff0000, v36
    v_lshlrev_b32 v202, 16, v37
    v_and_b32 v203, 0xffff0000, v37
    v_lshlrev_b32 v232, 16, v44
    v_and_b32 v233, 0xffff0000, v44
    v_lshlrev_b32 v234, 16, v45
    v_and_b32 v235, 0xffff0000, v45
    s_waitcnt vmcnt(16)
    s_waitcnt lgkmcnt(1)
    v_mfma_f32_16x16x32_bf16 v[192:195], a[144:147], a[0:3], v[192:195]
    ds_read_b128 a[172:175], v6 offset:2304
    v_mfma_f32_16x16x32_bf16 v[224:227], a[144:147], a[72:75], v[224:227]
    buffer_load_dwordx4 a[36:39], v4, s[24:27], s58 offen offset:1024 sc1
    v_mfma_f32_16x16x32_bf16 v[196:199], a[148:151], a[0:3], v[196:199]
    ds_read_b128 a[176:179], v6 offset:3328
    v_mfma_f32_16x16x32_bf16 v[228:231], a[148:151], a[72:75], v[228:231]
    buffer_load_dwordx4 a[108:111], v4, s[24:27], s85 offen offset:3072 sc1
    s_waitcnt lgkmcnt(2)
    v_mfma_f32_16x16x32_bf16 v[200:203], a[152:155], a[0:3], v[200:203]
    ds_read_b128 a[180:183], v31 offset:4352
    v_mfma_f32_16x16x32_bf16 v[232:235], a[152:155], a[72:75], v[232:235]
    s_waitcnt vmcnt(16)
    s_waitcnt lgkmcnt(1)
    v_mfma_f32_16x16x32_bf16 v[192:195], a[172:175], a[4:7], v[192:195]
    ds_read_b128 a[144:147], v6 offset:4608
    v_mfma_f32_16x16x32_bf16 v[224:227], a[172:175], a[76:79], v[224:227]
    buffer_load_dwordx4 a[40:43], v4, s[24:27], s58 offen offset:2048 sc1
    v_mfma_f32_16x16x32_bf16 v[196:199], a[176:179], a[4:7], v[196:199]
    ds_read_b128 a[148:151], v6 offset:5632
    v_mfma_f32_16x16x32_bf16 v[228:231], a[176:179], a[76:79], v[228:231]
    buffer_load_dwordx4 a[112:115], v4, s[24:27], s86 offen offset:0 sc1
    s_waitcnt lgkmcnt(2)
    v_mfma_f32_16x16x32_bf16 v[200:203], a[180:183], a[4:7], v[200:203]
    ds_read_b128 a[152:155], v31 offset:6656
    v_mfma_f32_16x16x32_bf16 v[232:235], a[180:183], a[76:79], v[232:235]
    s_waitcnt vmcnt(16)
    s_waitcnt lgkmcnt(1)
    v_mfma_f32_16x16x32_bf16 v[192:195], a[144:147], a[8:11], v[192:195]
    ds_read_b128 a[172:175], v6 offset:6912
    v_mfma_f32_16x16x32_bf16 v[224:227], a[144:147], a[80:83], v[224:227]
    buffer_load_dwordx4 a[44:47], v4, s[24:27], s58 offen offset:3072 sc1
    v_mfma_f32_16x16x32_bf16 v[196:199], a[148:151], a[8:11], v[196:199]
    ds_read_b128 a[176:179], v6 offset:7936
    v_mfma_f32_16x16x32_bf16 v[228:231], a[148:151], a[80:83], v[228:231]
    buffer_load_dwordx4 a[116:119], v4, s[24:27], s86 offen offset:1024 sc1
    s_waitcnt lgkmcnt(2)
    v_mfma_f32_16x16x32_bf16 v[200:203], a[152:155], a[8:11], v[200:203]
    ds_read_b128 a[180:183], v31 offset:8960
    v_mfma_f32_16x16x32_bf16 v[232:235], a[152:155], a[80:83], v[232:235]
    s_waitcnt vmcnt(16)
    s_waitcnt lgkmcnt(1)
    v_mfma_f32_16x16x32_bf16 v[192:195], a[172:175], a[12:15], v[192:195]
    ds_read_b128 a[144:147], v6 offset:9216
    v_mfma_f32_16x16x32_bf16 v[224:227], a[172:175], a[84:87], v[224:227]
    buffer_load_dwordx4 a[48:51], v4, s[24:27], s59 offen offset:0 sc1
    v_mfma_f32_16x16x32_bf16 v[196:199], a[176:179], a[12:15], v[196:199]
    ds_read_b128 a[148:151], v6 offset:10240
    v_mfma_f32_16x16x32_bf16 v[228:231], a[176:179], a[84:87], v[228:231]
    buffer_load_dwordx4 a[120:123], v4, s[24:27], s86 offen offset:2048 sc1
    s_waitcnt lgkmcnt(2)
    v_mfma_f32_16x16x32_bf16 v[200:203], a[180:183], a[12:15], v[200:203]
    ds_read_b128 a[152:155], v31 offset:11264
    v_mfma_f32_16x16x32_bf16 v[232:235], a[180:183], a[84:87], v[232:235]
    s_waitcnt vmcnt(16)
    s_waitcnt lgkmcnt(1)
    v_mfma_f32_16x16x32_bf16 v[192:195], a[144:147], a[16:19], v[192:195]
    ds_read_b128 a[172:175], v6 offset:11520
    v_mfma_f32_16x16x32_bf16 v[224:227], a[144:147], a[88:91], v[224:227]
    buffer_load_dwordx4 a[52:55], v4, s[24:27], s59 offen offset:1024 sc1
    v_mfma_f32_16x16x32_bf16 v[196:199], a[148:151], a[16:19], v[196:199]
    ds_read_b128 a[176:179], v6 offset:12544
    v_mfma_f32_16x16x32_bf16 v[228:231], a[148:151], a[88:91], v[228:231]
    buffer_load_dwordx4 a[124:127], v4, s[24:27], s86 offen offset:3072 sc1
    s_waitcnt lgkmcnt(2)
    v_mfma_f32_16x16x32_bf16 v[200:203], a[152:155], a[16:19], v[200:203]
    ds_read_b128 a[180:183], v31 offset:13568
    v_mfma_f32_16x16x32_bf16 v[232:235], a[152:155], a[88:91], v[232:235]
    s_waitcnt vmcnt(16)
    s_waitcnt lgkmcnt(1)
    v_mfma_f32_16x16x32_bf16 v[192:195], a[172:175], a[20:23], v[192:195]
    ds_read_b128 a[144:147], v6 offset:13824
    v_mfma_f32_16x16x32_bf16 v[224:227], a[172:175], a[92:95], v[224:227]
    buffer_load_dwordx4 a[56:59], v4, s[24:27], s59 offen offset:2048 sc1
    v_mfma_f32_16x16x32_bf16 v[196:199], a[176:179], a[20:23], v[196:199]
    ds_read_b128 a[148:151], v6 offset:14848
    v_mfma_f32_16x16x32_bf16 v[228:231], a[176:179], a[92:95], v[228:231]
    buffer_load_dwordx4 a[128:131], v4, s[24:27], s87 offen offset:0 sc1
    s_waitcnt lgkmcnt(2)
    v_mfma_f32_16x16x32_bf16 v[200:203], a[180:183], a[20:23], v[200:203]
    ds_read_b128 a[152:155], v31 offset:15872
    v_mfma_f32_16x16x32_bf16 v[232:235], a[180:183], a[92:95], v[232:235]
    s_waitcnt vmcnt(16)
    s_waitcnt lgkmcnt(1)
    v_mfma_f32_16x16x32_bf16 v[192:195], a[144:147], a[24:27], v[192:195]
    ds_read_b128 a[172:175], v6 offset:16128
    v_mfma_f32_16x16x32_bf16 v[224:227], a[144:147], a[96:99], v[224:227]
    buffer_load_dwordx4 a[60:63], v4, s[24:27], s59 offen offset:3072 sc1
    v_mfma_f32_16x16x32_bf16 v[196:199], a[148:151], a[24:27], v[196:199]
    ds_read_b128 a[176:179], v6 offset:17152
    v_mfma_f32_16x16x32_bf16 v[228:231], a[148:151], a[96:99], v[228:231]
    buffer_load_dwordx4 a[132:135], v4, s[24:27], s87 offen offset:1024 sc1
    s_waitcnt lgkmcnt(2)
    v_mfma_f32_16x16x32_bf16 v[200:203], a[152:155], a[24:27], v[200:203]
    ds_read_b128 a[180:183], v31 offset:18176
    v_mfma_f32_16x16x32_bf16 v[232:235], a[152:155], a[96:99], v[232:235]
    s_waitcnt vmcnt(16)
    s_waitcnt lgkmcnt(1)
    v_mfma_f32_16x16x32_bf16 v[192:195], a[172:175], a[28:31], v[192:195]
    ds_read_b128 a[144:147], v6 offset:18432
    v_mfma_f32_16x16x32_bf16 v[224:227], a[172:175], a[100:103], v[224:227]
    buffer_load_dwordx4 a[64:67], v4, s[24:27], s60 offen offset:0 sc1
    v_mfma_f32_16x16x32_bf16 v[196:199], a[176:179], a[28:31], v[196:199]
    ds_read_b128 a[148:151], v6 offset:19456
    v_mfma_f32_16x16x32_bf16 v[228:231], a[176:179], a[100:103], v[228:231]
    buffer_load_dwordx4 a[136:139], v4, s[24:27], s87 offen offset:2048 sc1
    s_waitcnt lgkmcnt(2)
    v_mfma_f32_16x16x32_bf16 v[200:203], a[180:183], a[28:31], v[200:203]
    ds_read_b128 a[152:155], v31 offset:20480
    v_mfma_f32_16x16x32_bf16 v[232:235], a[180:183], a[100:103], v[232:235]
    s_waitcnt vmcnt(16)
    s_waitcnt lgkmcnt(1)
    v_mfma_f32_16x16x32_bf16 v[192:195], a[144:147], a[32:35], v[192:195]
    ds_read_b128 a[172:175], v6 offset:20736
    v_mfma_f32_16x16x32_bf16 v[224:227], a[144:147], a[104:107], v[224:227]
    buffer_load_dwordx4 a[68:71], v4, s[24:27], s60 offen offset:1024 sc1
    v_mfma_f32_16x16x32_bf16 v[196:199], a[148:151], a[32:35], v[196:199]
    ds_read_b128 a[176:179], v6 offset:21760
    v_mfma_f32_16x16x32_bf16 v[228:231], a[148:151], a[104:107], v[228:231]
    buffer_load_dwordx4 a[140:143], v4, s[24:27], s87 offen offset:3072 sc1
    s_waitcnt lgkmcnt(2)
    v_mfma_f32_16x16x32_bf16 v[200:203], a[152:155], a[32:35], v[200:203]
    ds_read_b128 a[180:183], v31 offset:22784
    v_mfma_f32_16x16x32_bf16 v[232:235], a[152:155], a[104:107], v[232:235]
    s_waitcnt vmcnt(16)
    s_waitcnt lgkmcnt(1)
    v_mfma_f32_16x16x32_bf16 v[192:195], a[172:175], a[36:39], v[192:195]
    ds_read_b128 a[144:147], v6 offset:23040
    v_mfma_f32_16x16x32_bf16 v[224:227], a[172:175], a[108:111], v[224:227]
    v_mfma_f32_16x16x32_bf16 v[196:199], a[176:179], a[36:39], v[196:199]
    ds_read_b128 a[148:151], v6 offset:24064
    v_mfma_f32_16x16x32_bf16 v[228:231], a[176:179], a[108:111], v[228:231]
    s_waitcnt lgkmcnt(2)
    v_mfma_f32_16x16x32_bf16 v[200:203], a[180:183], a[36:39], v[200:203]
    ds_read_b128 a[152:155], v31 offset:25088
    v_mfma_f32_16x16x32_bf16 v[232:235], a[180:183], a[108:111], v[232:235]
    s_waitcnt vmcnt(14)
    s_waitcnt lgkmcnt(1)
    v_mfma_f32_16x16x32_bf16 v[192:195], a[144:147], a[40:43], v[192:195]
    ds_read_b128 a[172:175], v6 offset:25344
    v_mfma_f32_16x16x32_bf16 v[224:227], a[144:147], a[112:115], v[224:227]
    v_mfma_f32_16x16x32_bf16 v[196:199], a[148:151], a[40:43], v[196:199]
    ds_read_b128 a[176:179], v6 offset:26368
    v_mfma_f32_16x16x32_bf16 v[228:231], a[148:151], a[112:115], v[228:231]
    s_waitcnt lgkmcnt(2)
    v_mfma_f32_16x16x32_bf16 v[200:203], a[152:155], a[40:43], v[200:203]
    ds_read_b128 a[180:183], v31 offset:27392
    v_mfma_f32_16x16x32_bf16 v[232:235], a[152:155], a[112:115], v[232:235]
    s_waitcnt vmcnt(12)
    s_waitcnt lgkmcnt(1)
    v_mfma_f32_16x16x32_bf16 v[192:195], a[172:175], a[44:47], v[192:195]
    ds_read_b128 a[144:147], v6 offset:27648
    v_mfma_f32_16x16x32_bf16 v[224:227], a[172:175], a[116:119], v[224:227]
    v_mfma_f32_16x16x32_bf16 v[196:199], a[176:179], a[44:47], v[196:199]
    ds_read_b128 a[148:151], v6 offset:28672
    v_mfma_f32_16x16x32_bf16 v[228:231], a[176:179], a[116:119], v[228:231]
    s_waitcnt lgkmcnt(2)
    v_mfma_f32_16x16x32_bf16 v[200:203], a[180:183], a[44:47], v[200:203]
    ds_read_b128 a[152:155], v31 offset:29696
    v_mfma_f32_16x16x32_bf16 v[232:235], a[180:183], a[116:119], v[232:235]
    s_waitcnt vmcnt(10)
    s_waitcnt lgkmcnt(1)
    v_mfma_f32_16x16x32_bf16 v[192:195], a[144:147], a[48:51], v[192:195]
    ds_read_b128 a[172:175], v7 offset:53248
    v_mfma_f32_16x16x32_bf16 v[224:227], a[144:147], a[120:123], v[224:227]
    v_mfma_f32_16x16x32_bf16 v[196:199], a[148:151], a[48:51], v[196:199]
    ds_read_b128 a[176:179], v7 offset:54272
    v_mfma_f32_16x16x32_bf16 v[228:231], a[148:151], a[120:123], v[228:231]
    s_waitcnt lgkmcnt(2)
    v_mfma_f32_16x16x32_bf16 v[200:203], a[152:155], a[48:51], v[200:203]
    ds_read_b128 a[180:183], v30 offset:55296
    v_mfma_f32_16x16x32_bf16 v[232:235], a[152:155], a[120:123], v[232:235]
    s_waitcnt vmcnt(8)
    s_waitcnt lgkmcnt(1)
    v_mfma_f32_16x16x32_bf16 v[192:195], a[172:175], a[52:55], v[192:195]
    ds_read_b128 a[144:147], v7 offset:55552
    v_mfma_f32_16x16x32_bf16 v[224:227], a[172:175], a[124:127], v[224:227]
    v_mfma_f32_16x16x32_bf16 v[196:199], a[176:179], a[52:55], v[196:199]
    ds_read_b128 a[148:151], v7 offset:56576
    v_mfma_f32_16x16x32_bf16 v[228:231], a[176:179], a[124:127], v[228:231]
    s_waitcnt lgkmcnt(2)
    v_mfma_f32_16x16x32_bf16 v[200:203], a[180:183], a[52:55], v[200:203]
    ds_read_b128 a[152:155], v30 offset:57600
    v_mfma_f32_16x16x32_bf16 v[232:235], a[180:183], a[124:127], v[232:235]
    s_waitcnt vmcnt(6)
    s_waitcnt lgkmcnt(1)
    v_mfma_f32_16x16x32_bf16 v[192:195], a[144:147], a[56:59], v[192:195]
    ds_read_b128 a[172:175], v7 offset:57856
    v_mfma_f32_16x16x32_bf16 v[224:227], a[144:147], a[128:131], v[224:227]
    v_mfma_f32_16x16x32_bf16 v[196:199], a[148:151], a[56:59], v[196:199]
    ds_read_b128 a[176:179], v7 offset:58880
    v_mfma_f32_16x16x32_bf16 v[228:231], a[148:151], a[128:131], v[228:231]
    s_waitcnt lgkmcnt(2)
    v_mfma_f32_16x16x32_bf16 v[200:203], a[152:155], a[56:59], v[200:203]
    ds_read_b128 a[180:183], v30 offset:59904
    v_mfma_f32_16x16x32_bf16 v[232:235], a[152:155], a[128:131], v[232:235]
    s_waitcnt vmcnt(4)
    s_waitcnt lgkmcnt(1)
    v_mfma_f32_16x16x32_bf16 v[192:195], a[172:175], a[60:63], v[192:195]
    ds_read_b128 a[144:147], v7 offset:60160
    v_mfma_f32_16x16x32_bf16 v[224:227], a[172:175], a[132:135], v[224:227]
    v_mfma_f32_16x16x32_bf16 v[196:199], a[176:179], a[60:63], v[196:199]
    ds_read_b128 a[148:151], v7 offset:61184
    v_mfma_f32_16x16x32_bf16 v[228:231], a[176:179], a[132:135], v[228:231]
    s_waitcnt lgkmcnt(2)
    v_mfma_f32_16x16x32_bf16 v[200:203], a[180:183], a[60:63], v[200:203]
    ds_read_b128 a[152:155], v30 offset:62208
    v_mfma_f32_16x16x32_bf16 v[232:235], a[180:183], a[132:135], v[232:235]
    s_waitcnt vmcnt(2)
    s_waitcnt lgkmcnt(1)
    v_mfma_f32_16x16x32_bf16 v[192:195], a[144:147], a[64:67], v[192:195]
    ds_read_b128 a[172:175], v7 offset:62464
    v_mfma_f32_16x16x32_bf16 v[224:227], a[144:147], a[136:139], v[224:227]
    v_mfma_f32_16x16x32_bf16 v[196:199], a[148:151], a[64:67], v[196:199]
    ds_read_b128 a[176:179], v7 offset:63488
    v_mfma_f32_16x16x32_bf16 v[228:231], a[148:151], a[136:139], v[228:231]
    s_waitcnt lgkmcnt(2)
    v_mfma_f32_16x16x32_bf16 v[200:203], a[152:155], a[64:67], v[200:203]
    ds_read_b128 a[180:183], v30 offset:64512
    v_mfma_f32_16x16x32_bf16 v[232:235], a[152:155], a[136:139], v[232:235]
    s_waitcnt vmcnt(0)
    s_waitcnt lgkmcnt(1)
    v_mfma_f32_16x16x32_bf16 v[192:195], a[172:175], a[68:71], v[192:195]
    v_mfma_f32_16x16x32_bf16 v[224:227], a[172:175], a[140:143], v[224:227]
    v_mfma_f32_16x16x32_bf16 v[196:199], a[176:179], a[68:71], v[196:199]
    v_mfma_f32_16x16x32_bf16 v[228:231], a[176:179], a[140:143], v[228:231]
    s_waitcnt lgkmcnt(0)
    v_mfma_f32_16x16x32_bf16 v[200:203], a[180:183], a[68:71], v[200:203]
    v_mfma_f32_16x16x32_bf16 v[232:235], a[180:183], a[140:143], v[232:235]
    s_nop 1
    v_cvt_pk_bf16_f32 v48, v192, v193
    v_cvt_pk_bf16_f32 v49, v194, v195
    v_cvt_pk_bf16_f32 v56, v224, v225
    v_cvt_pk_bf16_f32 v57, v226, v227
    v_cvt_pk_bf16_f32 v50, v196, v197
    v_cvt_pk_bf16_f32 v51, v198, v199
    v_cvt_pk_bf16_f32 v58, v228, v229
    v_cvt_pk_bf16_f32 v59, v230, v231
    v_cvt_pk_bf16_f32 v52, v200, v201
    v_cvt_pk_bf16_f32 v53, v202, v203
    v_cvt_pk_bf16_f32 v60, v232, v233
    v_cvt_pk_bf16_f32 v61, v234, v235
    s_cmp_eq_u32 s3, 3
    s_cbranch_scc1 mega_fin
    s_cmp_eq_u32 s56, 0
    s_cbranch_scc1 mega_kernel_stg57
    buffer_store_dwordx2 v[48:49], v24, s[36:39], 0 offen
    buffer_store_dwordx2 v[50:51], v25, s[36:39], 0 offen
    buffer_store_dwordx2 v[52:53], v26, s[36:39], 0 offen
    buffer_store_dwordx2 v[56:57], v24, s[36:39], s88 offen
    buffer_store_dwordx2 v[58:59], v25, s[36:39], s88 offen
    buffer_store_dwordx2 v[60:61], v26, s[36:39], s88 offen
    s_branch mega_kernel_std58
mega_kernel_stg57:
    buffer_store_dwordx2 v[48:49], v24, s[36:39], 0 offen sc1
    buffer_store_dwordx2 v[50:51], v25, s[36:39], 0 offen sc1
    buffer_store_dwordx2 v[52:53], v26, s[36:39], 0 offen sc1
    buffer_store_dwordx2 v[56:57], v24, s[36:39], s88 offen sc1
    buffer_store_dwordx2 v[58:59], v25, s[36:39], s88 offen sc1
    buffer_store_dwordx2 v[60:61], v26, s[36:39], s88 offen sc1
mega_kernel_std58:
    v_mov_b32 v80, 0x3f803f80
    v_cndmask_b32 v88, 0, v52, s[72:73]
    v_cndmask_b32 v96, 0, v60, s[72:73]
    v_cndmask_b32 v89, 0, v53, s[72:73]
    v_cndmask_b32 v97, 0, v61, s[72:73]
    v_mov_b32 v84, 0
    v_mov_b32 v92, 0
    v_mov_b32 v85, 0
    v_mov_b32 v93, 0
    v_dot2c_f32_bf16 v84, v48, v80
    v_dot2c_f32_bf16 v92, v56, v80
    v_dot2c_f32_bf16 v85, v48, v48
    v_dot2c_f32_bf16 v93, v56, v56
    v_dot2c_f32_bf16 v84, v49, v80
    v_dot2c_f32_bf16 v92, v57, v80
    v_dot2c_f32_bf16 v85, v49, v49
    v_dot2c_f32_bf16 v93, v57, v57
    v_dot2c_f32_bf16 v84, v50, v80
    v_dot2c_f32_bf16 v92, v58, v80
    v_dot2c_f32_bf16 v85, v50, v50
    v_dot2c_f32_bf16 v93, v58, v58
    v_dot2c_f32_bf16 v84, v51, v80
    v_dot2c_f32_bf16 v92, v59, v80
    v_dot2c_f32_bf16 v85, v51, v51
    v_dot2c_f32_bf16 v93, v59, v59
    v_dot2c_f32_bf16 v84, v88, v80
    v_dot2c_f32_bf16 v92, v96, v80
    v_dot2c_f32_bf16 v85, v88, v88
    v_dot2c_f32_bf16 v93, v96, v96
    v_dot2c_f32_bf16 v84, v89, v80
    v_dot2c_f32_bf16 v92, v97, v80
    v_dot2c_f32_bf16 v85, v89, v89
    v_dot2c_f32_bf16 v93, v97, v97
    v_mov_b32 v86, v84
    v_mov_b32 v94, v92
    v_mov_b32 v87, v85
    v_mov_b32 v95, v93
    v_permlane16_swap_b32 v84, v86
    v_permlane16_swap_b32 v92, v94
    v_permlane16_swap_b32 v85, v87
    v_permlane16_swap_b32 v93, v95
    v_add_f32 v84, v84, v86
    v_add_f32 v92, v92, v94
    v_add_f32 v85, v85, v87
    v_add_f32 v93, v93, v95
    v_mov_b32 v86, v84
    v_mov_b32 v94, v92
    v_mov_b32 v87, v85
    v_mov_b32 v95, v93
    v_permlane32_swap_b32 v84, v86
    v_permlane32_swap_b32 v92, v94
    v_permlane32_swap_b32 v85, v87
    v_permlane32_swap_b32 v93, v95
    v_add_f32 v84, v84, v86
    v_add_f32 v92, v92, v94
    v_add_f32 v85, v85, v87
    v_add_f32 v93, v93, v95
    s_cmp_eq_u32 s56, 0
    s_cbranch_scc1 mega_kernel_stg59
    buffer_store_dwordx2 v[84:85], v27, s[64:67], 0 offen offset:0
    buffer_store_dwordx2 v[92:93], v27, s[64:67], 0 offen offset:2048
    s_branch mega_kernel_std60
mega_kernel_stg59:
    buffer_store_dwordx2 v[84:85], v27, s[64:67], 0 offen offset:0 sc1
    buffer_store_dwordx2 v[92:93], v27, s[64:67], 0 offen offset:2048 sc1
mega_kernel_std60:
    s_mov_b32 s0, s76
    s_bitcmp1_b32 s3, 0
    s_cbranch_scc1 mega_kernel_shb61
    s_mul_i32 s52, s44, 3
    s_add_u32 s52, s52, 96256
    s_min_u32 s52, s52, 102400
    s_mov_b32 m0, s52
    s_nop 0
    buffer_load_dwordx4 v4, s[28:31], s52 offen offset:0 lds
    buffer_load_dwordx4 v4, s[28:31], s52 offen offset:1024 lds
    buffer_load_dwordx4 v4, s[28:31], s52 offen offset:2048 lds
    s_add_u32 s3, s3, 1
    s_add_u32 s45, s45, 4980736
    s_lshr_b32 s61, s3, 1
    s_mul_i32 s16, s61, 7340032
    s_lshl_b32 s62, s42, 17
    s_add_u32 s62, s62, s16
    s_add_u32 s68, s22, 28545024
    s_addc_u32 s69, s23, 0
    s_add_u32 s68, s68, s62
    s_addc_u32 s69, s69, 0
    s_mov_b32 s70, 131072
    s_mov_b32 s71, 0x00020000
    s_lshl_b32 s62, s42, 14
    s_add_u32 s62, s62, s16
    s_add_u32 s72, s22, 30904320
    s_addc_u32 s73, s23, 0
    s_add_u32 s72, s72, s62
    s_addc_u32 s73, s73, 0
    s_mov_b32 s74, 16384
    s_mov_b32 s75, 0x00020000
    s_mul_i32 s62, s42, 163840
    s_add_u32 s62, s62, s16
    s_add_u32 s76, s22, 31166464
    s_addc_u32 s77, s23, 0
    s_add_u32 s76, s76, s62
    s_addc_u32 s77, s77, 0
    s_mov_b32 s78, 163840
    s_mov_b32 s79, 0x00020000
    s_lshr_b32 s64, s43, 1
    s_lshl_b32 s64, s64, 10
    s_add_u32 s65, s64, 65536
    s_lshl_b32 s66, s43, 6
    s_add_u32 s67, s66, 8192
    s_mul_i32 s88, s43, 640
    s_add_u32 s89, s88, 81920
    s_lshl_b32 s61, s61, 15
    s_lshl_b32 s62, s42, 11
    s_add_u32 s17, s61, s62
    s_add_u32 s17, s17, 69632
    s_lshl_b32 s62, s41, 6
    s_add_u32 s92, s17, s62
    v_cmp_eq_u32 s[90:91], 0, v2
    s_mul_i32 s46, s43, 18432
    s_add_u32 s46, s46, s45
    s_add_u32 s24, s22, 6524928
    s_addc_u32 s25, s23, 0
    s_add_u32 s24, s24, s46
    s_addc_u32 s25, s25, 0
    s_mov_b32 s26, 36864
    s_mov_b32 s27, 0x00020000
    s_lshl_b32 s61, s43, 11
    s_add_u32 s61, s61, s45
    s_add_u32 s32, s22, 8884224
    s_addc_u32 s33, s23, 0
    s_add_u32 s32, s32, s61
    s_addc_u32 s33, s33, 0
    s_mov_b32 s34, 4096
    s_mov_b32 s35, 0x00020000
    s_add_u32 s8, s22, s45
    s_addc_u32 s9, s23, 0
    s_mov_b32 s10, 16486400
    s_mov_b32 s11, 0x00020000
    s_mul_i32 s61, s42, 43008
    s_and_b32 s62, s3, 1
    s_mul_i32 s62, s62, 2932736
    s_add_u32 s61, s61, s62
    s_add_u32 s80, s22, 2097152
    s_addc_u32 s81, s23, 0
    s_add_u32 s80, s80, s61
    s_addc_u32 s81, s81, 0
    s_mov_b32 s82, 43008
    s_mov_b32 s83, 0x00020000
    s_mov_b32 s84, 20480
    s_mov_b32 s85, 24576
    s_mov_b32 s86, 28672
    s_mov_b32 s87, 32768
    s_lshl_b32 s61, s3, 13
    s_lshl_b32 s62, s41, 8
    s_add_u32 s61, s61, s62
    s_sub_u32 s61, s61, 8192
    s_add_u32 s62, s62, 139264
    s_cmp_eq_u32 s3, 0
    s_cselect_b32 s14, -1, 0xffff
    s_mov_b32 s15, 0
    s_cselect_b32 s1, s62, s61
    v_accvgpr_read_b32 v14, a200
    v_accvgpr_read_b32 v15, a201
    v_accvgpr_read_b32 v32, a232
    v_accvgpr_read_b32 v33, a205
    v_add_u32 v33, 512, v33
    s_waitcnt vmcnt(3) lgkmcnt(0)
    s_barrier
    s_cmp_lg_u32 s40, 0
    s_cbranch_scc1 mega_kernel_nosig62
    v_mov_b32 v5, s2
    s_mov_b64 exec, 1
    s_cmp_eq_u32 s56, 0
    s_cbranch_scc1 mega_kernel_stg63
    buffer_store_dword v5, off, s[48:51], s0
    s_branch mega_kernel_std64
mega_kernel_stg63:
    buffer_store_dword v5, off, s[48:51], s0 sc1
mega_kernel_std64:
    s_mov_b64 exec, -1
mega_kernel_nosig62:
    s_nop 3
    s_cmp_eq_u32 s40, 0
    s_cbranch_scc1 mega_kernel_nopf65
    s_mul_i32 s52, s44, 4
    s_add_u32 s52, s52, 114688
    s_min_u32 s52, s52, 124928
    s_mov_b32 m0, s52
    s_nop 0
    buffer_load_dwordx4 v4, s[28:31], s52 offen offset:0 lds
    buffer_load_dwordx4 v4, s[28:31], s52 offen offset:1024 lds
    buffer_load_dwordx4 v4, s[28:31], s52 offen offset:2048 lds
    buffer_load_dwordx4 v4, s[28:31], s52 offen offset:3072 lds
mega_kernel_nopf65:
    s_nop 1
    s_branch mega_b
mega_kernel_shb61:
    s_nop 3
    s_mul_i32 s52, s44, 4
    s_add_u32 s52, s52, 75776
    s_mov_b32 m0, s52
    s_nop 0
    buffer_load_dwordx4 v4, s[28:31], s52 offen offset:0 lds
    buffer_load_dwordx4 v4, s[28:31], s52 offen offset:1024 lds
    buffer_load_dwordx4 v4, s[28:31], s52 offen offset:2048 lds
    buffer_load_dwordx4 v4, s[28:31], s52 offen offset:3072 lds
    s_mul_i32 s52, s44, 3
    s_add_u32 s52, s52, 94208
    s_min_u32 s52, s52, 102400
    s_mov_b32 m0, s52
    s_nop 0
    buffer_load_dwordx4 v4, s[28:31], s52 offen offset:0 lds
    buffer_load_dwordx4 v4, s[28:31], s52 offen offset:1024 lds
    buffer_load_dwordx4 v4, s[28:31], s52 offen offset:2048 lds
    s_add_u32 s3, s3, 1
    s_add_u32 s45, s45, 4980736
    s_lshr_b32 s61, s3, 1
    s_mul_i32 s62, s61, 196608
    s_mul_i32 s63, s42, 12288
    s_add_u32 s62, s62, s63
    s_add_u32 s64, s22, 5865472
    s_addc_u32 s65, s23, 0
    s_add_u32 s64, s64, s62
    s_addc_u32 s65, s65, 0
    s_mov_b32 s66, 12288
    s_mov_b32 s67, 0x00020000
    s_lshl_b32 s61, s61, 12
    s_lshl_b32 s62, s42, 8
    s_add_u32 s76, s61, s62
    s_add_u32 s76, s76, 57344
    s_lshl_b32 s62, s41, 2
    s_add_u32 s78, s76, s62
    s_lshl_b32 s77, s3, 13
    s_lshl_b32 s62, s41, 8
    s_add_u32 s77, s77, s62
    s_add_u32 s77, s77, 200704
    s_lshl_b32 s62, s42, 2
    s_add_u32 s77, s77, s62
    v_add_u32 v34, -2, v3
    v_cmp_lt_u32 s[72:73], 5, v34
    v_cmp_gt_u32 s[74:75], 10, v3
    s_mul_i32 s46, s43, 18432
    s_add_u32 s46, s46, s45
    s_add_u32 s24, s22, 6524928
    s_addc_u32 s25, s23, 0
    s_add_u32 s24, s24, s46
    s_addc_u32 s25, s25, 0
    s_mov_b32 s26, 36864
    s_mov_b32 s27, 0x00020000
    s_lshl_b32 s61, s43, 11
    s_add_u32 s61, s61, s45
    s_add_u32 s32, s22, 8884224
    s_addc_u32 s33, s23, 0
    s_add_u32 s32, s32, s61
    s_addc_u32 s33, s33, 0
    s_mov_b32 s34, 4096
    s_mov_b32 s35, 0x00020000
    s_add_u32 s8, s22, s45
    s_addc_u32 s9, s23, 0
    s_mov_b32 s10, 16486400
    s_mov_b32 s11, 0x00020000
    s_mul_i32 s61, s42, 43008
    s_and_b32 s62, s3, 1
    s_mul_i32 s62, s62, 2932736
    s_add_u32 s61, s61, s62
    s_add_u32 s80, s22, 2097152
    s_addc_u32 s81, s23, 0
    s_add_u32 s80, s80, s61
    s_addc_u32 s81, s81, 0
    s_mov_b32 s82, 43008
    s_mov_b32 s83, 0x00020000
    s_mov_b32 s84, 20480
    s_mov_b32 s85, 24576
    s_mov_b32 s86, 28672
    s_mov_b32 s87, 32768
    s_lshl_b32 s61, s3, 13
    s_lshl_b32 s62, s41, 8
    s_add_u32 s61, s61, s62
    s_sub_u32 s61, s61, 8192
    s_add_u32 s62, s62, 139264
    s_cmp_eq_u32 s3, 0
    s_cselect_b32 s14, -1, 0xffff
    s_mov_b32 s15, 0
    s_cselect_b32 s1, s62, s61
    v_accvgpr_read_b32 v14, a200
    v_accvgpr_read_b32 v15, a201
    v_accvgpr_read_b32 v32, a232
    v_accvgpr_read_b32 v33, a205
    s_add_u32 s68, s22, 9146368
    s_addc_u32 s69, s23, 0
    s_add_u32 s68, s68, s46
    s_addc_u32 s69, s69, 0
    s_mov_b32 s70, 36864
    s_mov_b32 s71, 0x00020000
    s_lshl_b32 s4, s42, 10
    s_add_u32 s5, s4, 18432
    s_add_u32 s6, s101, 18432
    s_waitcnt vmcnt(7) lgkmcnt(0)
    s_barrier
    s_cmp_lg_u32 s40, 0
    s_cbranch_scc1 mega_kernel_nosig66
    v_mov_b32 v5, s2
    s_mov_b64 exec, 1
    s_cmp_eq_u32 s56, 0
    s_cbranch_scc1 mega_kernel_stg67
    buffer_store_dword v5, off, s[48:51], s0
    s_branch mega_kernel_std68
mega_kernel_stg67:
    buffer_store_dword v5, off, s[48:51], s0 sc1
mega_kernel_std68:
    s_mov_b64 exec, -1
mega_kernel_nosig66:
    s_nop 3
    s_cmp_eq_u32 s40, 0
    s_cbranch_scc1 mega_kernel_nopf69
    s_mul_i32 s52, s44, 4
    s_add_u32 s52, s52, 114688
    s_mov_b32 m0, s52
    s_nop 0
    buffer_load_dwordx4 v4, s[28:31], s52 offen offset:0 lds
    buffer_load_dwordx4 v4, s[28:31], s52 offen offset:1024 lds
    buffer_load_dwordx4 v4, s[28:31], s52 offen offset:2048 lds
    buffer_load_dwordx4 v4, s[28:31], s52 offen offset:3072 lds
mega_kernel_nopf69:
    s_nop 1
    s_branch mega_a
mega_fin:
    s_nop 3
    v_accvgpr_read_b32 v24, a225
    v_accvgpr_read_b32 v25, a227
    v_accvgpr_read_b32 v26, a229
    buffer_store_dwordx2 v[48:49], v24, s[68:71], 0 offen
    buffer_store_dwordx2 v[50:51], v25, s[68:71], 0 offen
    buffer_store_dwordx2 v[52:53], v26, s[68:71], 0 offen
    buffer_store_dwordx2 v[56:57], v24, s[68:71], s88 offen
    buffer_store_dwordx2 v[58:59], v25, s[68:71], s88 offen
    buffer_store_dwordx2 v[60:61], v26, s[68:71], s88 offen
mega_end:
    s_endpgm
mega_kernel_cz34:
    s_nop 7
    v_mov_b32 v208, 0
    v_mov_b32 v209, 0
    v_mov_b32 v210, 0
    v_mov_b32 v211, 0
    v_mov_b32 v212, 0
    v_mov_b32 v213, 0
    v_mov_b32 v214, 0
    v_mov_b32 v215, 0
    v_mov_b32 v216, 0
    v_mov_b32 v217, 0
    v_mov_b32 v218, 0
    v_mov_b32 v219, 0
    v_mov_b32 v220, 0
    v_mov_b32 v221, 0
    v_mov_b32 v222, 0
    v_mov_b32 v223, 0
    s_nop 1
    s_branch mega_kernel_cz34_back
mega_kernel_cz35:
    s_nop 7
    v_mov_b32 v208, 0
    v_mov_b32 v209, 0
    v_mov_b32 v210, 0
    v_mov_b32 v211, 0
    v_mov_b32 v212, 0
    v_mov_b32 v213, 0
    v_mov_b32 v214, 0
    v_mov_b32 v215, 0
    v_mov_b32 v216, 0
    v_mov_b32 v217, 0
    v_mov_b32 v218, 0
    v_mov_b32 v219, 0
    v_mov_b32 v220, 0
    v_mov_b32 v221, 0
    v_mov_b32 v222, 0
    v_mov_b32 v223, 0
    s_nop 1
    s_branch mega_kernel_cz35_back
mega_kernel_cz36:
    s_nop 7
    v_mov_b32 v208, 0
    v_mov_b32 v209, 0
    v_mov_b32 v210, 0
    v_mov_b32 v211, 0
    v_mov_b32 v212, 0
    v_mov_b32 v213, 0
    v_mov_b32 v214, 0
    v_mov_b32 v215, 0
    v_mov_b32 v216, 0
    v_mov_b32 v217, 0
    v_mov_b32 v218, 0
    v_mov_b32 v219, 0
    v_mov_b32 v220, 0
    v_mov_b32 v221, 0
    v_mov_b32 v222, 0
    v_mov_b32 v223, 0
    s_nop 1
    s_branch mega_kernel_cz36_back
mega_kernel_cz37:
    s_nop 7
    v_mov_b32 v208, 0
    v_mov_b32 v209, 0
    v_mov_b32 v210, 0
    v_mov_b32 v211, 0
    v_mov_b32 v212, 0
    v_mov_b32 v213, 0
    v_mov_b32 v214, 0
    v_mov_b32 v215, 0
    v_mov_b32 v216, 0
    v_mov_b32 v217, 0
    v_mov_b32 v218, 0
    v_mov_b32 v219, 0
    v_mov_b32 v220, 0
    v_mov_b32 v221, 0
    v_mov_b32 v222, 0
    v_mov_b32 v223, 0
    s_nop 1
    s_branch mega_kernel_cz37_back
mega_kernel_cz38:
    s_nop 7
    v_mov_b32 v208, 0
    v_mov_b32 v209, 0
    v_mov_b32 v210, 0
    v_mov_b32 v211, 0
    v_mov_b32 v212, 0
    v_mov_b32 v213, 0
    v_mov_b32 v214, 0
    v_mov_b32 v215, 0
    v_mov_b32 v216, 0
    v_mov_b32 v217, 0
    v_mov_b32 v218, 0
    v_mov_b32 v219, 0
    v_mov_b32 v220, 0
    v_mov_b32 v221, 0
    v_mov_b32 v222, 0
    v_mov_b32 v223, 0
    s_nop 1
    s_branch mega_kernel_cz38_back
mega_kernel_cz39:
    s_nop 7
    v_mov_b32 v208, 0
    v_mov_b32 v209, 0
    v_mov_b32 v210, 0
    v_mov_b32 v211, 0
    v_mov_b32 v212, 0
    v_mov_b32 v213, 0
    v_mov_b32 v214, 0
    v_mov_b32 v215, 0
    v_mov_b32 v216, 0
    v_mov_b32 v217, 0
    v_mov_b32 v218, 0
    v_mov_b32 v219, 0
    v_mov_b32 v220, 0
    v_mov_b32 v221, 0
    v_mov_b32 v222, 0
    v_mov_b32 v223, 0
    s_nop 1
    s_branch mega_kernel_cz39_back
mega_kernel_cz40:
    s_nop 7
    v_mov_b32 v208, 0
    v_mov_b32 v209, 0
    v_mov_b32 v210, 0
    v_mov_b32 v211, 0
    v_mov_b32 v212, 0
    v_mov_b32 v213, 0
    v_mov_b32 v214, 0
    v_mov_b32 v215, 0
    v_mov_b32 v216, 0
    v_mov_b32 v217, 0
    v_mov_b32 v218, 0
    v_mov_b32 v219, 0
    v_mov_b32 v220, 0
    v_mov_b32 v221, 0
    v_mov_b32 v222, 0
    v_mov_b32 v223, 0
    s_nop 1
    s_branch mega_kernel_cz40_back
mega_kernel_cz41:
    s_nop 7
    v_mov_b32 v208, 0
    v_mov_b32 v209, 0
    v_mov_b32 v210, 0
    v_mov_b32 v211, 0
    v_mov_b32 v212, 0
    v_mov_b32 v213, 0
    v_mov_b32 v214, 0
    v_mov_b32 v215, 0
    v_mov_b32 v216, 0
    v_mov_b32 v217, 0
    v_mov_b32 v218, 0
    v_mov_b32 v219, 0
    v_mov_b32 v220, 0
    v_mov_b32 v221, 0
    v_mov_b32 v222, 0
    v_mov_b32 v223, 0
    s_nop 1
    s_branch mega_kernel_cz41_back
mega_kernel_cz42:
    s_nop 7
    v_mov_b32 v208, 0
    v_mov_b32 v209, 0
    v_mov_b32 v210, 0
    v_mov_b32 v211, 0
    v_mov_b32 v212, 0
    v_mov_b32 v213, 0
    v_mov_b32 v214, 0
    v_mov_b32 v215, 0
    v_mov_b32 v216, 0
    v_mov_b32 v217, 0
    v_mov_b32 v218, 0
    v_mov_b32 v219, 0
    v_mov_b32 v220, 0
    v_mov_b32 v221, 0
    v_mov_b32 v222, 0
    v_mov_b32 v223, 0
    s_nop 1
    s_branch mega_kernel_cz42_back
mega_kernel_cz43:
    s_nop 7
    v_mov_b32 v208, 0
    v_mov_b32 v209, 0
    v_mov_b32 v210, 0
    v_mov_b32 v211, 0
    v_mov_b32 v212, 0
    v_mov_b32 v213, 0
    v_mov_b32 v214, 0
    v_mov_b32 v215, 0
    v_mov_b32 v216, 0
    v_mov_b32 v217, 0
    v_mov_b32 v218, 0
    v_mov_b32 v219, 0
    v_mov_b32 v220, 0
    v_mov_b32 v221, 0
    v_mov_b32 v222, 0
    v_mov_b32 v223, 0
    s_nop 1
    s_branch mega_kernel_cz43_back
mega_kernel_cz44:
    s_nop 7
    v_mov_b32 v208, 0
    v_mov_b32 v209, 0
    v_mov_b32 v210, 0
    v_mov_b32 v211, 0
    v_mov_b32 v212, 0
    v_mov_b32 v213, 0
    v_mov_b32 v214, 0
    v_mov_b32 v215, 0
    v_mov_b32 v216, 0
    v_mov_b32 v217, 0
    v_mov_b32 v218, 0
    v_mov_b32 v219, 0
    v_mov_b32 v220, 0
    v_mov_b32 v221, 0
    v_mov_b32 v222, 0
    v_mov_b32 v223, 0
    s_nop 1
    s_branch mega_kernel_cz44_back
mega_kernel_cz45:
    s_nop 7
    v_mov_b32 v208, 0
    v_mov_b32 v209, 0
    v_mov_b32 v210, 0
    v_mov_b32 v211, 0
    v_mov_b32 v212, 0
    v_mov_b32 v213, 0
    v_mov_b32 v214, 0
    v_mov_b32 v215, 0
    v_mov_b32 v216, 0
    v_mov_b32 v217, 0
    v_mov_b32 v218, 0
    v_mov_b32 v219, 0
    v_mov_b32 v220, 0
    v_mov_b32 v221, 0
    v_mov_b32 v222, 0
    v_mov_b32 v223, 0
    s_nop 1
    s_branch mega_kernel_cz45_back
mega_kernel_cz46:
    s_nop 7
    v_mov_b32 v208, 0
    v_mov_b32 v209, 0
    v_mov_b32 v210, 0
    v_mov_b32 v211, 0
    v_mov_b32 v212, 0
    v_mov_b32 v213, 0
    v_mov_b32 v214, 0
    v_mov_b32 v215, 0
    v_mov_b32 v216, 0
    v_mov_b32 v217, 0
    v_mov_b32 v218, 0
    v_mov_b32 v219, 0
    v_mov_b32 v220, 0
    v_mov_b32 v221, 0
    v_mov_b32 v222, 0
    v_mov_b32 v223, 0
    s_nop 1
    s_branch mega_kernel_cz46_back
mega_kernel_cz47:
    s_nop 7
    v_mov_b32 v208, 0
    v_mov_b32 v209, 0
    v_mov_b32 v210, 0
    v_mov_b32 v211, 0
    v_mov_b32 v212, 0
    v_mov_b32 v213, 0
    v_mov_b32 v214, 0
    v_mov_b32 v215, 0
    v_mov_b32 v216, 0
    v_mov_b32 v217, 0
    v_mov_b32 v218, 0
    v_mov_b32 v219, 0
    v_mov_b32 v220, 0
    v_mov_b32 v221, 0
    v_mov_b32 v222, 0
    v_mov_b32 v223, 0
    s_nop 1
    s_branch mega_kernel_cz47_back
mega_kernel_cz48:
    s_nop 7
    v_mov_b32 v208, 0
    v_mov_b32 v209, 0
    v_mov_b32 v210, 0
    v_mov_b32 v211, 0
    v_mov_b32 v212, 0
    v_mov_b32 v213, 0
    v_mov_b32 v214, 0
    v_mov_b32 v215, 0
    v_mov_b32 v216, 0
    v_mov_b32 v217, 0
    v_mov_b32 v218, 0
    v_mov_b32 v219, 0
    v_mov_b32 v220, 0
    v_mov_b32 v221, 0
    v_mov_b32 v222, 0
    v_mov_b32 v223, 0
    s_nop 1
    s_branch mega_kernel_cz48_back
mega_kernel_cz49:
    s_nop 7
    v_mov_b32 v208, 0
    v_mov_b32 v209, 0
    v_mov_b32 v210, 0
    v_mov_b32 v211, 0
    v_mov_b32 v212, 0
    v_mov_b32 v213, 0
    v_mov_b32 v214, 0
    v_mov_b32 v215, 0
    v_mov_b32 v216, 0
    v_mov_b32 v217, 0
    v_mov_b32 v218, 0
    v_mov_b32 v219, 0
    v_mov_b32 v220, 0
    v_mov_b32 v221, 0
    v_mov_b32 v222, 0
    v_mov_b32 v223, 0
    s_nop 1
    s_branch mega_kernel_cz49_back
.p2align 8
.fill 2048, 4, 0xBF800000
.section .rodata,"a"
.p2align 6
.amdhsa_kernel mega_kernel
  .amdhsa_next_free_vgpr 512
  .amdhsa_next_free_sgpr 102
  .amdhsa_accum_offset 256
  .amdhsa_group_segment_fixed_size 0
  .amdhsa_kernarg_size 80
  .amdhsa_user_sgpr_count 2
  .amdhsa_user_sgpr_kernarg_segment_ptr 1
  .amdhsa_system_sgpr_workgroup_id_x 1
  .amdhsa_float_denorm_mode_32 3
.end_amdhsa_kernel
```
